```python
import torch

def _softmax(x, axis=-1):
    return torch.softmax(x, dim=axis)
def _gelu(x):
    return torch.nn.functional.gelu(x, approximate="tanh")
def _silu(x):
    return torch.nn.functional.silu(x)
def _sigmoid(x):
    return torch.sigmoid(x)
def _layernorm(x, axis=-1, eps=1e-5):
    m = x.mean(dim=axis, keepdim=True)
    v = x.var(dim=axis, keepdim=True, unbiased=False)
    return (x - m) / torch.sqrt(v + eps)
def _scatter_add(tgt, idx, src, axis=0):
    return tgt.clone().index_add_(axis, idx, src)
def _segment_sum(src, seg, n):
    out = torch.zeros((n,) + src.shape[1:], dtype=src.dtype)
    return out.index_add_(0, seg, src)
def _pad(x, pw):
    flat = tuple(v for pair in reversed(pw) for v in pair)
    return torch.nn.functional.pad(x, flat)

kernel_name = 'gated_mix__linear_attn_block__spectral_gfnet__prompt'

def setup_inputs():

    _w = (lambda a: (lambda t: t.to(torch.bfloat16) if t.is_floating_point() else t)(torch.as_tensor(a)))
    def _A_setup():
        B, S, D = 1, 2048, 640
        return {
            "x": _w((lambda *s: torch.randn(*s, dtype=torch.bfloat16) * 0.05)(B, S, D)),
            "wqkv": _w((lambda *s: torch.randn(*s, dtype=torch.bfloat16) * 0.4)(D, 3 * D)),
            "wo": _w((lambda *s: torch.randn(*s, dtype=torch.bfloat16) * 0.05)(D, D)),
        }
    _A_in = _A_setup()

    def _B_setup():
        B, S, D = 1, 2048, 640
        Df = D // 2 + 1
        return {
            "x": _w((lambda *s: torch.randn(*s, dtype=torch.bfloat16) * 0.05)(B, S, D)),
            "w_r": _w((lambda *s: torch.randn(*s, dtype=torch.bfloat16) * 1.6)(S, Df) * 0.02),
            "w_i": _w((lambda *s: torch.randn(*s, dtype=torch.bfloat16) * 1.6)(S, Df) * 0.02),
        }
    _B_in = _B_setup()

    return {
        "A_x": _A_in["x"],
        "A_wqkv": _A_in["wqkv"],
        "A_wo": _A_in["wo"],
        "B_x": _B_in["x"],
        "B_w_r": _B_in["w_r"],
        "B_w_i": _B_in["w_i"],
        "gate_w": _w((lambda *s: torch.randn(*s, dtype=torch.bfloat16) * 0.05)(640) * 16.0),
    }

def reference(A_x, A_wqkv, A_wo, B_x, B_w_r, B_w_i, gate_w):
    def _A_ref(x, wqkv, wo):
        B, S, D = x.shape
        H = 32; Dh = D // H
        qkv = (lambda x, *d: x.permute(*d))((x @ wqkv).reshape(B, S, 3, H, Dh), 2, 0, 3, 1, 4)
        q, k, v = qkv[0], qkv[1], qkv[2]
        phi = lambda t: torch.where(t > 0, t + 1, torch.exp(t)) + 1e-6
        pq, pk = phi(q), phi(k)
        kv = torch.einsum("bhsd,bhse->bhde", pk, v)
        z = torch.einsum("bhsd->bhd", pk)
        num = torch.einsum("bhqd,bhde->bhqe", pq, kv)
        den = torch.einsum("bhqd,bhd->bhq", pq, z)[..., None] + 1e-6
        o = num / den
        return (lambda x, *d: x.permute(*d))(o, 0, 2, 1, 3).reshape(B, S, D) @ wo

    def _B_ref(x, w_r, w_i):
        B, S, D = x.shape
        X = (lambda x, axes=(-2,-1): torch.fft.rfft2(x.float(), dim=axes))(x, axes=(-2, -1))
        W = w_r + 1j * w_i
        X = X * W
        y = (lambda x, s, axes=(-2,-1): torch.fft.irfft2(x, s=s, dim=axes).to(torch.bfloat16))(X, (S, D), axes=(-2, -1))
        return y

    x = A_x
    g = _sigmoid((x * gate_w).sum(-1, keepdims=True))
    a = _A_ref(x, A_wqkv, A_wo)
    b = _B_ref(x, B_w_r, B_w_i)
    return g * a + (1 - g) * b
```

```asm
; @launch kernel=f_kernel grid=(256,1,1) block=(512,1,1) lds=163840
.amdgcn_target "amdgcn-amd-amdhsa--gfx950"
.text
.globl f_kernel
.p2align 8
.type f_kernel,@function
f_kernel:
    s_load_dwordx8 s[8:15], s[0:1], 0
    s_load_dwordx8 s[16:23], s[0:1], 32
    s_load_dwordx4 s[24:27], s[0:1], 64
    s_cmp_ge_u32 s2, 256
    s_cbranch_scc0 L1
    s_endpgm
L1:
    v_lshrrev_b32 v1, 6, v0
    v_and_b32 v0, 63, v0
    v_readfirstlane_b32 s3, v1
    s_and_b32 s79, s2, 3
    s_lshl_b32 s79, s79, 2
    s_lshr_b32 s78, s2, 3
    s_and_b32 s78, s78, 3
    s_add_u32 s4, s79, s78
    s_cmp_ge_u32 s2, 192
    s_cbranch_scc1 K1_F
    s_cmp_ge_u32 s2, 128
    s_cbranch_scc1 K1_Q
    s_and_b32 s79, s2, 4
    s_lshr_b32 s78, s2, 5
    s_and_b32 s78, s78, 3
    s_add_u32 s5, s79, s78
    v_and_b32 v127, 7, v0
    v_lshrrev_b32 v126, 4, v0
    v_xor_b32 v126, v127, v126
    v_lshrrev_b32 v127, 3, v0
    v_mul_u32_u24 v127, 0x14000, v127
    v_lshl_add_u32 v127, v126, 4, v127
    s_and_b32 s79, s3, 1
    s_lshl_b32 s79, s79, 10
    s_lshl_b32 s78, s4, 2
    s_add_u32 s78, s79, s78
    s_lshr_b32 s79, s3, 1
    s_add_u32 s79, s78, s79
    s_mul_i32 s79, s79, 0x500
    v_add_u32 v100, s79, v127
    v_and_b32 v127, 7, v0
    v_lshrrev_b32 v126, 4, v0
    v_add_u32 v126, 4, v126
    v_xor_b32 v126, v127, v126
    v_lshrrev_b32 v127, 3, v0
    v_mul_u32_u24 v127, 0x14000, v127
    v_lshl_add_u32 v127, v126, 4, v127
    s_and_b32 s79, s3, 1
    s_lshl_b32 s79, s79, 10
    s_add_u32 s79, s79, 0x200
    s_lshl_b32 s78, s4, 2
    s_add_u32 s78, s79, s78
    s_lshr_b32 s79, s3, 1
    s_add_u32 s79, s78, s79
    s_mul_i32 s79, s79, 0x500
    v_add_u32 v101, s79, v127
    s_and_b32 s79, s3, 3
    s_lshl_b32 s79, s79, 4
    v_mul_u32_u24 v127, 0xcd, v0
    v_lshrrev_b32 v127, 11, v127
    v_add_u32 v138, s79, v127
    v_and_b32 v127, 4, v138
    v_and_b32 v126, 51, v138
    v_lshl_add_u32 v126, v127, 1, v126
    v_and_b32 v127, 8, v138
    v_lshrrev_b32 v127, 1, v127
    v_add_u32 v139, v126, v127
    v_mul_u32_u24 v127, 0xcd, v0
    v_lshrrev_b32 v127, 11, v127
    v_mul_u32_u24 v127, 10, v127
    v_sub_u32 v127, v0, v127
    v_mul_u32_u24 v126, 0xf00, v139
    v_lshl_add_u32 v126, v127, 4, v126
    s_lshr_b32 s79, s3, 2
    s_mul_i32 s79, s79, 0x500
    s_add_u32 s79, 0x500, s79
    s_mul_i32 s78, s5, 0xa0
    s_add_u32 s78, s79, s78
    v_add_u32 v102, s78, v126
    s_and_b32 s79, s3, 3
    s_lshl_b32 s79, s79, 4
    v_add_u32 v127, 64, v0
    v_mul_u32_u24 v127, 0xcd, v127
    v_lshrrev_b32 v127, 11, v127
    v_add_u32 v138, s79, v127
    v_and_b32 v127, 4, v138
    v_and_b32 v126, 51, v138
    v_lshl_add_u32 v126, v127, 1, v126
    v_and_b32 v127, 8, v138
    v_lshrrev_b32 v127, 1, v127
    v_add_u32 v139, v126, v127
    v_add_u32 v127, 64, v0
    v_mul_u32_u24 v126, 0xcd, v127
    v_lshrrev_b32 v126, 11, v126
    v_mul_u32_u24 v126, 10, v126
    v_sub_u32 v126, v127, v126
    v_mul_u32_u24 v127, 0xf00, v139
    v_lshl_add_u32 v127, v126, 4, v127
    s_lshr_b32 s79, s3, 2
    s_mul_i32 s79, s79, 0x500
    s_add_u32 s79, 0x500, s79
    s_mul_i32 s78, s5, 0xa0
    s_add_u32 s78, s79, s78
    v_add_u32 v103, s78, v127
    s_and_b32 s79, s3, 3
    s_lshl_b32 s79, s79, 4
    v_add_u32 v127, 0x80, v0
    v_mul_u32_u24 v127, 0xcd, v127
    v_lshrrev_b32 v127, 11, v127
    v_add_u32 v138, s79, v127
    v_and_b32 v127, 4, v138
    v_and_b32 v126, 51, v138
    v_lshl_add_u32 v126, v127, 1, v126
    v_and_b32 v127, 8, v138
    v_lshrrev_b32 v127, 1, v127
    v_add_u32 v139, v126, v127
    v_add_u32 v127, 0x80, v0
    v_mul_u32_u24 v126, 0xcd, v127
    v_lshrrev_b32 v126, 11, v126
    v_mul_u32_u24 v126, 10, v126
    v_sub_u32 v126, v127, v126
    v_mul_u32_u24 v127, 0xf00, v139
    v_lshl_add_u32 v127, v126, 4, v127
    s_lshr_b32 s79, s3, 2
    s_mul_i32 s79, s79, 0x500
    s_add_u32 s79, 0x500, s79
    s_mul_i32 s78, s5, 0xa0
    s_add_u32 s78, s79, s78
    v_add_u32 v104, s78, v127
    s_lshl_b32 s83, s3, 11
    s_lshr_b32 s79, s3, 2
    s_mul_i32 s79, s79, 0x2800
    s_and_b32 s78, s3, 3
    s_mul_i32 s78, s78, 0xa00
    s_add_u32 s78, s79, s78
    s_add_u32 s84, s78, 0x4000
    s_and_b32 s79, s4, 3
    s_mul_i32 s79, s79, 3
    s_and_b32 s78, s5, 3
    s_lshl_b32 s78, s78, 1
    s_add_u32 s78, s79, s78
    s_add_u32 s78, s78, 10
    s_mul_i32 s79, s78, 0xcd
    s_lshr_b32 s79, s79, 11
    s_mul_i32 s79, s79, 10
    s_sub_u32 s80, s78, s79
    s_waitcnt lgkmcnt(0)
    s_mov_b32 s28, s8
    s_and_b32 s29, s9, 0xffff
    s_mov_b32 s30, 0x280000
    s_mov_b32 s31, 0x20000
    s_mov_b32 s32, s10
    s_and_b32 s33, s11, 0xffff
    s_mov_b32 s34, 0x258000
    s_mov_b32 s35, 0x20000
    s_lshl_b32 s81, s80, 7
    s_mul_i32 s82, s80, 245760
    s_add_u32 s80, s80, 1
    s_cmp_eq_u32 s80, 10
    s_cselect_b32 s80, 0, s80
    s_add_u32 m0, s83, 0
    s_nop 0
    buffer_load_dwordx4 v100, s[28:31], s81 offen lds
    s_add_u32 m0, s84, 0
    s_nop 0
    buffer_load_dwordx4 v102, s[32:35], s82 offen lds
    s_add_u32 m0, s83, 1024
    s_nop 0
    buffer_load_dwordx4 v101, s[28:31], s81 offen lds
    s_add_u32 m0, s84, 1024
    s_nop 0
    buffer_load_dwordx4 v103, s[32:35], s82 offen lds
    s_add_u32 m0, s84, 2048
    s_mov_b64 exec, 0xffffffff
    buffer_load_dwordx4 v104, s[32:35], s82 offen lds
    s_mov_b64 exec, -1
    s_barrier
    s_mov_b32 s36, s26
    s_and_b32 s37, s27, 0xffff
    s_mov_b32 s38, 0xc40000
    s_mov_b32 s39, 0x20000
    s_mov_b32 s40, s24
    s_and_b32 s41, s25, 0xffff
    s_mov_b32 s42, 0x100
    s_mov_b32 s43, 0x20000
    s_and_b32 s79, s3, 3
    s_lshl_b32 s79, s79, 5
    v_and_b32 v127, 15, v0
    v_add_u32 v127, s79, v127
    v_lshrrev_b32 v126, 4, v0
    v_and_b32 v125, 15, v0
    v_lshrrev_b32 v125, 1, v125
    v_xor_b32 v125, v126, v125
    v_lshlrev_b32 v125, 4, v125
    v_lshl_add_u32 v106, v127, 7, v125
    s_and_b32 s79, s3, 3
    s_lshl_b32 s79, s79, 5
    v_and_b32 v127, 15, v0
    v_add_u32 v127, s79, v127
    v_lshrrev_b32 v126, 4, v0
    v_add_u32 v126, 4, v126
    v_and_b32 v125, 15, v0
    v_lshrrev_b32 v125, 1, v125
    v_xor_b32 v125, v126, v125
    v_lshlrev_b32 v125, 4, v125
    v_lshl_add_u32 v107, v127, 7, v125
    v_lshrrev_b32 v127, 5, v0
    v_lshrrev_b32 v126, 4, v0
    v_and_b32 v126, 1, v126
    v_lshlrev_b32 v126, 2, v126
    v_lshl_add_u32 v126, v127, 4, v126
    v_lshrrev_b32 v127, 2, v0
    v_and_b32 v127, 3, v127
    v_add_u32 v127, v126, v127
    v_mul_u32_u24 v138, 0xa0, v127
    v_and_b32 v127, 3, v0
    v_lshl_add_u32 v127, v127, 3, v138
    s_lshr_b32 s79, s3, 2
    s_mul_i32 s79, s79, 0x50
    v_add_u32 v127, s79, v127
    v_add_u32 v114, 0x4000, v127
    v_and_b32 v127, 3, v0
    v_mul_u32_u24 v127, 40, v127
    v_add_u32 v127, v138, v127
    s_lshr_b32 s79, s3, 2
    s_mul_i32 s79, s79, 0x2800
    v_add_u32 v127, s79, v127
    v_add_u32 v118, 0x4020, v127
    v_add_u32 v108, 36864, v106
    v_add_u32 v109, 36864, v107
    v_add_u32 v115, 36864, v114
    v_add_u32 v119, 36864, v118
    v_add_u32 v110, 73728, v106
    v_add_u32 v111, 73728, v107
    v_add_u32 v116, 73728, v114
    v_add_u32 v120, 73728, v118
    v_add_u32 v112, 110592, v106
    v_add_u32 v113, 110592, v107
    v_add_u32 v117, 110592, v114
    v_add_u32 v121, 110592, v118
    s_mov_b32 s85, 0x3fb8aa3b
    s_mov_b32 s86, 0x358637bd
    s_cmp_lt_u32 s3, 4
    s_cselect_b32 s74, s86, 0
    v_mov_b32 v4, s86
    v_mov_b32 v5, s86
    v_mov_b32 v6, s86
    v_mov_b32 v7, s86
    v_mov_b32 v8, s86
    v_mov_b32 v9, s86
    v_mov_b32 v10, s86
    v_mov_b32 v11, s86
    v_mov_b32 v12, s86
    v_mov_b32 v13, s86
    v_mov_b32 v14, s86
    v_mov_b32 v15, s86
    v_mov_b32 v16, s86
    v_mov_b32 v17, s86
    v_mov_b32 v18, s86
    v_mov_b32 v19, s86
    v_mov_b32 v20, s74
    v_mov_b32 v21, s74
    v_mov_b32 v22, s74
    v_mov_b32 v23, s74
    v_mov_b32 v24, s74
    v_mov_b32 v25, s74
    v_mov_b32 v26, s74
    v_mov_b32 v27, s74
    v_mov_b32 v28, 0
    v_mov_b32 v29, 0
    v_mov_b32 v30, 0
    v_mov_b32 v31, 0
    v_mov_b32 v32, 0
    v_mov_b32 v33, 0
    v_mov_b32 v34, 0
    v_mov_b32 v35, 0
    v_mov_b32 v36, 0
    v_mov_b32 v37, 0
    v_mov_b32 v38, 0
    v_mov_b32 v39, 0
    v_mov_b32 v40, 0
    v_mov_b32 v41, 0
    v_mov_b32 v42, 0
    v_mov_b32 v43, 0
    s_lshr_b32 s79, s3, 2
    s_lshl_b32 s79, s79, 11
    s_and_b32 s78, s3, 3
    s_mul_i32 s78, s78, 0x2820
    s_add_u32 s78, s79, s78
    v_lshl_add_u32 v127, v0, 4, s78
    v_add_u32 v128, 0x12000, v127
    s_and_b32 s79, s3, 3
    s_mul_i32 s79, s79, 0x2820
    s_lshr_b32 s78, s3, 2
    s_mul_i32 s78, s78, 0x1400
    s_add_u32 s78, s79, s78
    v_lshl_add_u32 v127, v0, 4, s78
    v_add_u32 v129, 0x13000, v127
    v_lshlrev_b32 v127, 4, v0
    v_add_u32 v142, 0x12000, v127
    v_lshrrev_b32 v127, 4, v0
    v_lshrrev_b32 v126, 2, v0
    v_and_b32 v126, 3, v126
    v_lshl_add_u32 v126, v127, 4, v126
    v_lshlrev_b32 v126, 4, v126
    v_add_u32 v143, 0x12000, v126
    s_cmp_ge_u32 s3, 4
    s_cbranch_scc1 L2
    s_lshl_b32 s79, s3, 10
    v_add_u32 v130, s79, v142
    s_add_u32 s79, s3, 5
    s_lshl_b32 s79, s79, 10
    v_add_u32 v131, s79, v142
    s_lshl_b32 s79, s3, 6
    v_add_u32 v127, s79, v143
    v_add_u32 v132, 0x1000, v127
    v_mov_b32 v133, v131
    s_nop 1
    s_branch L4
L2:
    s_and_b32 s79, s3, 1
    s_lshl_b32 s79, s79, 7
    s_add_u32 s87, s79, 0x2400
    v_add_u32 v131, s87, v143
    v_and_b32 v122, 3, v0
    v_mov_b32 v123, 83968
    v_mov_b32 v124, 83984
    v_cmp_eq_u32 vcc, 1, v122
    s_nop 1
    v_cndmask_b32 v131, v124, v131, vcc
    v_cmp_eq_u32 vcc, 0, v122
    s_nop 1
    v_cndmask_b32 v131, v131, v123, vcc
    s_and_b32 s79, s3, 1
    s_lshl_b32 s79, s79, 7
    s_add_u32 s87, s79, 0x2440
    v_add_u32 v133, s87, v143
    v_and_b32 v122, 3, v0
    v_mov_b32 v123, 83968
    v_mov_b32 v124, 83984
    v_cmp_eq_u32 vcc, 3, v122
    s_nop 1
    v_cndmask_b32 v133, v124, v133, vcc
    v_cmp_eq_u32 vcc, 2, v122
    s_nop 1
    v_cndmask_b32 v133, v133, v123, vcc
    s_cmp_ge_u32 s3, 6
    s_cbranch_scc1 L3
    s_and_b32 s79, s3, 1
    s_lshl_b32 s79, s79, 11
    v_add_u32 v130, s79, v142
    v_add_u32 v132, 1024, v130
    s_nop 1
    s_branch L4
L3:
    s_and_b32 s79, s3, 1
    s_lshl_b32 s79, s79, 7
    v_add_u32 v127, s79, v143
    v_add_u32 v130, 0x1000, v127
    v_add_u32 v132, 64, v130
    s_nop 1
L4:
    v_lshlrev_b32 v134, 2, v0
    v_mov_b32 v135, 0
    s_lshl_b32 s81, s80, 7
    s_mul_i32 s82, s80, 245760
    s_add_u32 s80, s80, 1
    s_cmp_eq_u32 s80, 10
    s_cselect_b32 s80, 0, s80
    s_add_u32 m0, s83, 36864
    s_nop 0
    buffer_load_dwordx4 v100, s[28:31], s81 offen lds
    s_add_u32 m0, s84, 36864
    s_nop 0
    buffer_load_dwordx4 v102, s[32:35], s82 offen lds
    s_add_u32 m0, s83, 37888
    s_nop 0
    buffer_load_dwordx4 v101, s[28:31], s81 offen lds
    s_add_u32 m0, s84, 37888
    s_nop 0
    buffer_load_dwordx4 v103, s[32:35], s82 offen lds
    s_add_u32 m0, s84, 38912
    s_mov_b64 exec, 0xffffffff
    buffer_load_dwordx4 v104, s[32:35], s82 offen lds
    s_mov_b64 exec, -1
    s_waitcnt vmcnt(5)
    s_barrier
    ds_read_b128 v[44:47], v106 offset:0
    ds_read_b128 v[48:51], v106 offset:2048
    ds_read_b64_tr_b16 v[60:61], v114 offset:0
    ds_read_b64_tr_b16 v[62:63], v114 offset:1280
    ds_read_b64_tr_b16 v[64:65], v114 offset:40
    ds_read_b64_tr_b16 v[66:67], v114 offset:1320
    ds_read_b64_tr_b16 v[68:69], v118 offset:0
    ds_read_b64_tr_b16 v[70:71], v118 offset:1280
    ds_read_b64_tr_b16 v[72:73], v114 offset:10240
    ds_read_b64_tr_b16 v[74:75], v114 offset:11520
    ds_read_b64_tr_b16 v[76:77], v114 offset:10280
    ds_read_b64_tr_b16 v[78:79], v114 offset:11560
    ds_read_b128 v[52:55], v107 offset:0
    ds_read_b128 v[56:59], v107 offset:2048
    s_waitcnt lgkmcnt(10)
    v_mfma_f32_16x16x32_bf16 v[4:7], v[44:47], v[60:63], v[4:7]
    ds_read_b64_tr_b16 v[80:81], v114 offset:5120
    ds_read_b64_tr_b16 v[82:83], v114 offset:6400
    v_mfma_f32_16x16x32_bf16 v[8:11], v[48:51], v[60:63], v[8:11]
    s_lshl_b32 s81, s80, 7
    s_mul_i32 s82, s80, 245760
    s_add_u32 s80, s80, 1
    s_cmp_eq_u32 s80, 10
    s_cselect_b32 s80, 0, s80
    s_add_u32 m0, s83, 73728
    s_nop 0
    buffer_load_dwordx4 v100, s[28:31], s81 offen lds
    ds_read_b64_tr_b16 v[84:85], v114 offset:5160
    ds_read_b64_tr_b16 v[86:87], v114 offset:6440
    s_waitcnt lgkmcnt(12)
    v_mfma_f32_16x16x32_bf16 v[12:15], v[44:47], v[64:67], v[12:15]
    ds_read_b64_tr_b16 v[88:89], v118 offset:5120
    ds_read_b64_tr_b16 v[90:91], v118 offset:6400
    v_mfma_f32_16x16x32_bf16 v[16:19], v[48:51], v[64:67], v[16:19]
    s_add_u32 m0, s84, 73728
    s_nop 0
    buffer_load_dwordx4 v102, s[32:35], s82 offen lds
    ds_read_b64_tr_b16 v[92:93], v114 offset:15360
    ds_read_b64_tr_b16 v[94:95], v114 offset:16640
    s_waitcnt lgkmcnt(14)
    v_mfma_f32_16x16x32_bf16 v[20:23], v[44:47], v[68:71], v[20:23]
    ds_read_b64_tr_b16 v[96:97], v114 offset:15400
    ds_read_b64_tr_b16 v[98:99], v114 offset:16680
    v_mfma_f32_16x16x32_bf16 v[24:27], v[48:51], v[68:71], v[24:27]
    s_add_u32 m0, s83, 74752
    s_nop 0
    buffer_load_dwordx4 v101, s[28:31], s81 offen lds
    s_waitcnt lgkmcnt(14)
    v_mfma_f32_16x16x32_bf16 v[28:31], v[44:47], v[72:75], v[28:31]
    v_mfma_f32_16x16x32_bf16 v[32:35], v[48:51], v[72:75], v[32:35]
    s_add_u32 m0, s84, 74752
    s_nop 0
    buffer_load_dwordx4 v103, s[32:35], s82 offen lds
    s_waitcnt lgkmcnt(12)
    v_mfma_f32_16x16x32_bf16 v[36:39], v[44:47], v[76:79], v[36:39]
    v_mfma_f32_16x16x32_bf16 v[40:43], v[48:51], v[76:79], v[40:43]
    s_add_u32 m0, s84, 75776
    s_mov_b64 exec, 0xffffffff
    buffer_load_dwordx4 v104, s[32:35], s82 offen lds
    s_mov_b64 exec, -1
    s_waitcnt lgkmcnt(0)
    s_waitcnt vmcnt(5)
    s_barrier
    ds_read_b128 v[44:47], v108 offset:0
    ds_read_b128 v[48:51], v108 offset:2048
    v_mfma_f32_16x16x32_bf16 v[4:7], v[52:55], v[80:83], v[4:7]
    ds_read_b64_tr_b16 v[60:61], v115 offset:0
    ds_read_b64_tr_b16 v[62:63], v115 offset:1280
    v_mfma_f32_16x16x32_bf16 v[8:11], v[56:59], v[80:83], v[8:11]
    s_lshl_b32 s81, s80, 7
    s_mul_i32 s82, s80, 245760
    s_add_u32 s80, s80, 1
    s_cmp_eq_u32 s80, 10
    s_cselect_b32 s80, 0, s80
    s_add_u32 m0, s83, 110592
    s_nop 0
    buffer_load_dwordx4 v100, s[28:31], s81 offen lds
    ds_read_b64_tr_b16 v[64:65], v115 offset:40
    ds_read_b64_tr_b16 v[66:67], v115 offset:1320
    v_mfma_f32_16x16x32_bf16 v[12:15], v[52:55], v[84:87], v[12:15]
    ds_read_b64_tr_b16 v[68:69], v119 offset:0
    ds_read_b64_tr_b16 v[70:71], v119 offset:1280
    v_mfma_f32_16x16x32_bf16 v[16:19], v[56:59], v[84:87], v[16:19]
    s_add_u32 m0, s84, 110592
    s_nop 0
    buffer_load_dwordx4 v102, s[32:35], s82 offen lds
    ds_read_b64_tr_b16 v[72:73], v115 offset:10240
    ds_read_b64_tr_b16 v[74:75], v115 offset:11520
    v_mfma_f32_16x16x32_bf16 v[20:23], v[52:55], v[88:91], v[20:23]
    ds_read_b64_tr_b16 v[76:77], v115 offset:10280
    ds_read_b64_tr_b16 v[78:79], v115 offset:11560
    v_mfma_f32_16x16x32_bf16 v[24:27], v[56:59], v[88:91], v[24:27]
    s_add_u32 m0, s83, 111616
    s_nop 0
    buffer_load_dwordx4 v101, s[28:31], s81 offen lds
    v_mfma_f32_16x16x32_bf16 v[28:31], v[52:55], v[92:95], v[28:31]
    v_mfma_f32_16x16x32_bf16 v[32:35], v[56:59], v[92:95], v[32:35]
    s_add_u32 m0, s84, 111616
    s_nop 0
    buffer_load_dwordx4 v103, s[32:35], s82 offen lds
    v_mfma_f32_16x16x32_bf16 v[36:39], v[52:55], v[96:99], v[36:39]
    v_mfma_f32_16x16x32_bf16 v[40:43], v[56:59], v[96:99], v[40:43]
    s_add_u32 m0, s84, 112640
    s_mov_b64 exec, 0xffffffff
    buffer_load_dwordx4 v104, s[32:35], s82 offen lds
    s_mov_b64 exec, -1
    ds_read_b128 v[52:55], v109 offset:0
    ds_read_b128 v[56:59], v109 offset:2048
    s_waitcnt lgkmcnt(10)
    v_mfma_f32_16x16x32_bf16 v[4:7], v[44:47], v[60:63], v[4:7]
    ds_read_b64_tr_b16 v[80:81], v115 offset:5120
    ds_read_b64_tr_b16 v[82:83], v115 offset:6400
    v_mfma_f32_16x16x32_bf16 v[8:11], v[48:51], v[60:63], v[8:11]
    s_lshl_b32 s81, s80, 7
    s_mul_i32 s82, s80, 245760
    s_add_u32 s80, s80, 1
    s_cmp_eq_u32 s80, 10
    s_cselect_b32 s80, 0, s80
    s_add_u32 m0, s83, 0
    s_nop 0
    buffer_load_dwordx4 v100, s[28:31], s81 offen lds
    ds_read_b64_tr_b16 v[84:85], v115 offset:5160
    ds_read_b64_tr_b16 v[86:87], v115 offset:6440
    s_waitcnt lgkmcnt(12)
    v_mfma_f32_16x16x32_bf16 v[12:15], v[44:47], v[64:67], v[12:15]
    ds_read_b64_tr_b16 v[88:89], v119 offset:5120
    ds_read_b64_tr_b16 v[90:91], v119 offset:6400
    v_mfma_f32_16x16x32_bf16 v[16:19], v[48:51], v[64:67], v[16:19]
    s_add_u32 m0, s84, 0
    s_nop 0
    buffer_load_dwordx4 v102, s[32:35], s82 offen lds
    ds_read_b64_tr_b16 v[92:93], v115 offset:15360
    ds_read_b64_tr_b16 v[94:95], v115 offset:16640
    s_waitcnt lgkmcnt(14)
    v_mfma_f32_16x16x32_bf16 v[20:23], v[44:47], v[68:71], v[20:23]
    ds_read_b64_tr_b16 v[96:97], v115 offset:15400
    ds_read_b64_tr_b16 v[98:99], v115 offset:16680
    v_mfma_f32_16x16x32_bf16 v[24:27], v[48:51], v[68:71], v[24:27]
    s_add_u32 m0, s83, 1024
    s_nop 0
    buffer_load_dwordx4 v101, s[28:31], s81 offen lds
    s_waitcnt lgkmcnt(14)
    v_mfma_f32_16x16x32_bf16 v[28:31], v[44:47], v[72:75], v[28:31]
    v_mfma_f32_16x16x32_bf16 v[32:35], v[48:51], v[72:75], v[32:35]
    s_add_u32 m0, s84, 1024
    s_nop 0
    buffer_load_dwordx4 v103, s[32:35], s82 offen lds
    s_waitcnt lgkmcnt(12)
    v_mfma_f32_16x16x32_bf16 v[36:39], v[44:47], v[76:79], v[36:39]
    v_mfma_f32_16x16x32_bf16 v[40:43], v[48:51], v[76:79], v[40:43]
    s_add_u32 m0, s84, 2048
    s_mov_b64 exec, 0xffffffff
    buffer_load_dwordx4 v104, s[32:35], s82 offen lds
    s_mov_b64 exec, -1
    s_waitcnt lgkmcnt(0)
    s_waitcnt vmcnt(10)
    s_barrier
    ds_read_b128 v[44:47], v110 offset:0
    ds_read_b128 v[48:51], v110 offset:2048
    v_mfma_f32_16x16x32_bf16 v[4:7], v[52:55], v[80:83], v[4:7]
    ds_read_b64_tr_b16 v[60:61], v116 offset:0
    ds_read_b64_tr_b16 v[62:63], v116 offset:1280
    v_mfma_f32_16x16x32_bf16 v[8:11], v[56:59], v[80:83], v[8:11]
    s_lshl_b32 s81, s80, 7
    s_mul_i32 s82, s80, 245760
    s_add_u32 s80, s80, 1
    s_cmp_eq_u32 s80, 10
    s_cselect_b32 s80, 0, s80
    s_add_u32 m0, s83, 36864
    s_nop 0
    buffer_load_dwordx4 v100, s[28:31], s81 offen lds
    ds_read_b64_tr_b16 v[64:65], v116 offset:40
    ds_read_b64_tr_b16 v[66:67], v116 offset:1320
    v_mfma_f32_16x16x32_bf16 v[12:15], v[52:55], v[84:87], v[12:15]
    ds_read_b64_tr_b16 v[68:69], v120 offset:0
    ds_read_b64_tr_b16 v[70:71], v120 offset:1280
    v_mfma_f32_16x16x32_bf16 v[16:19], v[56:59], v[84:87], v[16:19]
    s_add_u32 m0, s84, 36864
    s_nop 0
    buffer_load_dwordx4 v102, s[32:35], s82 offen lds
    ds_read_b64_tr_b16 v[72:73], v116 offset:10240
    ds_read_b64_tr_b16 v[74:75], v116 offset:11520
    v_mfma_f32_16x16x32_bf16 v[20:23], v[52:55], v[88:91], v[20:23]
    ds_read_b64_tr_b16 v[76:77], v116 offset:10280
    ds_read_b64_tr_b16 v[78:79], v116 offset:11560
    v_mfma_f32_16x16x32_bf16 v[24:27], v[56:59], v[88:91], v[24:27]
    s_add_u32 m0, s83, 37888
    s_nop 0
    buffer_load_dwordx4 v101, s[28:31], s81 offen lds
    v_mfma_f32_16x16x32_bf16 v[28:31], v[52:55], v[92:95], v[28:31]
    v_mfma_f32_16x16x32_bf16 v[32:35], v[56:59], v[92:95], v[32:35]
    s_add_u32 m0, s84, 37888
    s_nop 0
    buffer_load_dwordx4 v103, s[32:35], s82 offen lds
    v_mfma_f32_16x16x32_bf16 v[36:39], v[52:55], v[96:99], v[36:39]
    v_mfma_f32_16x16x32_bf16 v[40:43], v[56:59], v[96:99], v[40:43]
    s_add_u32 m0, s84, 38912
    s_mov_b64 exec, 0xffffffff
    buffer_load_dwordx4 v104, s[32:35], s82 offen lds
    s_mov_b64 exec, -1
    ds_read_b128 v[52:55], v111 offset:0
    ds_read_b128 v[56:59], v111 offset:2048
    s_waitcnt lgkmcnt(10)
    v_mfma_f32_16x16x32_bf16 v[4:7], v[44:47], v[60:63], v[4:7]
    ds_read_b64_tr_b16 v[80:81], v116 offset:5120
    ds_read_b64_tr_b16 v[82:83], v116 offset:6400
    v_mfma_f32_16x16x32_bf16 v[8:11], v[48:51], v[60:63], v[8:11]
    ds_read_b64_tr_b16 v[84:85], v116 offset:5160
    ds_read_b64_tr_b16 v[86:87], v116 offset:6440
    s_waitcnt lgkmcnt(12)
    v_mfma_f32_16x16x32_bf16 v[12:15], v[44:47], v[64:67], v[12:15]
    ds_read_b64_tr_b16 v[88:89], v120 offset:5120
    ds_read_b64_tr_b16 v[90:91], v120 offset:6400
    v_mfma_f32_16x16x32_bf16 v[16:19], v[48:51], v[64:67], v[16:19]
    ds_read_b64_tr_b16 v[92:93], v116 offset:15360
    ds_read_b64_tr_b16 v[94:95], v116 offset:16640
    s_waitcnt lgkmcnt(14)
    v_mfma_f32_16x16x32_bf16 v[20:23], v[44:47], v[68:71], v[20:23]
    ds_read_b64_tr_b16 v[96:97], v116 offset:15400
    ds_read_b64_tr_b16 v[98:99], v116 offset:16680
    v_mfma_f32_16x16x32_bf16 v[24:27], v[48:51], v[68:71], v[24:27]
    s_waitcnt lgkmcnt(14)
    v_mfma_f32_16x16x32_bf16 v[28:31], v[44:47], v[72:75], v[28:31]
    v_mfma_f32_16x16x32_bf16 v[32:35], v[48:51], v[72:75], v[32:35]
    s_waitcnt lgkmcnt(12)
    v_mfma_f32_16x16x32_bf16 v[36:39], v[44:47], v[76:79], v[36:39]
    v_mfma_f32_16x16x32_bf16 v[40:43], v[48:51], v[76:79], v[40:43]
    s_waitcnt lgkmcnt(0)
    s_waitcnt vmcnt(10)
    s_barrier
    ds_read_b128 v[44:47], v112 offset:0
    ds_read_b128 v[48:51], v112 offset:2048
    v_mfma_f32_16x16x32_bf16 v[4:7], v[52:55], v[80:83], v[4:7]
    ds_read_b64_tr_b16 v[60:61], v117 offset:0
    ds_read_b64_tr_b16 v[62:63], v117 offset:1280
    v_mfma_f32_16x16x32_bf16 v[8:11], v[56:59], v[80:83], v[8:11]
    s_lshl_b32 s81, s80, 7
    s_mul_i32 s82, s80, 245760
    s_add_u32 s80, s80, 1
    s_cmp_eq_u32 s80, 10
    s_cselect_b32 s80, 0, s80
    s_add_u32 m0, s83, 73728
    s_nop 0
    buffer_load_dwordx4 v100, s[28:31], s81 offen lds
    ds_read_b64_tr_b16 v[64:65], v117 offset:40
    ds_read_b64_tr_b16 v[66:67], v117 offset:1320
    v_mfma_f32_16x16x32_bf16 v[12:15], v[52:55], v[84:87], v[12:15]
    ds_read_b64_tr_b16 v[68:69], v121 offset:0
    ds_read_b64_tr_b16 v[70:71], v121 offset:1280
    v_mfma_f32_16x16x32_bf16 v[16:19], v[56:59], v[84:87], v[16:19]
    s_add_u32 m0, s84, 73728
    s_nop 0
    buffer_load_dwordx4 v102, s[32:35], s82 offen lds
    ds_read_b64_tr_b16 v[72:73], v117 offset:10240
    ds_read_b64_tr_b16 v[74:75], v117 offset:11520
    v_mfma_f32_16x16x32_bf16 v[20:23], v[52:55], v[88:91], v[20:23]
    ds_read_b64_tr_b16 v[76:77], v117 offset:10280
    ds_read_b64_tr_b16 v[78:79], v117 offset:11560
    v_mfma_f32_16x16x32_bf16 v[24:27], v[56:59], v[88:91], v[24:27]
    s_add_u32 m0, s83, 74752
    s_nop 0
    buffer_load_dwordx4 v101, s[28:31], s81 offen lds
    v_mfma_f32_16x16x32_bf16 v[28:31], v[52:55], v[92:95], v[28:31]
    v_mfma_f32_16x16x32_bf16 v[32:35], v[56:59], v[92:95], v[32:35]
    s_add_u32 m0, s84, 74752
    s_nop 0
    buffer_load_dwordx4 v103, s[32:35], s82 offen lds
    v_mfma_f32_16x16x32_bf16 v[36:39], v[52:55], v[96:99], v[36:39]
    v_mfma_f32_16x16x32_bf16 v[40:43], v[56:59], v[96:99], v[40:43]
    s_add_u32 m0, s84, 75776
    s_mov_b64 exec, 0xffffffff
    buffer_load_dwordx4 v104, s[32:35], s82 offen lds
    s_mov_b64 exec, -1
    ds_read_b128 v[52:55], v113 offset:0
    ds_read_b128 v[56:59], v113 offset:2048
    s_waitcnt lgkmcnt(10)
    v_mfma_f32_16x16x32_bf16 v[4:7], v[44:47], v[60:63], v[4:7]
    ds_read_b64_tr_b16 v[80:81], v117 offset:5120
    ds_read_b64_tr_b16 v[82:83], v117 offset:6400
    v_mfma_f32_16x16x32_bf16 v[8:11], v[48:51], v[60:63], v[8:11]
    ds_read_b64_tr_b16 v[84:85], v117 offset:5160
    ds_read_b64_tr_b16 v[86:87], v117 offset:6440
    s_waitcnt lgkmcnt(12)
    v_mfma_f32_16x16x32_bf16 v[12:15], v[44:47], v[64:67], v[12:15]
    ds_read_b64_tr_b16 v[88:89], v121 offset:5120
    ds_read_b64_tr_b16 v[90:91], v121 offset:6400
    v_mfma_f32_16x16x32_bf16 v[16:19], v[48:51], v[64:67], v[16:19]
    ds_read_b64_tr_b16 v[92:93], v117 offset:15360
    ds_read_b64_tr_b16 v[94:95], v117 offset:16640
    s_waitcnt lgkmcnt(14)
    v_mfma_f32_16x16x32_bf16 v[20:23], v[44:47], v[68:71], v[20:23]
    ds_read_b64_tr_b16 v[96:97], v117 offset:15400
    ds_read_b64_tr_b16 v[98:99], v117 offset:16680
    v_mfma_f32_16x16x32_bf16 v[24:27], v[48:51], v[68:71], v[24:27]
    s_waitcnt lgkmcnt(14)
    v_mfma_f32_16x16x32_bf16 v[28:31], v[44:47], v[72:75], v[28:31]
    v_mfma_f32_16x16x32_bf16 v[32:35], v[48:51], v[72:75], v[32:35]
    s_waitcnt lgkmcnt(12)
    v_mfma_f32_16x16x32_bf16 v[36:39], v[44:47], v[76:79], v[36:39]
    v_mfma_f32_16x16x32_bf16 v[40:43], v[48:51], v[76:79], v[40:43]
    s_waitcnt lgkmcnt(0)
    s_waitcnt vmcnt(10)
    s_barrier
    ds_read_b128 v[44:47], v106 offset:0
    ds_read_b128 v[48:51], v106 offset:2048
    v_mfma_f32_16x16x32_bf16 v[4:7], v[52:55], v[80:83], v[4:7]
    ds_read_b64_tr_b16 v[60:61], v114 offset:0
    ds_read_b64_tr_b16 v[62:63], v114 offset:1280
    v_mfma_f32_16x16x32_bf16 v[8:11], v[56:59], v[80:83], v[8:11]
    s_lshl_b32 s81, s80, 7
    s_mul_i32 s82, s80, 245760
    s_add_u32 s80, s80, 1
    s_cmp_eq_u32 s80, 10
    s_cselect_b32 s80, 0, s80
    s_add_u32 m0, s83, 110592
    s_nop 0
    buffer_load_dwordx4 v100, s[28:31], s81 offen lds
    ds_read_b64_tr_b16 v[64:65], v114 offset:40
    ds_read_b64_tr_b16 v[66:67], v114 offset:1320
    v_mfma_f32_16x16x32_bf16 v[12:15], v[52:55], v[84:87], v[12:15]
    ds_read_b64_tr_b16 v[68:69], v118 offset:0
    ds_read_b64_tr_b16 v[70:71], v118 offset:1280
    v_mfma_f32_16x16x32_bf16 v[16:19], v[56:59], v[84:87], v[16:19]
    s_add_u32 m0, s84, 110592
    s_nop 0
    buffer_load_dwordx4 v102, s[32:35], s82 offen lds
    ds_read_b64_tr_b16 v[72:73], v114 offset:10240
    ds_read_b64_tr_b16 v[74:75], v114 offset:11520
    v_mfma_f32_16x16x32_bf16 v[20:23], v[52:55], v[88:91], v[20:23]
    ds_read_b64_tr_b16 v[76:77], v114 offset:10280
    ds_read_b64_tr_b16 v[78:79], v114 offset:11560
    v_mfma_f32_16x16x32_bf16 v[24:27], v[56:59], v[88:91], v[24:27]
    s_add_u32 m0, s83, 111616
    s_nop 0
    buffer_load_dwordx4 v101, s[28:31], s81 offen lds
    v_mfma_f32_16x16x32_bf16 v[28:31], v[52:55], v[92:95], v[28:31]
    v_mfma_f32_16x16x32_bf16 v[32:35], v[56:59], v[92:95], v[32:35]
    s_add_u32 m0, s84, 111616
    s_nop 0
    buffer_load_dwordx4 v103, s[32:35], s82 offen lds
    v_mfma_f32_16x16x32_bf16 v[36:39], v[52:55], v[96:99], v[36:39]
    v_mfma_f32_16x16x32_bf16 v[40:43], v[56:59], v[96:99], v[40:43]
    s_add_u32 m0, s84, 112640
    s_mov_b64 exec, 0xffffffff
    buffer_load_dwordx4 v104, s[32:35], s82 offen lds
    s_mov_b64 exec, -1
    ds_read_b128 v[52:55], v107 offset:0
    ds_read_b128 v[56:59], v107 offset:2048
    s_waitcnt lgkmcnt(10)
    v_mfma_f32_16x16x32_bf16 v[4:7], v[44:47], v[60:63], v[4:7]
    ds_read_b64_tr_b16 v[80:81], v114 offset:5120
    ds_read_b64_tr_b16 v[82:83], v114 offset:6400
    v_mfma_f32_16x16x32_bf16 v[8:11], v[48:51], v[60:63], v[8:11]
    ds_read_b64_tr_b16 v[84:85], v114 offset:5160
    ds_read_b64_tr_b16 v[86:87], v114 offset:6440
    s_waitcnt lgkmcnt(12)
    v_mfma_f32_16x16x32_bf16 v[12:15], v[44:47], v[64:67], v[12:15]
    ds_read_b64_tr_b16 v[88:89], v118 offset:5120
    ds_read_b64_tr_b16 v[90:91], v118 offset:6400
    v_mfma_f32_16x16x32_bf16 v[16:19], v[48:51], v[64:67], v[16:19]
    ds_read_b64_tr_b16 v[92:93], v114 offset:15360
    ds_read_b64_tr_b16 v[94:95], v114 offset:16640
    s_waitcnt lgkmcnt(14)
    v_mfma_f32_16x16x32_bf16 v[20:23], v[44:47], v[68:71], v[20:23]
    ds_read_b64_tr_b16 v[96:97], v114 offset:15400
    ds_read_b64_tr_b16 v[98:99], v114 offset:16680
    v_mfma_f32_16x16x32_bf16 v[24:27], v[48:51], v[68:71], v[24:27]
    s_waitcnt lgkmcnt(14)
    v_mfma_f32_16x16x32_bf16 v[28:31], v[44:47], v[72:75], v[28:31]
    v_mfma_f32_16x16x32_bf16 v[32:35], v[48:51], v[72:75], v[32:35]
    s_waitcnt lgkmcnt(12)
    v_mfma_f32_16x16x32_bf16 v[36:39], v[44:47], v[76:79], v[36:39]
    v_mfma_f32_16x16x32_bf16 v[40:43], v[48:51], v[76:79], v[40:43]
    s_waitcnt lgkmcnt(0)
    s_waitcnt vmcnt(10)
    s_barrier
    ds_read_b128 v[44:47], v108 offset:0
    ds_read_b128 v[48:51], v108 offset:2048
    v_mfma_f32_16x16x32_bf16 v[4:7], v[52:55], v[80:83], v[4:7]
    ds_read_b64_tr_b16 v[60:61], v115 offset:0
    ds_read_b64_tr_b16 v[62:63], v115 offset:1280
    v_mfma_f32_16x16x32_bf16 v[8:11], v[56:59], v[80:83], v[8:11]
    s_lshl_b32 s81, s80, 7
    s_mul_i32 s82, s80, 245760
    s_add_u32 s80, s80, 1
    s_cmp_eq_u32 s80, 10
    s_cselect_b32 s80, 0, s80
    s_add_u32 m0, s83, 0
    s_nop 0
    buffer_load_dwordx4 v100, s[28:31], s81 offen lds
    ds_read_b64_tr_b16 v[64:65], v115 offset:40
    ds_read_b64_tr_b16 v[66:67], v115 offset:1320
    v_mfma_f32_16x16x32_bf16 v[12:15], v[52:55], v[84:87], v[12:15]
    ds_read_b64_tr_b16 v[68:69], v119 offset:0
    ds_read_b64_tr_b16 v[70:71], v119 offset:1280
    v_mfma_f32_16x16x32_bf16 v[16:19], v[56:59], v[84:87], v[16:19]
    s_add_u32 m0, s84, 0
    s_nop 0
    buffer_load_dwordx4 v102, s[32:35], s82 offen lds
    ds_read_b64_tr_b16 v[72:73], v115 offset:10240
    ds_read_b64_tr_b16 v[74:75], v115 offset:11520
    v_mfma_f32_16x16x32_bf16 v[20:23], v[52:55], v[88:91], v[20:23]
    ds_read_b64_tr_b16 v[76:77], v115 offset:10280
    ds_read_b64_tr_b16 v[78:79], v115 offset:11560
    v_mfma_f32_16x16x32_bf16 v[24:27], v[56:59], v[88:91], v[24:27]
    s_add_u32 m0, s83, 1024
    s_nop 0
    buffer_load_dwordx4 v101, s[28:31], s81 offen lds
    v_mfma_f32_16x16x32_bf16 v[28:31], v[52:55], v[92:95], v[28:31]
    v_mfma_f32_16x16x32_bf16 v[32:35], v[56:59], v[92:95], v[32:35]
    s_add_u32 m0, s84, 1024
    s_nop 0
    buffer_load_dwordx4 v103, s[32:35], s82 offen lds
    v_mfma_f32_16x16x32_bf16 v[36:39], v[52:55], v[96:99], v[36:39]
    v_mfma_f32_16x16x32_bf16 v[40:43], v[56:59], v[96:99], v[40:43]
    s_add_u32 m0, s84, 2048
    s_mov_b64 exec, 0xffffffff
    buffer_load_dwordx4 v104, s[32:35], s82 offen lds
    s_mov_b64 exec, -1
    ds_read_b128 v[52:55], v109 offset:0
    ds_read_b128 v[56:59], v109 offset:2048
    s_waitcnt lgkmcnt(10)
    v_mfma_f32_16x16x32_bf16 v[4:7], v[44:47], v[60:63], v[4:7]
    ds_read_b64_tr_b16 v[80:81], v115 offset:5120
    ds_read_b64_tr_b16 v[82:83], v115 offset:6400
    v_mfma_f32_16x16x32_bf16 v[8:11], v[48:51], v[60:63], v[8:11]
    ds_read_b64_tr_b16 v[84:85], v115 offset:5160
    ds_read_b64_tr_b16 v[86:87], v115 offset:6440
    s_waitcnt lgkmcnt(12)
    v_mfma_f32_16x16x32_bf16 v[12:15], v[44:47], v[64:67], v[12:15]
    ds_read_b64_tr_b16 v[88:89], v119 offset:5120
    ds_read_b64_tr_b16 v[90:91], v119 offset:6400
    v_mfma_f32_16x16x32_bf16 v[16:19], v[48:51], v[64:67], v[16:19]
    ds_read_b64_tr_b16 v[92:93], v115 offset:15360
    ds_read_b64_tr_b16 v[94:95], v115 offset:16640
    s_waitcnt lgkmcnt(14)
    v_mfma_f32_16x16x32_bf16 v[20:23], v[44:47], v[68:71], v[20:23]
    ds_read_b64_tr_b16 v[96:97], v115 offset:15400
    ds_read_b64_tr_b16 v[98:99], v115 offset:16680
    v_mfma_f32_16x16x32_bf16 v[24:27], v[48:51], v[68:71], v[24:27]
    s_waitcnt lgkmcnt(14)
    v_mfma_f32_16x16x32_bf16 v[28:31], v[44:47], v[72:75], v[28:31]
    v_mfma_f32_16x16x32_bf16 v[32:35], v[48:51], v[72:75], v[32:35]
    s_waitcnt lgkmcnt(12)
    v_mfma_f32_16x16x32_bf16 v[36:39], v[44:47], v[76:79], v[36:39]
    v_mfma_f32_16x16x32_bf16 v[40:43], v[48:51], v[76:79], v[40:43]
    s_waitcnt lgkmcnt(0)
    s_waitcnt vmcnt(10)
    s_barrier
    ds_read_b128 v[44:47], v110 offset:0
    ds_read_b128 v[48:51], v110 offset:2048
    v_mfma_f32_16x16x32_bf16 v[4:7], v[52:55], v[80:83], v[4:7]
    ds_read_b64_tr_b16 v[60:61], v116 offset:0
    ds_read_b64_tr_b16 v[62:63], v116 offset:1280
    v_mfma_f32_16x16x32_bf16 v[8:11], v[56:59], v[80:83], v[8:11]
    s_lshl_b32 s81, s80, 7
    s_mul_i32 s82, s80, 245760
    s_add_u32 s80, s80, 1
    s_cmp_eq_u32 s80, 10
    s_cselect_b32 s80, 0, s80
    s_add_u32 m0, s83, 36864
    s_nop 0
    buffer_load_dwordx4 v100, s[28:31], s81 offen lds
    ds_read_b64_tr_b16 v[64:65], v116 offset:40
    ds_read_b64_tr_b16 v[66:67], v116 offset:1320
    v_mfma_f32_16x16x32_bf16 v[12:15], v[52:55], v[84:87], v[12:15]
    ds_read_b64_tr_b16 v[68:69], v120 offset:0
    ds_read_b64_tr_b16 v[70:71], v120 offset:1280
    v_mfma_f32_16x16x32_bf16 v[16:19], v[56:59], v[84:87], v[16:19]
    s_add_u32 m0, s84, 36864
    s_nop 0
    buffer_load_dwordx4 v102, s[32:35], s82 offen lds
    ds_read_b64_tr_b16 v[72:73], v116 offset:10240
    ds_read_b64_tr_b16 v[74:75], v116 offset:11520
    v_mfma_f32_16x16x32_bf16 v[20:23], v[52:55], v[88:91], v[20:23]
    ds_read_b64_tr_b16 v[76:77], v116 offset:10280
    ds_read_b64_tr_b16 v[78:79], v116 offset:11560
    v_mfma_f32_16x16x32_bf16 v[24:27], v[56:59], v[88:91], v[24:27]
    s_add_u32 m0, s83, 37888
    s_nop 0
    buffer_load_dwordx4 v101, s[28:31], s81 offen lds
    v_mfma_f32_16x16x32_bf16 v[28:31], v[52:55], v[92:95], v[28:31]
    v_mfma_f32_16x16x32_bf16 v[32:35], v[56:59], v[92:95], v[32:35]
    s_add_u32 m0, s84, 37888
    s_nop 0
    buffer_load_dwordx4 v103, s[32:35], s82 offen lds
    v_mfma_f32_16x16x32_bf16 v[36:39], v[52:55], v[96:99], v[36:39]
    v_mfma_f32_16x16x32_bf16 v[40:43], v[56:59], v[96:99], v[40:43]
    s_add_u32 m0, s84, 38912
    s_mov_b64 exec, 0xffffffff
    buffer_load_dwordx4 v104, s[32:35], s82 offen lds
    s_mov_b64 exec, -1
    ds_read_b128 v[52:55], v111 offset:0
    ds_read_b128 v[56:59], v111 offset:2048
    s_waitcnt lgkmcnt(10)
    v_mfma_f32_16x16x32_bf16 v[4:7], v[44:47], v[60:63], v[4:7]
    ds_read_b64_tr_b16 v[80:81], v116 offset:5120
    ds_read_b64_tr_b16 v[82:83], v116 offset:6400
    v_mfma_f32_16x16x32_bf16 v[8:11], v[48:51], v[60:63], v[8:11]
    ds_read_b64_tr_b16 v[84:85], v116 offset:5160
    ds_read_b64_tr_b16 v[86:87], v116 offset:6440
    s_waitcnt lgkmcnt(12)
    v_mfma_f32_16x16x32_bf16 v[12:15], v[44:47], v[64:67], v[12:15]
    ds_read_b64_tr_b16 v[88:89], v120 offset:5120
    ds_read_b64_tr_b16 v[90:91], v120 offset:6400
    v_mfma_f32_16x16x32_bf16 v[16:19], v[48:51], v[64:67], v[16:19]
    ds_read_b64_tr_b16 v[92:93], v116 offset:15360
    ds_read_b64_tr_b16 v[94:95], v116 offset:16640
    s_waitcnt lgkmcnt(14)
    v_mfma_f32_16x16x32_bf16 v[20:23], v[44:47], v[68:71], v[20:23]
    ds_read_b64_tr_b16 v[96:97], v116 offset:15400
    ds_read_b64_tr_b16 v[98:99], v116 offset:16680
    v_mfma_f32_16x16x32_bf16 v[24:27], v[48:51], v[68:71], v[24:27]
    s_waitcnt lgkmcnt(14)
    v_mfma_f32_16x16x32_bf16 v[28:31], v[44:47], v[72:75], v[28:31]
    v_mfma_f32_16x16x32_bf16 v[32:35], v[48:51], v[72:75], v[32:35]
    s_waitcnt lgkmcnt(12)
    v_mfma_f32_16x16x32_bf16 v[36:39], v[44:47], v[76:79], v[36:39]
    v_mfma_f32_16x16x32_bf16 v[40:43], v[48:51], v[76:79], v[40:43]
    s_waitcnt lgkmcnt(0)
    s_waitcnt vmcnt(10)
    s_barrier
    v_and_b32 v135, 7, v0
    v_lshlrev_b32 v135, 2, v135
    buffer_load_dword v136, v135, s[40:43], 0 offen offset:128 sc1
    ds_read_b128 v[44:47], v112 offset:0
    ds_read_b128 v[48:51], v112 offset:2048
    v_mfma_f32_16x16x32_bf16 v[4:7], v[52:55], v[80:83], v[4:7]
    ds_read_b64_tr_b16 v[60:61], v117 offset:0
    ds_read_b64_tr_b16 v[62:63], v117 offset:1280
    v_mfma_f32_16x16x32_bf16 v[8:11], v[56:59], v[80:83], v[8:11]
    ds_read_b64_tr_b16 v[64:65], v117 offset:40
    ds_read_b64_tr_b16 v[66:67], v117 offset:1320
    v_mfma_f32_16x16x32_bf16 v[12:15], v[52:55], v[84:87], v[12:15]
    ds_read_b64_tr_b16 v[68:69], v121 offset:0
    ds_read_b64_tr_b16 v[70:71], v121 offset:1280
    v_mfma_f32_16x16x32_bf16 v[16:19], v[56:59], v[84:87], v[16:19]
    ds_read_b64_tr_b16 v[72:73], v117 offset:10240
    ds_read_b64_tr_b16 v[74:75], v117 offset:11520
    v_mfma_f32_16x16x32_bf16 v[20:23], v[52:55], v[88:91], v[20:23]
    ds_read_b64_tr_b16 v[76:77], v117 offset:10280
    ds_read_b64_tr_b16 v[78:79], v117 offset:11560
    v_mfma_f32_16x16x32_bf16 v[24:27], v[56:59], v[88:91], v[24:27]
    v_mfma_f32_16x16x32_bf16 v[28:31], v[52:55], v[92:95], v[28:31]
    v_mfma_f32_16x16x32_bf16 v[32:35], v[56:59], v[92:95], v[32:35]
    v_mfma_f32_16x16x32_bf16 v[36:39], v[52:55], v[96:99], v[36:39]
    v_mfma_f32_16x16x32_bf16 v[40:43], v[56:59], v[96:99], v[40:43]
    ds_read_b128 v[52:55], v113 offset:0
    ds_read_b128 v[56:59], v113 offset:2048
    s_waitcnt lgkmcnt(10)
    v_mfma_f32_16x16x32_bf16 v[4:7], v[44:47], v[60:63], v[4:7]
    ds_read_b64_tr_b16 v[80:81], v117 offset:5120
    ds_read_b64_tr_b16 v[82:83], v117 offset:6400
    v_mfma_f32_16x16x32_bf16 v[8:11], v[48:51], v[60:63], v[8:11]
    ds_read_b64_tr_b16 v[84:85], v117 offset:5160
    ds_read_b64_tr_b16 v[86:87], v117 offset:6440
    s_waitcnt lgkmcnt(12)
    v_mfma_f32_16x16x32_bf16 v[12:15], v[44:47], v[64:67], v[12:15]
    ds_read_b64_tr_b16 v[88:89], v121 offset:5120
    ds_read_b64_tr_b16 v[90:91], v121 offset:6400
    v_mfma_f32_16x16x32_bf16 v[16:19], v[48:51], v[64:67], v[16:19]
    ds_read_b64_tr_b16 v[92:93], v117 offset:15360
    ds_read_b64_tr_b16 v[94:95], v117 offset:16640
    s_waitcnt lgkmcnt(14)
    v_mfma_f32_16x16x32_bf16 v[20:23], v[44:47], v[68:71], v[20:23]
    ds_read_b64_tr_b16 v[96:97], v117 offset:15400
    ds_read_b64_tr_b16 v[98:99], v117 offset:16680
    v_mfma_f32_16x16x32_bf16 v[24:27], v[48:51], v[68:71], v[24:27]
    s_waitcnt lgkmcnt(14)
    v_mfma_f32_16x16x32_bf16 v[28:31], v[44:47], v[72:75], v[28:31]
    v_mfma_f32_16x16x32_bf16 v[32:35], v[48:51], v[72:75], v[32:35]
    s_waitcnt lgkmcnt(12)
    v_mfma_f32_16x16x32_bf16 v[36:39], v[44:47], v[76:79], v[36:39]
    v_mfma_f32_16x16x32_bf16 v[40:43], v[48:51], v[76:79], v[40:43]
    s_waitcnt lgkmcnt(0)
    s_waitcnt vmcnt(6)
    s_barrier
    ds_read_b128 v[44:47], v106 offset:0
    ds_read_b128 v[48:51], v106 offset:2048
    v_mfma_f32_16x16x32_bf16 v[4:7], v[52:55], v[80:83], v[4:7]
    ds_read_b64_tr_b16 v[60:61], v114 offset:0
    ds_read_b64_tr_b16 v[62:63], v114 offset:1280
    v_mfma_f32_16x16x32_bf16 v[8:11], v[56:59], v[80:83], v[8:11]
    ds_read_b64_tr_b16 v[64:65], v114 offset:40
    ds_read_b64_tr_b16 v[66:67], v114 offset:1320
    v_mfma_f32_16x16x32_bf16 v[12:15], v[52:55], v[84:87], v[12:15]
    ds_read_b64_tr_b16 v[68:69], v118 offset:0
    ds_read_b64_tr_b16 v[70:71], v118 offset:1280
    v_mfma_f32_16x16x32_bf16 v[16:19], v[56:59], v[84:87], v[16:19]
    ds_read_b64_tr_b16 v[72:73], v114 offset:10240
    ds_read_b64_tr_b16 v[74:75], v114 offset:11520
    v_mfma_f32_16x16x32_bf16 v[20:23], v[52:55], v[88:91], v[20:23]
    ds_read_b64_tr_b16 v[76:77], v114 offset:10280
    ds_read_b64_tr_b16 v[78:79], v114 offset:11560
    v_mfma_f32_16x16x32_bf16 v[24:27], v[56:59], v[88:91], v[24:27]
    v_mfma_f32_16x16x32_bf16 v[28:31], v[52:55], v[92:95], v[28:31]
    v_mfma_f32_16x16x32_bf16 v[32:35], v[56:59], v[92:95], v[32:35]
    v_mfma_f32_16x16x32_bf16 v[36:39], v[52:55], v[96:99], v[36:39]
    v_mfma_f32_16x16x32_bf16 v[40:43], v[56:59], v[96:99], v[40:43]
    ds_read_b128 v[52:55], v107 offset:0
    ds_read_b128 v[56:59], v107 offset:2048
    s_waitcnt lgkmcnt(10)
    v_mfma_f32_16x16x32_bf16 v[4:7], v[44:47], v[60:63], v[4:7]
    ds_read_b64_tr_b16 v[80:81], v114 offset:5120
    ds_read_b64_tr_b16 v[82:83], v114 offset:6400
    v_mfma_f32_16x16x32_bf16 v[8:11], v[48:51], v[60:63], v[8:11]
    ds_read_b64_tr_b16 v[84:85], v114 offset:5160
    ds_read_b64_tr_b16 v[86:87], v114 offset:6440
    s_waitcnt lgkmcnt(12)
    v_mfma_f32_16x16x32_bf16 v[12:15], v[44:47], v[64:67], v[12:15]
    ds_read_b64_tr_b16 v[88:89], v118 offset:5120
    ds_read_b64_tr_b16 v[90:91], v118 offset:6400
    v_mfma_f32_16x16x32_bf16 v[16:19], v[48:51], v[64:67], v[16:19]
    ds_read_b64_tr_b16 v[92:93], v114 offset:15360
    ds_read_b64_tr_b16 v[94:95], v114 offset:16640
    s_waitcnt lgkmcnt(14)
    v_mfma_f32_16x16x32_bf16 v[20:23], v[44:47], v[68:71], v[20:23]
    ds_read_b64_tr_b16 v[96:97], v114 offset:15400
    ds_read_b64_tr_b16 v[98:99], v114 offset:16680
    v_mfma_f32_16x16x32_bf16 v[24:27], v[48:51], v[68:71], v[24:27]
    s_waitcnt lgkmcnt(14)
    v_mfma_f32_16x16x32_bf16 v[28:31], v[44:47], v[72:75], v[28:31]
    v_mfma_f32_16x16x32_bf16 v[32:35], v[48:51], v[72:75], v[32:35]
    s_waitcnt lgkmcnt(12)
    v_mfma_f32_16x16x32_bf16 v[36:39], v[44:47], v[76:79], v[36:39]
    v_mfma_f32_16x16x32_bf16 v[40:43], v[48:51], v[76:79], v[40:43]
    s_waitcnt lgkmcnt(0)
    s_waitcnt vmcnt(1)
    s_barrier
    v_and_b32 v127, 3, v0
    v_mul_u32_u24 v127, 0x2820, v127
    v_add_u32 v126, 0x14800, v127
    v_mov_b32 v142, 0x3f803f80
    v_mov_b32 v143, 0x3f803f80
    v_mov_b32 v144, 0
    v_mov_b32 v145, 0
    ds_write2_b64 v126, v[142:143], v[142:143] offset0:0 offset1:1
    ds_write2_b64 v126, v[144:145], v[144:145] offset0:2 offset1:3
    ds_read_b128 v[44:47], v108 offset:0
    ds_read_b128 v[48:51], v108 offset:2048
    v_mfma_f32_16x16x32_bf16 v[4:7], v[52:55], v[80:83], v[4:7]
    ds_read_b64_tr_b16 v[60:61], v115 offset:0
    ds_read_b64_tr_b16 v[62:63], v115 offset:1280
    v_mfma_f32_16x16x32_bf16 v[8:11], v[56:59], v[80:83], v[8:11]
    ds_read_b64_tr_b16 v[64:65], v115 offset:40
    ds_read_b64_tr_b16 v[66:67], v115 offset:1320
    v_mfma_f32_16x16x32_bf16 v[12:15], v[52:55], v[84:87], v[12:15]
    ds_read_b64_tr_b16 v[68:69], v119 offset:0
    ds_read_b64_tr_b16 v[70:71], v119 offset:1280
    v_mfma_f32_16x16x32_bf16 v[16:19], v[56:59], v[84:87], v[16:19]
    ds_read_b64_tr_b16 v[72:73], v115 offset:10240
    ds_read_b64_tr_b16 v[74:75], v115 offset:11520
    v_mfma_f32_16x16x32_bf16 v[20:23], v[52:55], v[88:91], v[20:23]
    ds_read_b64_tr_b16 v[76:77], v115 offset:10280
    ds_read_b64_tr_b16 v[78:79], v115 offset:11560
    v_mfma_f32_16x16x32_bf16 v[24:27], v[56:59], v[88:91], v[24:27]
    v_mfma_f32_16x16x32_bf16 v[28:31], v[52:55], v[92:95], v[28:31]
    v_mfma_f32_16x16x32_bf16 v[32:35], v[56:59], v[92:95], v[32:35]
    v_mfma_f32_16x16x32_bf16 v[36:39], v[52:55], v[96:99], v[36:39]
    v_mfma_f32_16x16x32_bf16 v[40:43], v[56:59], v[96:99], v[40:43]
    ds_read_b128 v[52:55], v109 offset:0
    ds_read_b128 v[56:59], v109 offset:2048
    s_waitcnt lgkmcnt(10)
    v_mfma_f32_16x16x32_bf16 v[4:7], v[44:47], v[60:63], v[4:7]
    ds_read_b64_tr_b16 v[80:81], v115 offset:5120
    ds_read_b64_tr_b16 v[82:83], v115 offset:6400
    v_mfma_f32_16x16x32_bf16 v[8:11], v[48:51], v[60:63], v[8:11]
    ds_read_b64_tr_b16 v[84:85], v115 offset:5160
    ds_read_b64_tr_b16 v[86:87], v115 offset:6440
    s_waitcnt lgkmcnt(12)
    v_mfma_f32_16x16x32_bf16 v[12:15], v[44:47], v[64:67], v[12:15]
    ds_read_b64_tr_b16 v[88:89], v119 offset:5120
    ds_read_b64_tr_b16 v[90:91], v119 offset:6400
    v_mfma_f32_16x16x32_bf16 v[16:19], v[48:51], v[64:67], v[16:19]
    ds_read_b64_tr_b16 v[92:93], v115 offset:15360
    ds_read_b64_tr_b16 v[94:95], v115 offset:16640
    s_waitcnt lgkmcnt(14)
    v_mfma_f32_16x16x32_bf16 v[20:23], v[44:47], v[68:71], v[20:23]
    ds_read_b64_tr_b16 v[96:97], v115 offset:15400
    ds_read_b64_tr_b16 v[98:99], v115 offset:16680
    v_mfma_f32_16x16x32_bf16 v[24:27], v[48:51], v[68:71], v[24:27]
    s_waitcnt lgkmcnt(14)
    v_mfma_f32_16x16x32_bf16 v[28:31], v[44:47], v[72:75], v[28:31]
    v_mfma_f32_16x16x32_bf16 v[32:35], v[48:51], v[72:75], v[32:35]
    s_waitcnt lgkmcnt(12)
    v_mfma_f32_16x16x32_bf16 v[36:39], v[44:47], v[76:79], v[36:39]
    v_mfma_f32_16x16x32_bf16 v[40:43], v[48:51], v[76:79], v[40:43]
    s_waitcnt lgkmcnt(8)
    v_mfma_f32_16x16x32_bf16 v[4:7], v[52:55], v[80:83], v[4:7]
    v_mfma_f32_16x16x32_bf16 v[8:11], v[56:59], v[80:83], v[8:11]
    s_waitcnt lgkmcnt(6)
    v_mfma_f32_16x16x32_bf16 v[12:15], v[52:55], v[84:87], v[12:15]
    v_mfma_f32_16x16x32_bf16 v[16:19], v[56:59], v[84:87], v[16:19]
    s_waitcnt lgkmcnt(4)
    v_mfma_f32_16x16x32_bf16 v[20:23], v[52:55], v[88:91], v[20:23]
    v_mfma_f32_16x16x32_bf16 v[24:27], v[56:59], v[88:91], v[24:27]
    s_waitcnt lgkmcnt(2)
    v_mfma_f32_16x16x32_bf16 v[28:31], v[52:55], v[92:95], v[28:31]
    v_mfma_f32_16x16x32_bf16 v[32:35], v[56:59], v[92:95], v[32:35]
    s_waitcnt lgkmcnt(0)
    v_mfma_f32_16x16x32_bf16 v[36:39], v[52:55], v[96:99], v[36:39]
    v_mfma_f32_16x16x32_bf16 v[40:43], v[56:59], v[96:99], v[40:43]
    s_waitcnt vmcnt(0)
    v_cmp_ne_u32 vcc, 1, v136
    s_cmp_eq_u64 vcc, 0
    s_cbranch_scc1 L5
    s_mov_b32 s89, 0x8000
L6:
    s_sub_u32 s89, s89, 1
    s_cbranch_scc1 L5
    s_sleep 2
    buffer_load_dword v136, v135, s[40:43], 0 offen offset:128 sc1
    s_waitcnt vmcnt(0)
    v_cmp_ne_u32 vcc, 1, v136
    s_cmp_eq_u64 vcc, 0
    s_cbranch_scc0 L6
L5:
    s_and_b32 s101, s2, 15
    s_lshl_b32 s101, s101, 9
    s_add_u32 s101, s101, 0xc34000
    v_and_b32 v147, 7, v0
    v_lshlrev_b32 v147, 6, v147
    buffer_load_dword v146, v147, s[36:39], s101 offen sc1
    v_cvt_pk_bf16_f32 v92, v28, v29
    v_cvt_pk_bf16_f32 v93, v30, v31
    v_cvt_pk_bf16_f32 v94, v32, v33
    v_cvt_pk_bf16_f32 v95, v34, v35
    ds_write_b128 v128, v[92:95] offset:5120
    v_cvt_pk_bf16_f32 v96, v36, v37
    v_cvt_pk_bf16_f32 v97, v38, v39
    v_cvt_pk_bf16_f32 v98, v40, v41
    v_cvt_pk_bf16_f32 v99, v42, v43
    ds_write_b128 v128, v[96:99] offset:6144
    v_mul_f32 v60, s85, v4
    v_mul_f32 v61, s85, v5
    v_mul_f32 v62, s85, v6
    v_mul_f32 v63, s85, v7
    v_mul_f32 v64, s85, v8
    v_mul_f32 v65, s85, v9
    v_mul_f32 v66, s85, v10
    v_mul_f32 v67, s85, v11
    v_exp_f32_e64 v60, v60 clamp
    v_exp_f32_e64 v61, v61 clamp
    v_exp_f32_e64 v62, v62 clamp
    v_exp_f32_e64 v63, v63 clamp
    v_exp_f32_e64 v64, v64 clamp
    v_exp_f32_e64 v65, v65 clamp
    v_exp_f32_e64 v66, v66 clamp
    v_exp_f32_e64 v67, v67 clamp
    v_max_f32 v4, s86, v4
    v_max_f32 v5, s86, v5
    v_max_f32 v6, s86, v6
    v_max_f32 v7, s86, v7
    v_max_f32 v8, s86, v8
    v_max_f32 v9, s86, v9
    v_max_f32 v10, s86, v10
    v_max_f32 v11, s86, v11
    v_add_f32 v4, v4, v60
    v_add_f32 v5, v5, v61
    v_add_f32 v6, v6, v62
    v_add_f32 v7, v7, v63
    v_add_f32 v8, v8, v64
    v_add_f32 v9, v9, v65
    v_add_f32 v10, v10, v66
    v_add_f32 v11, v11, v67
    v_cvt_pk_bf16_f32 v80, v4, v5
    v_cvt_pk_bf16_f32 v81, v6, v7
    v_cvt_pk_bf16_f32 v82, v8, v9
    v_cvt_pk_bf16_f32 v83, v10, v11
    ds_write_b128 v128, v[80:83] offset:0
    v_mul_f32 v60, s85, v12
    v_mul_f32 v61, s85, v13
    v_mul_f32 v62, s85, v14
    v_mul_f32 v63, s85, v15
    v_mul_f32 v64, s85, v16
    v_mul_f32 v65, s85, v17
    v_mul_f32 v66, s85, v18
    v_mul_f32 v67, s85, v19
    v_exp_f32_e64 v60, v60 clamp
    v_exp_f32_e64 v61, v61 clamp
    v_exp_f32_e64 v62, v62 clamp
    v_exp_f32_e64 v63, v63 clamp
    v_exp_f32_e64 v64, v64 clamp
    v_exp_f32_e64 v65, v65 clamp
    v_exp_f32_e64 v66, v66 clamp
    v_exp_f32_e64 v67, v67 clamp
    v_max_f32 v12, s86, v12
    v_max_f32 v13, s86, v13
    v_max_f32 v14, s86, v14
    v_max_f32 v15, s86, v15
    v_max_f32 v16, s86, v16
    v_max_f32 v17, s86, v17
    v_max_f32 v18, s86, v18
    v_max_f32 v19, s86, v19
    v_add_f32 v12, v12, v60
    v_add_f32 v13, v13, v61
    v_add_f32 v14, v14, v62
    v_add_f32 v15, v15, v63
    v_add_f32 v16, v16, v64
    v_add_f32 v17, v17, v65
    v_add_f32 v18, v18, v66
    v_add_f32 v19, v19, v67
    v_cvt_pk_bf16_f32 v84, v12, v13
    v_cvt_pk_bf16_f32 v85, v14, v15
    v_cvt_pk_bf16_f32 v86, v16, v17
    v_cvt_pk_bf16_f32 v87, v18, v19
    ds_write_b128 v128, v[84:87] offset:1024
    s_cmp_ge_u32 s3, 4
    s_cbranch_scc1 L7
    v_mul_f32 v60, s85, v20
    v_mul_f32 v61, s85, v21
    v_mul_f32 v62, s85, v22
    v_mul_f32 v63, s85, v23
    v_mul_f32 v64, s85, v24
    v_mul_f32 v65, s85, v25
    v_mul_f32 v66, s85, v26
    v_mul_f32 v67, s85, v27
    v_exp_f32_e64 v60, v60 clamp
    v_exp_f32_e64 v61, v61 clamp
    v_exp_f32_e64 v62, v62 clamp
    v_exp_f32_e64 v63, v63 clamp
    v_exp_f32_e64 v64, v64 clamp
    v_exp_f32_e64 v65, v65 clamp
    v_exp_f32_e64 v66, v66 clamp
    v_exp_f32_e64 v67, v67 clamp
    v_max_f32 v20, s86, v20
    v_max_f32 v21, s86, v21
    v_max_f32 v22, s86, v22
    v_max_f32 v23, s86, v23
    v_max_f32 v24, s86, v24
    v_max_f32 v25, s86, v25
    v_max_f32 v26, s86, v26
    v_max_f32 v27, s86, v27
    v_add_f32 v20, v20, v60
    v_add_f32 v21, v21, v61
    v_add_f32 v22, v22, v62
    v_add_f32 v23, v23, v63
    v_add_f32 v24, v24, v64
    v_add_f32 v25, v25, v65
    v_add_f32 v26, v26, v66
    v_add_f32 v27, v27, v67
    s_nop 1
L7:
    v_cvt_pk_bf16_f32 v88, v20, v21
    v_cvt_pk_bf16_f32 v89, v22, v23
    v_cvt_pk_bf16_f32 v90, v24, v25
    v_cvt_pk_bf16_f32 v91, v26, v27
    ds_write_b128 v129, v[88:91]
    s_waitcnt lgkmcnt(0)
    s_barrier
    ds_read_b128 v[4:7], v130 offset:0
    ds_read_b128 v[8:11], v131 offset:0
    ds_read_b128 v[12:15], v132 offset:0
    ds_read_b128 v[16:19], v133 offset:0
    ds_read_b128 v[20:23], v130 offset:10272
    ds_read_b128 v[24:27], v131 offset:10272
    ds_read_b128 v[28:31], v132 offset:10272
    ds_read_b128 v[32:35], v133 offset:10272
    ds_read_b128 v[36:39], v130 offset:20544
    ds_read_b128 v[40:43], v131 offset:20544
    ds_read_b128 v[44:47], v132 offset:20544
    ds_read_b128 v[48:51], v133 offset:20544
    ds_read_b128 v[52:55], v130 offset:30816
    ds_read_b128 v[56:59], v131 offset:30816
    ds_read_b128 v[60:63], v132 offset:30816
    ds_read_b128 v[64:67], v133 offset:30816
    s_waitcnt lgkmcnt(14)
    v_mfma_f32_16x16x32_bf16 v[68:71], v[4:7], v[8:11], 0
    s_waitcnt lgkmcnt(12)
    v_mfma_f32_16x16x32_bf16 v[72:75], v[12:15], v[16:19], 0
    s_waitcnt lgkmcnt(10)
    v_mfma_f32_16x16x32_bf16 v[68:71], v[20:23], v[24:27], v[68:71]
    s_waitcnt lgkmcnt(8)
    v_mfma_f32_16x16x32_bf16 v[72:75], v[28:31], v[32:35], v[72:75]
    s_waitcnt lgkmcnt(6)
    v_mfma_f32_16x16x32_bf16 v[68:71], v[36:39], v[40:43], v[68:71]
    s_waitcnt lgkmcnt(4)
    v_mfma_f32_16x16x32_bf16 v[72:75], v[44:47], v[48:51], v[72:75]
    s_waitcnt lgkmcnt(2)
    v_mfma_f32_16x16x32_bf16 v[68:71], v[52:55], v[56:59], v[68:71]
    s_waitcnt lgkmcnt(0)
    v_mfma_f32_16x16x32_bf16 v[72:75], v[60:63], v[64:67], v[72:75]
    v_mov_b32 v147, 0
    ds_write_b32 v147, v147 offset:0
    ds_write_b32 v147, v147 offset:4
    ds_write_b32 v147, v147 offset:8
    ds_write_b32 v147, v147 offset:12
    ds_write_b32 v147, v147 offset:16
    s_waitcnt vmcnt(0)
    v_cmp_ne_u32 vcc, 8, v146
    s_cmp_eq_u64 vcc, 0
    s_cselect_b32 s101, 64, 0
    s_mul_i32 s79, s5, 0x1e00
    s_add_u32 s88, s79, 0x8a0000
    s_cmp_ge_u32 s3, 4
    s_cbranch_scc1 L8
    s_lshl_b32 s79, s3, 10
    s_add_u32 s89, s79, s88
    s_lshl_b32 s79, s3, 8
    s_add_u32 s79, s79, s88
    s_add_u32 s90, s79, 0x1800
    buffer_atomic_add_f32 v68, v134, s[36:39], s89 offen offset:0 sc0 sc1
    buffer_atomic_add_f32 v69, v134, s[36:39], s89 offen offset:256 sc0 sc1
    buffer_atomic_add_f32 v70, v134, s[36:39], s89 offen offset:512 sc0 sc1
    buffer_atomic_add_f32 v71, v134, s[36:39], s89 offen offset:768 sc0 sc1
    buffer_atomic_add_f32 v72, v134, s[36:39], s90 offen sc0 sc1
    s_branch L10
L8:
    v_add_f32 v68, v68, v72
    v_add_f32 v69, v69, v73
    v_add_f32 v70, v70, v74
    v_add_f32 v71, v71, v75
    s_cmp_ge_u32 s3, 6
    s_cbranch_scc1 L9
    s_and_b32 s79, s3, 1
    s_lshl_b32 s79, s79, 10
    s_add_u32 s79, s79, s88
    s_add_u32 s89, s79, 0x1000
    buffer_atomic_add_f32 v68, v134, s[36:39], s89 offen offset:0 sc0 sc1
    buffer_atomic_add_f32 v69, v134, s[36:39], s89 offen offset:256 sc0 sc1
    buffer_atomic_add_f32 v70, v134, s[36:39], s89 offen offset:512 sc0 sc1
    buffer_atomic_add_f32 v71, v134, s[36:39], s89 offen offset:768 sc0 sc1
    s_branch L10
L9:
    s_and_b32 s79, s3, 1
    s_lshl_b32 s79, s79, 8
    s_add_u32 s79, s79, s88
    s_add_u32 s89, s79, 0x1c00
    buffer_atomic_add_f32 v68, v134, s[36:39], s89 offen sc0 sc1
L10:
    s_lshl_b32 s79, s5, 10
    s_and_b32 s78, s5, 1
    s_mul_i32 s78, s78, 0x3c0
    s_sub_u32 s78, s79, s78
    s_add_u32 s89, s78, 0xc32000
    s_waitcnt vmcnt(0) lgkmcnt(0)
    s_barrier
    s_cmp_lg_u32 s3, 7
    s_cbranch_scc1 L11
    v_mov_b32 v123, 1
    v_lshlrev_b32 v122, 7, v0
    s_mov_b64 exec, 0xffff
    buffer_atomic_add v123, v122, s[36:39], s89 offen sc1
    s_mov_b64 exec, -1
L11:
    s_and_b32 s79, s2, 7
    s_lshl_b32 s79, s79, 2
    s_lshr_b32 s78, s2, 3
    s_and_b32 s78, s78, 3
    s_add_u32 s4, s79, s78
    s_lshr_b32 s5, s2, 5
    s_mov_b32 s100, 0
    s_cmp_lt_u32 s3, 4
    s_cbranch_scc1 FINAL_A
    s_branch FINAL_D
K1_Q:
    s_lshr_b32 s79, s2, 2
    s_and_b32 s79, s79, 1
    s_lshl_b32 s79, s79, 1
    s_lshr_b32 s78, s2, 5
    s_and_b32 s78, s78, 1
    s_add_u32 s91, s79, s78
    v_and_b32 v127, 7, v0
    v_lshrrev_b32 v126, 4, v0
    v_xor_b32 v126, v127, v126
    v_lshrrev_b32 v127, 3, v0
    v_mul_u32_u24 v127, 0x14000, v127
    v_lshl_add_u32 v127, v126, 4, v127
    s_and_b32 s79, s3, 1
    s_lshl_b32 s79, s79, 10
    s_lshl_b32 s78, s4, 2
    s_add_u32 s78, s79, s78
    s_lshr_b32 s79, s3, 1
    s_add_u32 s79, s78, s79
    s_mul_i32 s79, s79, 0x500
    v_add_u32 v100, s79, v127
    v_and_b32 v127, 7, v0
    v_lshrrev_b32 v126, 4, v0
    v_add_u32 v126, 4, v126
    v_xor_b32 v126, v127, v126
    v_lshrrev_b32 v127, 3, v0
    v_mul_u32_u24 v127, 0x14000, v127
    v_lshl_add_u32 v127, v126, 4, v127
    s_and_b32 s79, s3, 1
    s_lshl_b32 s79, s79, 10
    s_add_u32 s79, s79, 0x200
    s_lshl_b32 s78, s4, 2
    s_add_u32 s78, s79, s78
    s_lshr_b32 s79, s3, 1
    s_add_u32 s79, s78, s79
    s_mul_i32 s79, s79, 0x500
    v_add_u32 v101, s79, v127
    s_lshl_b32 s79, s3, 3
    v_mul_u32_u24 v127, 0xcd, v0
    v_lshrrev_b32 v127, 12, v127
    v_add_u32 v128, s79, v127
    v_and_b32 v127, 4, v128
    v_and_b32 v126, 51, v128
    v_lshl_add_u32 v126, v127, 1, v126
    v_and_b32 v127, 8, v128
    v_lshrrev_b32 v127, 1, v127
    v_add_u32 v129, v126, v127
    v_lshrrev_b32 v127, 2, v128
    v_and_b32 v127, 1, v127
    v_mul_u32_u24 v127, 10, v127
    v_add_u32 v127, v0, v127
    v_mul_u32_u24 v126, 0xcd, v127
    v_lshrrev_b32 v126, 12, v126
    v_mul_u32_u24 v126, 20, v126
    v_sub_u32 v128, v127, v126
    v_mul_u32_u24 v127, 0xf00, v129
    v_lshl_add_u32 v127, v128, 4, v127
    s_mul_i32 s79, s91, 0x140
    v_add_u32 v102, s79, v127
    s_lshl_b32 s79, s3, 3
    v_add_u32 v127, 64, v0
    v_mul_u32_u24 v127, 0xcd, v127
    v_lshrrev_b32 v127, 12, v127
    v_add_u32 v128, s79, v127
    v_and_b32 v127, 4, v128
    v_and_b32 v126, 51, v128
    v_lshl_add_u32 v126, v127, 1, v126
    v_and_b32 v127, 8, v128
    v_lshrrev_b32 v127, 1, v127
    v_add_u32 v129, v126, v127
    v_add_u32 v127, 64, v0
    v_lshrrev_b32 v126, 2, v128
    v_and_b32 v126, 1, v126
    v_mul_u32_u24 v126, 10, v126
    v_add_u32 v126, v127, v126
    v_mul_u32_u24 v127, 0xcd, v126
    v_lshrrev_b32 v127, 12, v127
    v_mul_u32_u24 v127, 20, v127
    v_sub_u32 v128, v126, v127
    v_mul_u32_u24 v127, 0xf00, v129
    v_lshl_add_u32 v127, v128, 4, v127
    s_mul_i32 s79, s91, 0x140
    v_add_u32 v103, s79, v127
    s_lshl_b32 s79, s3, 3
    v_add_u32 v127, 0x80, v0
    v_mul_u32_u24 v127, 0xcd, v127
    v_lshrrev_b32 v127, 12, v127
    v_add_u32 v128, s79, v127
    v_and_b32 v127, 4, v128
    v_and_b32 v126, 51, v128
    v_lshl_add_u32 v126, v127, 1, v126
    v_and_b32 v127, 8, v128
    v_lshrrev_b32 v127, 1, v127
    v_add_u32 v129, v126, v127
    v_add_u32 v127, 0x80, v0
    v_lshrrev_b32 v126, 2, v128
    v_and_b32 v126, 1, v126
    v_mul_u32_u24 v126, 10, v126
    v_add_u32 v126, v127, v126
    v_mul_u32_u24 v127, 0xcd, v126
    v_lshrrev_b32 v127, 12, v127
    v_mul_u32_u24 v127, 20, v127
    v_sub_u32 v128, v126, v127
    v_mul_u32_u24 v127, 0xf00, v129
    v_lshl_add_u32 v127, v128, 4, v127
    s_mul_i32 s79, s91, 0x140
    v_add_u32 v104, s79, v127
    s_lshl_b32 s83, s3, 11
    s_mul_i32 s79, s3, 0xa00
    s_add_u32 s84, s79, 0x4000
    s_and_b32 s79, s4, 3
    s_mul_i32 s79, s79, 3
    s_and_b32 s78, s91, 1
    s_lshl_b32 s78, s78, 2
    s_add_u32 s78, s79, s78
    s_add_u32 s78, s78, 1
    s_add_u32 s78, s78, 10
    s_mul_i32 s79, s78, 0xcd
    s_lshr_b32 s79, s79, 11
    s_mul_i32 s79, s79, 10
    s_sub_u32 s80, s78, s79
    s_waitcnt lgkmcnt(0)
    s_mov_b32 s28, s8
    s_and_b32 s29, s9, 0xffff
    s_mov_b32 s30, 0x280000
    s_mov_b32 s31, 0x20000
    s_mov_b32 s32, s10
    s_and_b32 s33, s11, 0xffff
    s_mov_b32 s34, 0x258000
    s_mov_b32 s35, 0x20000
    s_mov_b32 s36, s26
    s_and_b32 s37, s27, 0xffff
    s_mov_b32 s38, 0xc40000
    s_mov_b32 s39, 0x20000
    s_mov_b32 s40, s24
    s_and_b32 s41, s25, 0xffff
    s_mov_b32 s42, 0x100
    s_mov_b32 s43, 0x20000
    s_and_b32 s79, s4, 1
    s_lshl_b32 s79, s79, 2
    s_add_u32 s5, s79, s91
    s_lshr_b32 s74, s4, 1
    s_or_b32 s74, s74, s3
    s_cmp_eq_u32 s74, 0
    s_cselect_b64 s[96:97], -1, 0
    v_mov_b32 v140, 0
    v_mov_b32 v141, 0
    v_mov_b32 v142, 0
    v_mov_b32 v143, 0
    v_lshlrev_b32 v138, 4, v0
    v_lshlrev_b32 v139, 6, v0
    s_mov_b64 exec, s[96:97]
    s_lshl_b32 s79, s5, 14
    s_add_u32 s88, s79, 0xc20000
    buffer_store_dword v140, v139, s[36:39], s88 offen sc0 sc1
    s_lshl_b32 s79, s5, 14
    s_add_u32 s88, s79, 0xc21000
    buffer_store_dword v140, v139, s[36:39], s88 offen sc0 sc1
    s_lshl_b32 s79, s5, 14
    s_add_u32 s88, s79, 0xc22000
    buffer_store_dword v140, v139, s[36:39], s88 offen sc0 sc1
    s_lshl_b32 s79, s5, 14
    s_add_u32 s88, s79, 0xc23000
    buffer_store_dword v140, v139, s[36:39], s88 offen sc0 sc1
    s_mul_i32 s79, s5, 0x1e00
    s_add_u32 s88, s79, 0x8a0000
    buffer_store_dwordx4 v[140:143], v138, s[36:39], s88 offen offset:0 sc0 sc1
    buffer_store_dwordx4 v[140:143], v138, s[36:39], s88 offen offset:1024 sc0 sc1
    buffer_store_dwordx4 v[140:143], v138, s[36:39], s88 offen offset:2048 sc0 sc1
    buffer_store_dwordx4 v[140:143], v138, s[36:39], s88 offen offset:3072 sc0 sc1
    s_mul_i32 s79, s5, 0x1e00
    s_add_u32 s88, s79, 0x8a1000
    buffer_store_dwordx4 v[140:143], v138, s[36:39], s88 offen offset:0 sc0 sc1
    buffer_store_dwordx4 v[140:143], v138, s[36:39], s88 offen offset:1024 sc0 sc1
    buffer_store_dwordx4 v[140:143], v138, s[36:39], s88 offen offset:2048 sc0 sc1
    s_mov_b32 exec_hi, 0
    buffer_store_dwordx4 v[140:143], v138, s[36:39], s88 offen offset:3072 sc0 sc1
    s_mov_b64 exec, -1
    s_lshl_b32 s81, s80, 7
    s_mul_i32 s82, s80, 245760
    s_add_u32 s80, s80, 1
    s_cmp_eq_u32 s80, 10
    s_cselect_b32 s80, 0, s80
    s_add_u32 m0, s83, 0
    s_nop 0
    buffer_load_dwordx4 v100, s[28:31], s81 offen lds
    s_add_u32 m0, s84, 0
    s_nop 0
    buffer_load_dwordx4 v102, s[32:35], s82 offen lds
    s_add_u32 m0, s83, 1024
    s_nop 0
    buffer_load_dwordx4 v101, s[28:31], s81 offen lds
    s_add_u32 m0, s84, 1024
    s_nop 0
    buffer_load_dwordx4 v103, s[32:35], s82 offen lds
    s_add_u32 m0, s84, 2048
    s_mov_b64 exec, 0xffffffff
    buffer_load_dwordx4 v104, s[32:35], s82 offen lds
    s_mov_b64 exec, -1
    s_barrier
    s_and_b32 s79, s3, 3
    s_lshl_b32 s79, s79, 5
    v_and_b32 v127, 15, v0
    v_add_u32 v127, s79, v127
    v_lshrrev_b32 v126, 4, v0
    v_and_b32 v125, 15, v0
    v_lshrrev_b32 v125, 1, v125
    v_xor_b32 v125, v126, v125
    v_lshlrev_b32 v125, 4, v125
    v_lshl_add_u32 v106, v127, 7, v125
    s_and_b32 s79, s3, 3
    s_lshl_b32 s79, s79, 5
    v_and_b32 v127, 15, v0
    v_add_u32 v127, s79, v127
    v_lshrrev_b32 v126, 4, v0
    v_add_u32 v126, 4, v126
    v_and_b32 v125, 15, v0
    v_lshrrev_b32 v125, 1, v125
    v_xor_b32 v125, v126, v125
    v_lshlrev_b32 v125, 4, v125
    v_lshl_add_u32 v107, v127, 7, v125
    v_lshrrev_b32 v127, 5, v0
    v_lshrrev_b32 v126, 4, v0
    v_and_b32 v126, 1, v126
    v_lshlrev_b32 v126, 2, v126
    v_lshl_add_u32 v126, v127, 4, v126
    v_lshrrev_b32 v127, 2, v0
    v_and_b32 v127, 3, v127
    v_add_u32 v127, v126, v127
    v_mul_u32_u24 v127, 0x140, v127
    v_lshrrev_b32 v126, 4, v0
    v_and_b32 v126, 1, v126
    s_lshr_b32 s79, s3, 2
    v_xor_b32 v126, s79, v126
    v_mul_u32_u24 v126, 0xa0, v126
    v_add_u32 v128, v127, v126
    v_and_b32 v127, 3, v0
    v_lshl_add_u32 v127, v127, 3, v128
    v_add_u32 v114, 0x4000, v127
    v_and_b32 v127, 3, v0
    v_mul_u32_u24 v127, 40, v127
    v_add_u32 v127, v128, v127
    v_add_u32 v118, 0x4020, v127
    v_add_u32 v108, 36864, v106
    v_add_u32 v109, 36864, v107
    v_add_u32 v115, 36864, v114
    v_add_u32 v119, 36864, v118
    v_add_u32 v110, 73728, v106
    v_add_u32 v111, 73728, v107
    v_add_u32 v116, 73728, v114
    v_add_u32 v120, 73728, v118
    v_add_u32 v112, 110592, v106
    v_add_u32 v113, 110592, v107
    v_add_u32 v117, 110592, v114
    v_add_u32 v121, 110592, v118
    s_mov_b32 s85, 0x3fb8aa3b
    s_mov_b32 s86, 0x358637bd
    v_mov_b32 v4, s86
    v_mov_b32 v5, s86
    v_mov_b32 v6, s86
    v_mov_b32 v7, s86
    v_mov_b32 v8, s86
    v_mov_b32 v9, s86
    v_mov_b32 v10, s86
    v_mov_b32 v11, s86
    v_mov_b32 v12, s86
    v_mov_b32 v13, s86
    v_mov_b32 v14, s86
    v_mov_b32 v15, s86
    v_mov_b32 v16, s86
    v_mov_b32 v17, s86
    v_mov_b32 v18, s86
    v_mov_b32 v19, s86
    v_mov_b32 v20, s86
    v_mov_b32 v21, s86
    v_mov_b32 v22, s86
    v_mov_b32 v23, s86
    v_mov_b32 v24, s86
    v_mov_b32 v25, s86
    v_mov_b32 v26, s86
    v_mov_b32 v27, s86
    v_mov_b32 v28, s86
    v_mov_b32 v29, s86
    v_mov_b32 v30, s86
    v_mov_b32 v31, s86
    v_mov_b32 v32, s86
    v_mov_b32 v33, s86
    v_mov_b32 v34, s86
    v_mov_b32 v35, s86
    v_mov_b32 v36, s86
    v_mov_b32 v37, s86
    v_mov_b32 v38, s86
    v_mov_b32 v39, s86
    v_mov_b32 v40, s86
    v_mov_b32 v41, s86
    v_mov_b32 v42, s86
    v_mov_b32 v43, s86
    s_lshl_b32 s79, s4, 3
    s_and_b32 s78, s3, 3
    s_lshl_b32 s78, s78, 1
    s_add_u32 s78, s79, s78
    s_mul_i32 s78, s78, 0x5000
    s_mul_i32 s79, s91, 0x1400
    s_add_u32 s79, s78, s79
    s_lshr_b32 s78, s3, 2
    s_mul_i32 s78, s78, 0xa00
    s_add_u32 s78, s79, s78
    s_mov_b32 s79, s78
    v_lshl_add_u32 v130, v0, 4, s79
    v_lshl_add_u32 v132, v0, 3, s79
    s_lshl_b32 s81, s80, 7
    s_mul_i32 s82, s80, 245760
    s_add_u32 s80, s80, 1
    s_cmp_eq_u32 s80, 10
    s_cselect_b32 s80, 0, s80
    s_add_u32 m0, s83, 36864
    s_nop 0
    buffer_load_dwordx4 v100, s[28:31], s81 offen lds
    s_add_u32 m0, s84, 36864
    s_nop 0
    buffer_load_dwordx4 v102, s[32:35], s82 offen lds
    s_add_u32 m0, s83, 37888
    s_nop 0
    buffer_load_dwordx4 v101, s[28:31], s81 offen lds
    s_add_u32 m0, s84, 37888
    s_nop 0
    buffer_load_dwordx4 v103, s[32:35], s82 offen lds
    s_add_u32 m0, s84, 38912
    s_mov_b64 exec, 0xffffffff
    buffer_load_dwordx4 v104, s[32:35], s82 offen lds
    s_mov_b64 exec, -1
    s_cmp_eq_u64 s[96:97], 0
    s_cbranch_scc1 L12
    s_waitcnt vmcnt(0)
    s_lshl_b32 s79, s5, 2
    s_add_u32 s88, s79, 0x80
    v_mov_b32 v137, 1
    v_mov_b32 v136, 0
    s_and_b64 exec, s[96:97], 1
    buffer_store_dword v137, v136, s[40:43], s88 offen sc0 sc1
    s_mov_b64 exec, -1
L12:
    s_lshl_b32 s79, s91, 1
    s_lshr_b32 s78, s3, 2
    s_add_u32 s5, s79, s78
    s_waitcnt vmcnt(5)
    s_barrier
    ds_read_b128 v[44:47], v106 offset:0
    ds_read_b128 v[48:51], v106 offset:2048
    ds_read_b64_tr_b16 v[60:61], v114 offset:0
    ds_read_b64_tr_b16 v[62:63], v114 offset:2560
    ds_read_b64_tr_b16 v[64:65], v114 offset:40
    ds_read_b64_tr_b16 v[66:67], v114 offset:2600
    ds_read_b64_tr_b16 v[68:69], v114 offset:80
    ds_read_b64_tr_b16 v[70:71], v114 offset:2640
    ds_read_b64_tr_b16 v[72:73], v114 offset:120
    ds_read_b64_tr_b16 v[74:75], v114 offset:2680
    ds_read_b64_tr_b16 v[76:77], v118 offset:0
    ds_read_b64_tr_b16 v[78:79], v118 offset:2560
    ds_read_b128 v[52:55], v107 offset:0
    ds_read_b128 v[56:59], v107 offset:2048
    s_waitcnt lgkmcnt(10)
    v_mfma_f32_16x16x32_bf16 v[4:7], v[60:63], v[44:47], v[4:7]
    ds_read_b64_tr_b16 v[80:81], v114 offset:10240
    ds_read_b64_tr_b16 v[82:83], v114 offset:12800
    v_mfma_f32_16x16x32_bf16 v[8:11], v[60:63], v[48:51], v[8:11]
    s_lshl_b32 s81, s80, 7
    s_mul_i32 s82, s80, 245760
    s_add_u32 s80, s80, 1
    s_cmp_eq_u32 s80, 10
    s_cselect_b32 s80, 0, s80
    s_add_u32 m0, s83, 73728
    s_nop 0
    buffer_load_dwordx4 v100, s[28:31], s81 offen lds
    ds_read_b64_tr_b16 v[84:85], v114 offset:10280
    ds_read_b64_tr_b16 v[86:87], v114 offset:12840
    s_waitcnt lgkmcnt(12)
    v_mfma_f32_16x16x32_bf16 v[12:15], v[64:67], v[44:47], v[12:15]
    ds_read_b64_tr_b16 v[88:89], v114 offset:10320
    ds_read_b64_tr_b16 v[90:91], v114 offset:12880
    v_mfma_f32_16x16x32_bf16 v[16:19], v[64:67], v[48:51], v[16:19]
    s_add_u32 m0, s84, 73728
    s_nop 0
    buffer_load_dwordx4 v102, s[32:35], s82 offen lds
    ds_read_b64_tr_b16 v[92:93], v114 offset:10360
    ds_read_b64_tr_b16 v[94:95], v114 offset:12920
    s_waitcnt lgkmcnt(14)
    v_mfma_f32_16x16x32_bf16 v[20:23], v[68:71], v[44:47], v[20:23]
    ds_read_b64_tr_b16 v[96:97], v118 offset:10240
    ds_read_b64_tr_b16 v[98:99], v118 offset:12800
    v_mfma_f32_16x16x32_bf16 v[24:27], v[68:71], v[48:51], v[24:27]
    s_add_u32 m0, s83, 74752
    s_nop 0
    buffer_load_dwordx4 v101, s[28:31], s81 offen lds
    s_waitcnt lgkmcnt(14)
    v_mfma_f32_16x16x32_bf16 v[28:31], v[72:75], v[44:47], v[28:31]
    v_mfma_f32_16x16x32_bf16 v[32:35], v[72:75], v[48:51], v[32:35]
    s_add_u32 m0, s84, 74752
    s_nop 0
    buffer_load_dwordx4 v103, s[32:35], s82 offen lds
    s_waitcnt lgkmcnt(12)
    v_mfma_f32_16x16x32_bf16 v[36:39], v[76:79], v[44:47], v[36:39]
    v_mfma_f32_16x16x32_bf16 v[40:43], v[76:79], v[48:51], v[40:43]
    s_add_u32 m0, s84, 75776
    s_mov_b64 exec, 0xffffffff
    buffer_load_dwordx4 v104, s[32:35], s82 offen lds
    s_mov_b64 exec, -1
    s_waitcnt lgkmcnt(0)
    s_waitcnt vmcnt(5)
    s_barrier
    ds_read_b128 v[44:47], v108 offset:0
    ds_read_b128 v[48:51], v108 offset:2048
    v_mfma_f32_16x16x32_bf16 v[4:7], v[80:83], v[52:55], v[4:7]
    ds_read_b64_tr_b16 v[60:61], v115 offset:0
    ds_read_b64_tr_b16 v[62:63], v115 offset:2560
    v_mfma_f32_16x16x32_bf16 v[8:11], v[80:83], v[56:59], v[8:11]
    s_lshl_b32 s81, s80, 7
    s_mul_i32 s82, s80, 245760
    s_add_u32 s80, s80, 1
    s_cmp_eq_u32 s80, 10
    s_cselect_b32 s80, 0, s80
    s_add_u32 m0, s83, 110592
    s_nop 0
    buffer_load_dwordx4 v100, s[28:31], s81 offen lds
    ds_read_b64_tr_b16 v[64:65], v115 offset:40
    ds_read_b64_tr_b16 v[66:67], v115 offset:2600
    v_mfma_f32_16x16x32_bf16 v[12:15], v[84:87], v[52:55], v[12:15]
    ds_read_b64_tr_b16 v[68:69], v115 offset:80
    ds_read_b64_tr_b16 v[70:71], v115 offset:2640
    v_mfma_f32_16x16x32_bf16 v[16:19], v[84:87], v[56:59], v[16:19]
    s_add_u32 m0, s84, 110592
    s_nop 0
    buffer_load_dwordx4 v102, s[32:35], s82 offen lds
    ds_read_b64_tr_b16 v[72:73], v115 offset:120
    ds_read_b64_tr_b16 v[74:75], v115 offset:2680
    v_mfma_f32_16x16x32_bf16 v[20:23], v[88:91], v[52:55], v[20:23]
    ds_read_b64_tr_b16 v[76:77], v119 offset:0
    ds_read_b64_tr_b16 v[78:79], v119 offset:2560
    v_mfma_f32_16x16x32_bf16 v[24:27], v[88:91], v[56:59], v[24:27]
    s_add_u32 m0, s83, 111616
    s_nop 0
    buffer_load_dwordx4 v101, s[28:31], s81 offen lds
    v_mfma_f32_16x16x32_bf16 v[28:31], v[92:95], v[52:55], v[28:31]
    v_mfma_f32_16x16x32_bf16 v[32:35], v[92:95], v[56:59], v[32:35]
    s_add_u32 m0, s84, 111616
    s_nop 0
    buffer_load_dwordx4 v103, s[32:35], s82 offen lds
    v_mfma_f32_16x16x32_bf16 v[36:39], v[96:99], v[52:55], v[36:39]
    v_mfma_f32_16x16x32_bf16 v[40:43], v[96:99], v[56:59], v[40:43]
    s_add_u32 m0, s84, 112640
    s_mov_b64 exec, 0xffffffff
    buffer_load_dwordx4 v104, s[32:35], s82 offen lds
    s_mov_b64 exec, -1
    ds_read_b128 v[52:55], v109 offset:0
    ds_read_b128 v[56:59], v109 offset:2048
    s_waitcnt lgkmcnt(10)
    v_mfma_f32_16x16x32_bf16 v[4:7], v[60:63], v[44:47], v[4:7]
    ds_read_b64_tr_b16 v[80:81], v115 offset:10240
    ds_read_b64_tr_b16 v[82:83], v115 offset:12800
    v_mfma_f32_16x16x32_bf16 v[8:11], v[60:63], v[48:51], v[8:11]
    s_lshl_b32 s81, s80, 7
    s_mul_i32 s82, s80, 245760
    s_add_u32 s80, s80, 1
    s_cmp_eq_u32 s80, 10
    s_cselect_b32 s80, 0, s80
    s_add_u32 m0, s83, 0
    s_nop 0
    buffer_load_dwordx4 v100, s[28:31], s81 offen lds
    ds_read_b64_tr_b16 v[84:85], v115 offset:10280
    ds_read_b64_tr_b16 v[86:87], v115 offset:12840
    s_waitcnt lgkmcnt(12)
    v_mfma_f32_16x16x32_bf16 v[12:15], v[64:67], v[44:47], v[12:15]
    ds_read_b64_tr_b16 v[88:89], v115 offset:10320
    ds_read_b64_tr_b16 v[90:91], v115 offset:12880
    v_mfma_f32_16x16x32_bf16 v[16:19], v[64:67], v[48:51], v[16:19]
    s_add_u32 m0, s84, 0
    s_nop 0
    buffer_load_dwordx4 v102, s[32:35], s82 offen lds
    ds_read_b64_tr_b16 v[92:93], v115 offset:10360
    ds_read_b64_tr_b16 v[94:95], v115 offset:12920
    s_waitcnt lgkmcnt(14)
    v_mfma_f32_16x16x32_bf16 v[20:23], v[68:71], v[44:47], v[20:23]
    ds_read_b64_tr_b16 v[96:97], v119 offset:10240
    ds_read_b64_tr_b16 v[98:99], v119 offset:12800
    v_mfma_f32_16x16x32_bf16 v[24:27], v[68:71], v[48:51], v[24:27]
    s_add_u32 m0, s83, 1024
    s_nop 0
    buffer_load_dwordx4 v101, s[28:31], s81 offen lds
    s_waitcnt lgkmcnt(14)
    v_mfma_f32_16x16x32_bf16 v[28:31], v[72:75], v[44:47], v[28:31]
    v_mfma_f32_16x16x32_bf16 v[32:35], v[72:75], v[48:51], v[32:35]
    s_add_u32 m0, s84, 1024
    s_nop 0
    buffer_load_dwordx4 v103, s[32:35], s82 offen lds
    s_waitcnt lgkmcnt(12)
    v_mfma_f32_16x16x32_bf16 v[36:39], v[76:79], v[44:47], v[36:39]
    v_mfma_f32_16x16x32_bf16 v[40:43], v[76:79], v[48:51], v[40:43]
    s_add_u32 m0, s84, 2048
    s_mov_b64 exec, 0xffffffff
    buffer_load_dwordx4 v104, s[32:35], s82 offen lds
    s_mov_b64 exec, -1
    s_waitcnt lgkmcnt(0)
    s_waitcnt vmcnt(10)
    s_barrier
    ds_read_b128 v[44:47], v110 offset:0
    ds_read_b128 v[48:51], v110 offset:2048
    v_mfma_f32_16x16x32_bf16 v[4:7], v[80:83], v[52:55], v[4:7]
    ds_read_b64_tr_b16 v[60:61], v116 offset:0
    ds_read_b64_tr_b16 v[62:63], v116 offset:2560
    v_mfma_f32_16x16x32_bf16 v[8:11], v[80:83], v[56:59], v[8:11]
    s_lshl_b32 s81, s80, 7
    s_mul_i32 s82, s80, 245760
    s_add_u32 s80, s80, 1
    s_cmp_eq_u32 s80, 10
    s_cselect_b32 s80, 0, s80
    s_add_u32 m0, s83, 36864
    s_nop 0
    buffer_load_dwordx4 v100, s[28:31], s81 offen lds
    ds_read_b64_tr_b16 v[64:65], v116 offset:40
    ds_read_b64_tr_b16 v[66:67], v116 offset:2600
    v_mfma_f32_16x16x32_bf16 v[12:15], v[84:87], v[52:55], v[12:15]
    ds_read_b64_tr_b16 v[68:69], v116 offset:80
    ds_read_b64_tr_b16 v[70:71], v116 offset:2640
    v_mfma_f32_16x16x32_bf16 v[16:19], v[84:87], v[56:59], v[16:19]
    s_add_u32 m0, s84, 36864
    s_nop 0
    buffer_load_dwordx4 v102, s[32:35], s82 offen lds
    ds_read_b64_tr_b16 v[72:73], v116 offset:120
    ds_read_b64_tr_b16 v[74:75], v116 offset:2680
    v_mfma_f32_16x16x32_bf16 v[20:23], v[88:91], v[52:55], v[20:23]
    ds_read_b64_tr_b16 v[76:77], v120 offset:0
    ds_read_b64_tr_b16 v[78:79], v120 offset:2560
    v_mfma_f32_16x16x32_bf16 v[24:27], v[88:91], v[56:59], v[24:27]
    s_add_u32 m0, s83, 37888
    s_nop 0
    buffer_load_dwordx4 v101, s[28:31], s81 offen lds
    v_mfma_f32_16x16x32_bf16 v[28:31], v[92:95], v[52:55], v[28:31]
    v_mfma_f32_16x16x32_bf16 v[32:35], v[92:95], v[56:59], v[32:35]
    s_add_u32 m0, s84, 37888
    s_nop 0
    buffer_load_dwordx4 v103, s[32:35], s82 offen lds
    v_mfma_f32_16x16x32_bf16 v[36:39], v[96:99], v[52:55], v[36:39]
    v_mfma_f32_16x16x32_bf16 v[40:43], v[96:99], v[56:59], v[40:43]
    s_add_u32 m0, s84, 38912
    s_mov_b64 exec, 0xffffffff
    buffer_load_dwordx4 v104, s[32:35], s82 offen lds
    s_mov_b64 exec, -1
    ds_read_b128 v[52:55], v111 offset:0
    ds_read_b128 v[56:59], v111 offset:2048
    s_waitcnt lgkmcnt(10)
    v_mfma_f32_16x16x32_bf16 v[4:7], v[60:63], v[44:47], v[4:7]
    ds_read_b64_tr_b16 v[80:81], v116 offset:10240
    ds_read_b64_tr_b16 v[82:83], v116 offset:12800
    v_mfma_f32_16x16x32_bf16 v[8:11], v[60:63], v[48:51], v[8:11]
    ds_read_b64_tr_b16 v[84:85], v116 offset:10280
    ds_read_b64_tr_b16 v[86:87], v116 offset:12840
    s_waitcnt lgkmcnt(12)
    v_mfma_f32_16x16x32_bf16 v[12:15], v[64:67], v[44:47], v[12:15]
    ds_read_b64_tr_b16 v[88:89], v116 offset:10320
    ds_read_b64_tr_b16 v[90:91], v116 offset:12880
    v_mfma_f32_16x16x32_bf16 v[16:19], v[64:67], v[48:51], v[16:19]
    ds_read_b64_tr_b16 v[92:93], v116 offset:10360
    ds_read_b64_tr_b16 v[94:95], v116 offset:12920
    s_waitcnt lgkmcnt(14)
    v_mfma_f32_16x16x32_bf16 v[20:23], v[68:71], v[44:47], v[20:23]
    ds_read_b64_tr_b16 v[96:97], v120 offset:10240
    ds_read_b64_tr_b16 v[98:99], v120 offset:12800
    v_mfma_f32_16x16x32_bf16 v[24:27], v[68:71], v[48:51], v[24:27]
    s_waitcnt lgkmcnt(14)
    v_mfma_f32_16x16x32_bf16 v[28:31], v[72:75], v[44:47], v[28:31]
    v_mfma_f32_16x16x32_bf16 v[32:35], v[72:75], v[48:51], v[32:35]
    s_waitcnt lgkmcnt(12)
    v_mfma_f32_16x16x32_bf16 v[36:39], v[76:79], v[44:47], v[36:39]
    v_mfma_f32_16x16x32_bf16 v[40:43], v[76:79], v[48:51], v[40:43]
    s_waitcnt lgkmcnt(0)
    s_waitcnt vmcnt(10)
    s_barrier
    ds_read_b128 v[44:47], v112 offset:0
    ds_read_b128 v[48:51], v112 offset:2048
    v_mfma_f32_16x16x32_bf16 v[4:7], v[80:83], v[52:55], v[4:7]
    ds_read_b64_tr_b16 v[60:61], v117 offset:0
    ds_read_b64_tr_b16 v[62:63], v117 offset:2560
    v_mfma_f32_16x16x32_bf16 v[8:11], v[80:83], v[56:59], v[8:11]
    s_lshl_b32 s81, s80, 7
    s_mul_i32 s82, s80, 245760
    s_add_u32 s80, s80, 1
    s_cmp_eq_u32 s80, 10
    s_cselect_b32 s80, 0, s80
    s_add_u32 m0, s83, 73728
    s_nop 0
    buffer_load_dwordx4 v100, s[28:31], s81 offen lds
    ds_read_b64_tr_b16 v[64:65], v117 offset:40
    ds_read_b64_tr_b16 v[66:67], v117 offset:2600
    v_mfma_f32_16x16x32_bf16 v[12:15], v[84:87], v[52:55], v[12:15]
    ds_read_b64_tr_b16 v[68:69], v117 offset:80
    ds_read_b64_tr_b16 v[70:71], v117 offset:2640
    v_mfma_f32_16x16x32_bf16 v[16:19], v[84:87], v[56:59], v[16:19]
    s_add_u32 m0, s84, 73728
    s_nop 0
    buffer_load_dwordx4 v102, s[32:35], s82 offen lds
    ds_read_b64_tr_b16 v[72:73], v117 offset:120
    ds_read_b64_tr_b16 v[74:75], v117 offset:2680
    v_mfma_f32_16x16x32_bf16 v[20:23], v[88:91], v[52:55], v[20:23]
    ds_read_b64_tr_b16 v[76:77], v121 offset:0
    ds_read_b64_tr_b16 v[78:79], v121 offset:2560
    v_mfma_f32_16x16x32_bf16 v[24:27], v[88:91], v[56:59], v[24:27]
    s_add_u32 m0, s83, 74752
    s_nop 0
    buffer_load_dwordx4 v101, s[28:31], s81 offen lds
    v_mfma_f32_16x16x32_bf16 v[28:31], v[92:95], v[52:55], v[28:31]
    v_mfma_f32_16x16x32_bf16 v[32:35], v[92:95], v[56:59], v[32:35]
    s_add_u32 m0, s84, 74752
    s_nop 0
    buffer_load_dwordx4 v103, s[32:35], s82 offen lds
    v_mfma_f32_16x16x32_bf16 v[36:39], v[96:99], v[52:55], v[36:39]
    v_mfma_f32_16x16x32_bf16 v[40:43], v[96:99], v[56:59], v[40:43]
    s_add_u32 m0, s84, 75776
    s_mov_b64 exec, 0xffffffff
    buffer_load_dwordx4 v104, s[32:35], s82 offen lds
    s_mov_b64 exec, -1
    ds_read_b128 v[52:55], v113 offset:0
    ds_read_b128 v[56:59], v113 offset:2048
    s_waitcnt lgkmcnt(10)
    v_mfma_f32_16x16x32_bf16 v[4:7], v[60:63], v[44:47], v[4:7]
    ds_read_b64_tr_b16 v[80:81], v117 offset:10240
    ds_read_b64_tr_b16 v[82:83], v117 offset:12800
    v_mfma_f32_16x16x32_bf16 v[8:11], v[60:63], v[48:51], v[8:11]
    ds_read_b64_tr_b16 v[84:85], v117 offset:10280
    ds_read_b64_tr_b16 v[86:87], v117 offset:12840
    s_waitcnt lgkmcnt(12)
    v_mfma_f32_16x16x32_bf16 v[12:15], v[64:67], v[44:47], v[12:15]
    ds_read_b64_tr_b16 v[88:89], v117 offset:10320
    ds_read_b64_tr_b16 v[90:91], v117 offset:12880
    v_mfma_f32_16x16x32_bf16 v[16:19], v[64:67], v[48:51], v[16:19]
    ds_read_b64_tr_b16 v[92:93], v117 offset:10360
    ds_read_b64_tr_b16 v[94:95], v117 offset:12920
    s_waitcnt lgkmcnt(14)
    v_mfma_f32_16x16x32_bf16 v[20:23], v[68:71], v[44:47], v[20:23]
    ds_read_b64_tr_b16 v[96:97], v121 offset:10240
    ds_read_b64_tr_b16 v[98:99], v121 offset:12800
    v_mfma_f32_16x16x32_bf16 v[24:27], v[68:71], v[48:51], v[24:27]
    s_waitcnt lgkmcnt(14)
    v_mfma_f32_16x16x32_bf16 v[28:31], v[72:75], v[44:47], v[28:31]
    v_mfma_f32_16x16x32_bf16 v[32:35], v[72:75], v[48:51], v[32:35]
    s_waitcnt lgkmcnt(12)
    v_mfma_f32_16x16x32_bf16 v[36:39], v[76:79], v[44:47], v[36:39]
    v_mfma_f32_16x16x32_bf16 v[40:43], v[76:79], v[48:51], v[40:43]
    s_waitcnt lgkmcnt(0)
    s_waitcnt vmcnt(10)
    s_barrier
    ds_read_b128 v[44:47], v106 offset:0
    ds_read_b128 v[48:51], v106 offset:2048
    v_mfma_f32_16x16x32_bf16 v[4:7], v[80:83], v[52:55], v[4:7]
    ds_read_b64_tr_b16 v[60:61], v114 offset:0
    ds_read_b64_tr_b16 v[62:63], v114 offset:2560
    v_mfma_f32_16x16x32_bf16 v[8:11], v[80:83], v[56:59], v[8:11]
    s_lshl_b32 s81, s80, 7
    s_mul_i32 s82, s80, 245760
    s_add_u32 s80, s80, 1
    s_cmp_eq_u32 s80, 10
    s_cselect_b32 s80, 0, s80
    s_add_u32 m0, s83, 110592
    s_nop 0
    buffer_load_dwordx4 v100, s[28:31], s81 offen lds
    ds_read_b64_tr_b16 v[64:65], v114 offset:40
    ds_read_b64_tr_b16 v[66:67], v114 offset:2600
    v_mfma_f32_16x16x32_bf16 v[12:15], v[84:87], v[52:55], v[12:15]
    ds_read_b64_tr_b16 v[68:69], v114 offset:80
    ds_read_b64_tr_b16 v[70:71], v114 offset:2640
    v_mfma_f32_16x16x32_bf16 v[16:19], v[84:87], v[56:59], v[16:19]
    s_add_u32 m0, s84, 110592
    s_nop 0
    buffer_load_dwordx4 v102, s[32:35], s82 offen lds
    ds_read_b64_tr_b16 v[72:73], v114 offset:120
    ds_read_b64_tr_b16 v[74:75], v114 offset:2680
    v_mfma_f32_16x16x32_bf16 v[20:23], v[88:91], v[52:55], v[20:23]
    ds_read_b64_tr_b16 v[76:77], v118 offset:0
    ds_read_b64_tr_b16 v[78:79], v118 offset:2560
    v_mfma_f32_16x16x32_bf16 v[24:27], v[88:91], v[56:59], v[24:27]
    s_add_u32 m0, s83, 111616
    s_nop 0
    buffer_load_dwordx4 v101, s[28:31], s81 offen lds
    v_mfma_f32_16x16x32_bf16 v[28:31], v[92:95], v[52:55], v[28:31]
    v_mfma_f32_16x16x32_bf16 v[32:35], v[92:95], v[56:59], v[32:35]
    s_add_u32 m0, s84, 111616
    s_nop 0
    buffer_load_dwordx4 v103, s[32:35], s82 offen lds
    v_mfma_f32_16x16x32_bf16 v[36:39], v[96:99], v[52:55], v[36:39]
    v_mfma_f32_16x16x32_bf16 v[40:43], v[96:99], v[56:59], v[40:43]
    s_add_u32 m0, s84, 112640
    s_mov_b64 exec, 0xffffffff
    buffer_load_dwordx4 v104, s[32:35], s82 offen lds
    s_mov_b64 exec, -1
    ds_read_b128 v[52:55], v107 offset:0
    ds_read_b128 v[56:59], v107 offset:2048
    s_waitcnt lgkmcnt(10)
    v_mfma_f32_16x16x32_bf16 v[4:7], v[60:63], v[44:47], v[4:7]
    ds_read_b64_tr_b16 v[80:81], v114 offset:10240
    ds_read_b64_tr_b16 v[82:83], v114 offset:12800
    v_mfma_f32_16x16x32_bf16 v[8:11], v[60:63], v[48:51], v[8:11]
    ds_read_b64_tr_b16 v[84:85], v114 offset:10280
    ds_read_b64_tr_b16 v[86:87], v114 offset:12840
    s_waitcnt lgkmcnt(12)
    v_mfma_f32_16x16x32_bf16 v[12:15], v[64:67], v[44:47], v[12:15]
    ds_read_b64_tr_b16 v[88:89], v114 offset:10320
    ds_read_b64_tr_b16 v[90:91], v114 offset:12880
    v_mfma_f32_16x16x32_bf16 v[16:19], v[64:67], v[48:51], v[16:19]
    ds_read_b64_tr_b16 v[92:93], v114 offset:10360
    ds_read_b64_tr_b16 v[94:95], v114 offset:12920
    s_waitcnt lgkmcnt(14)
    v_mfma_f32_16x16x32_bf16 v[20:23], v[68:71], v[44:47], v[20:23]
    ds_read_b64_tr_b16 v[96:97], v118 offset:10240
    ds_read_b64_tr_b16 v[98:99], v118 offset:12800
    v_mfma_f32_16x16x32_bf16 v[24:27], v[68:71], v[48:51], v[24:27]
    s_waitcnt lgkmcnt(14)
    v_mfma_f32_16x16x32_bf16 v[28:31], v[72:75], v[44:47], v[28:31]
    v_mfma_f32_16x16x32_bf16 v[32:35], v[72:75], v[48:51], v[32:35]
    s_waitcnt lgkmcnt(12)
    v_mfma_f32_16x16x32_bf16 v[36:39], v[76:79], v[44:47], v[36:39]
    v_mfma_f32_16x16x32_bf16 v[40:43], v[76:79], v[48:51], v[40:43]
    s_waitcnt lgkmcnt(0)
    s_waitcnt vmcnt(10)
    s_barrier
    ds_read_b128 v[44:47], v108 offset:0
    ds_read_b128 v[48:51], v108 offset:2048
    v_mfma_f32_16x16x32_bf16 v[4:7], v[80:83], v[52:55], v[4:7]
    ds_read_b64_tr_b16 v[60:61], v115 offset:0
    ds_read_b64_tr_b16 v[62:63], v115 offset:2560
    v_mfma_f32_16x16x32_bf16 v[8:11], v[80:83], v[56:59], v[8:11]
    s_lshl_b32 s81, s80, 7
    s_mul_i32 s82, s80, 245760
    s_add_u32 s80, s80, 1
    s_cmp_eq_u32 s80, 10
    s_cselect_b32 s80, 0, s80
    s_add_u32 m0, s83, 0
    s_nop 0
    buffer_load_dwordx4 v100, s[28:31], s81 offen lds
    ds_read_b64_tr_b16 v[64:65], v115 offset:40
    ds_read_b64_tr_b16 v[66:67], v115 offset:2600
    v_mfma_f32_16x16x32_bf16 v[12:15], v[84:87], v[52:55], v[12:15]
    ds_read_b64_tr_b16 v[68:69], v115 offset:80
    ds_read_b64_tr_b16 v[70:71], v115 offset:2640
    v_mfma_f32_16x16x32_bf16 v[16:19], v[84:87], v[56:59], v[16:19]
    s_add_u32 m0, s84, 0
    s_nop 0
    buffer_load_dwordx4 v102, s[32:35], s82 offen lds
    ds_read_b64_tr_b16 v[72:73], v115 offset:120
    ds_read_b64_tr_b16 v[74:75], v115 offset:2680
    v_mfma_f32_16x16x32_bf16 v[20:23], v[88:91], v[52:55], v[20:23]
    ds_read_b64_tr_b16 v[76:77], v119 offset:0
    ds_read_b64_tr_b16 v[78:79], v119 offset:2560
    v_mfma_f32_16x16x32_bf16 v[24:27], v[88:91], v[56:59], v[24:27]
    s_add_u32 m0, s83, 1024
    s_nop 0
    buffer_load_dwordx4 v101, s[28:31], s81 offen lds
    v_mfma_f32_16x16x32_bf16 v[28:31], v[92:95], v[52:55], v[28:31]
    v_mfma_f32_16x16x32_bf16 v[32:35], v[92:95], v[56:59], v[32:35]
    s_add_u32 m0, s84, 1024
    s_nop 0
    buffer_load_dwordx4 v103, s[32:35], s82 offen lds
    v_mfma_f32_16x16x32_bf16 v[36:39], v[96:99], v[52:55], v[36:39]
    v_mfma_f32_16x16x32_bf16 v[40:43], v[96:99], v[56:59], v[40:43]
    s_add_u32 m0, s84, 2048
    s_mov_b64 exec, 0xffffffff
    buffer_load_dwordx4 v104, s[32:35], s82 offen lds
    s_mov_b64 exec, -1
    ds_read_b128 v[52:55], v109 offset:0
    ds_read_b128 v[56:59], v109 offset:2048
    s_waitcnt lgkmcnt(10)
    v_mfma_f32_16x16x32_bf16 v[4:7], v[60:63], v[44:47], v[4:7]
    ds_read_b64_tr_b16 v[80:81], v115 offset:10240
    ds_read_b64_tr_b16 v[82:83], v115 offset:12800
    v_mfma_f32_16x16x32_bf16 v[8:11], v[60:63], v[48:51], v[8:11]
    ds_read_b64_tr_b16 v[84:85], v115 offset:10280
    ds_read_b64_tr_b16 v[86:87], v115 offset:12840
    s_waitcnt lgkmcnt(12)
    v_mfma_f32_16x16x32_bf16 v[12:15], v[64:67], v[44:47], v[12:15]
    ds_read_b64_tr_b16 v[88:89], v115 offset:10320
    ds_read_b64_tr_b16 v[90:91], v115 offset:12880
    v_mfma_f32_16x16x32_bf16 v[16:19], v[64:67], v[48:51], v[16:19]
    ds_read_b64_tr_b16 v[92:93], v115 offset:10360
    ds_read_b64_tr_b16 v[94:95], v115 offset:12920
    s_waitcnt lgkmcnt(14)
    v_mfma_f32_16x16x32_bf16 v[20:23], v[68:71], v[44:47], v[20:23]
    ds_read_b64_tr_b16 v[96:97], v119 offset:10240
    ds_read_b64_tr_b16 v[98:99], v119 offset:12800
    v_mfma_f32_16x16x32_bf16 v[24:27], v[68:71], v[48:51], v[24:27]
    s_waitcnt lgkmcnt(14)
    v_mfma_f32_16x16x32_bf16 v[28:31], v[72:75], v[44:47], v[28:31]
    v_mfma_f32_16x16x32_bf16 v[32:35], v[72:75], v[48:51], v[32:35]
    s_waitcnt lgkmcnt(12)
    v_mfma_f32_16x16x32_bf16 v[36:39], v[76:79], v[44:47], v[36:39]
    v_mfma_f32_16x16x32_bf16 v[40:43], v[76:79], v[48:51], v[40:43]
    s_waitcnt lgkmcnt(0)
    s_waitcnt vmcnt(10)
    s_barrier
    ds_read_b128 v[44:47], v110 offset:0
    ds_read_b128 v[48:51], v110 offset:2048
    v_mfma_f32_16x16x32_bf16 v[4:7], v[80:83], v[52:55], v[4:7]
    ds_read_b64_tr_b16 v[60:61], v116 offset:0
    ds_read_b64_tr_b16 v[62:63], v116 offset:2560
    v_mfma_f32_16x16x32_bf16 v[8:11], v[80:83], v[56:59], v[8:11]
    s_lshl_b32 s81, s80, 7
    s_mul_i32 s82, s80, 245760
    s_add_u32 s80, s80, 1
    s_cmp_eq_u32 s80, 10
    s_cselect_b32 s80, 0, s80
    s_add_u32 m0, s83, 36864
    s_nop 0
    buffer_load_dwordx4 v100, s[28:31], s81 offen lds
    ds_read_b64_tr_b16 v[64:65], v116 offset:40
    ds_read_b64_tr_b16 v[66:67], v116 offset:2600
    v_mfma_f32_16x16x32_bf16 v[12:15], v[84:87], v[52:55], v[12:15]
    ds_read_b64_tr_b16 v[68:69], v116 offset:80
    ds_read_b64_tr_b16 v[70:71], v116 offset:2640
    v_mfma_f32_16x16x32_bf16 v[16:19], v[84:87], v[56:59], v[16:19]
    s_add_u32 m0, s84, 36864
    s_nop 0
    buffer_load_dwordx4 v102, s[32:35], s82 offen lds
    ds_read_b64_tr_b16 v[72:73], v116 offset:120
    ds_read_b64_tr_b16 v[74:75], v116 offset:2680
    v_mfma_f32_16x16x32_bf16 v[20:23], v[88:91], v[52:55], v[20:23]
    ds_read_b64_tr_b16 v[76:77], v120 offset:0
    ds_read_b64_tr_b16 v[78:79], v120 offset:2560
    v_mfma_f32_16x16x32_bf16 v[24:27], v[88:91], v[56:59], v[24:27]
    s_add_u32 m0, s83, 37888
    s_nop 0
    buffer_load_dwordx4 v101, s[28:31], s81 offen lds
    v_mfma_f32_16x16x32_bf16 v[28:31], v[92:95], v[52:55], v[28:31]
    v_mfma_f32_16x16x32_bf16 v[32:35], v[92:95], v[56:59], v[32:35]
    s_add_u32 m0, s84, 37888
    s_nop 0
    buffer_load_dwordx4 v103, s[32:35], s82 offen lds
    v_mfma_f32_16x16x32_bf16 v[36:39], v[96:99], v[52:55], v[36:39]
    v_mfma_f32_16x16x32_bf16 v[40:43], v[96:99], v[56:59], v[40:43]
    s_add_u32 m0, s84, 38912
    s_mov_b64 exec, 0xffffffff
    buffer_load_dwordx4 v104, s[32:35], s82 offen lds
    s_mov_b64 exec, -1
    ds_read_b128 v[52:55], v111 offset:0
    ds_read_b128 v[56:59], v111 offset:2048
    s_waitcnt lgkmcnt(10)
    v_mfma_f32_16x16x32_bf16 v[4:7], v[60:63], v[44:47], v[4:7]
    ds_read_b64_tr_b16 v[80:81], v116 offset:10240
    ds_read_b64_tr_b16 v[82:83], v116 offset:12800
    v_mfma_f32_16x16x32_bf16 v[8:11], v[60:63], v[48:51], v[8:11]
    ds_read_b64_tr_b16 v[84:85], v116 offset:10280
    ds_read_b64_tr_b16 v[86:87], v116 offset:12840
    s_waitcnt lgkmcnt(12)
    v_mfma_f32_16x16x32_bf16 v[12:15], v[64:67], v[44:47], v[12:15]
    ds_read_b64_tr_b16 v[88:89], v116 offset:10320
    ds_read_b64_tr_b16 v[90:91], v116 offset:12880
    v_mfma_f32_16x16x32_bf16 v[16:19], v[64:67], v[48:51], v[16:19]
    ds_read_b64_tr_b16 v[92:93], v116 offset:10360
    ds_read_b64_tr_b16 v[94:95], v116 offset:12920
    s_waitcnt lgkmcnt(14)
    v_mfma_f32_16x16x32_bf16 v[20:23], v[68:71], v[44:47], v[20:23]
    ds_read_b64_tr_b16 v[96:97], v120 offset:10240
    ds_read_b64_tr_b16 v[98:99], v120 offset:12800
    v_mfma_f32_16x16x32_bf16 v[24:27], v[68:71], v[48:51], v[24:27]
    s_waitcnt lgkmcnt(14)
    v_mfma_f32_16x16x32_bf16 v[28:31], v[72:75], v[44:47], v[28:31]
    v_mfma_f32_16x16x32_bf16 v[32:35], v[72:75], v[48:51], v[32:35]
    s_waitcnt lgkmcnt(12)
    v_mfma_f32_16x16x32_bf16 v[36:39], v[76:79], v[44:47], v[36:39]
    v_mfma_f32_16x16x32_bf16 v[40:43], v[76:79], v[48:51], v[40:43]
    s_waitcnt lgkmcnt(0)
    s_waitcnt vmcnt(10)
    s_barrier
    v_and_b32 v135, 7, v0
    v_lshlrev_b32 v135, 2, v135
    buffer_load_dword v134, v135, s[40:43], 0 offen offset:128 sc1
    ds_read_b128 v[44:47], v112 offset:0
    ds_read_b128 v[48:51], v112 offset:2048
    v_mfma_f32_16x16x32_bf16 v[4:7], v[80:83], v[52:55], v[4:7]
    ds_read_b64_tr_b16 v[60:61], v117 offset:0
    ds_read_b64_tr_b16 v[62:63], v117 offset:2560
    v_mfma_f32_16x16x32_bf16 v[8:11], v[80:83], v[56:59], v[8:11]
    ds_read_b64_tr_b16 v[64:65], v117 offset:40
    ds_read_b64_tr_b16 v[66:67], v117 offset:2600
    v_mfma_f32_16x16x32_bf16 v[12:15], v[84:87], v[52:55], v[12:15]
    ds_read_b64_tr_b16 v[68:69], v117 offset:80
    ds_read_b64_tr_b16 v[70:71], v117 offset:2640
    v_mfma_f32_16x16x32_bf16 v[16:19], v[84:87], v[56:59], v[16:19]
    ds_read_b64_tr_b16 v[72:73], v117 offset:120
    ds_read_b64_tr_b16 v[74:75], v117 offset:2680
    v_mfma_f32_16x16x32_bf16 v[20:23], v[88:91], v[52:55], v[20:23]
    ds_read_b64_tr_b16 v[76:77], v121 offset:0
    ds_read_b64_tr_b16 v[78:79], v121 offset:2560
    v_mfma_f32_16x16x32_bf16 v[24:27], v[88:91], v[56:59], v[24:27]
    v_mfma_f32_16x16x32_bf16 v[28:31], v[92:95], v[52:55], v[28:31]
    v_mfma_f32_16x16x32_bf16 v[32:35], v[92:95], v[56:59], v[32:35]
    v_mfma_f32_16x16x32_bf16 v[36:39], v[96:99], v[52:55], v[36:39]
    v_mfma_f32_16x16x32_bf16 v[40:43], v[96:99], v[56:59], v[40:43]
    ds_read_b128 v[52:55], v113 offset:0
    ds_read_b128 v[56:59], v113 offset:2048
    s_waitcnt lgkmcnt(10)
    v_mfma_f32_16x16x32_bf16 v[4:7], v[60:63], v[44:47], v[4:7]
    ds_read_b64_tr_b16 v[80:81], v117 offset:10240
    ds_read_b64_tr_b16 v[82:83], v117 offset:12800
    v_mfma_f32_16x16x32_bf16 v[8:11], v[60:63], v[48:51], v[8:11]
    ds_read_b64_tr_b16 v[84:85], v117 offset:10280
    ds_read_b64_tr_b16 v[86:87], v117 offset:12840
    s_waitcnt lgkmcnt(12)
    v_mfma_f32_16x16x32_bf16 v[12:15], v[64:67], v[44:47], v[12:15]
    ds_read_b64_tr_b16 v[88:89], v117 offset:10320
    ds_read_b64_tr_b16 v[90:91], v117 offset:12880
    v_mfma_f32_16x16x32_bf16 v[16:19], v[64:67], v[48:51], v[16:19]
    ds_read_b64_tr_b16 v[92:93], v117 offset:10360
    ds_read_b64_tr_b16 v[94:95], v117 offset:12920
    s_waitcnt lgkmcnt(14)
    v_mfma_f32_16x16x32_bf16 v[20:23], v[68:71], v[44:47], v[20:23]
    ds_read_b64_tr_b16 v[96:97], v121 offset:10240
    ds_read_b64_tr_b16 v[98:99], v121 offset:12800
    v_mfma_f32_16x16x32_bf16 v[24:27], v[68:71], v[48:51], v[24:27]
    s_waitcnt lgkmcnt(14)
    v_mfma_f32_16x16x32_bf16 v[28:31], v[72:75], v[44:47], v[28:31]
    v_mfma_f32_16x16x32_bf16 v[32:35], v[72:75], v[48:51], v[32:35]
    s_waitcnt lgkmcnt(12)
    v_mfma_f32_16x16x32_bf16 v[36:39], v[76:79], v[44:47], v[36:39]
    v_mfma_f32_16x16x32_bf16 v[40:43], v[76:79], v[48:51], v[40:43]
    s_waitcnt lgkmcnt(0)
    s_waitcnt vmcnt(6)
    s_barrier
    ds_read_b128 v[44:47], v106 offset:0
    ds_read_b128 v[48:51], v106 offset:2048
    v_mfma_f32_16x16x32_bf16 v[4:7], v[80:83], v[52:55], v[4:7]
    ds_read_b64_tr_b16 v[60:61], v114 offset:0
    ds_read_b64_tr_b16 v[62:63], v114 offset:2560
    v_mfma_f32_16x16x32_bf16 v[8:11], v[80:83], v[56:59], v[8:11]
    ds_read_b64_tr_b16 v[64:65], v114 offset:40
    ds_read_b64_tr_b16 v[66:67], v114 offset:2600
    v_mfma_f32_16x16x32_bf16 v[12:15], v[84:87], v[52:55], v[12:15]
    ds_read_b64_tr_b16 v[68:69], v114 offset:80
    ds_read_b64_tr_b16 v[70:71], v114 offset:2640
    v_mfma_f32_16x16x32_bf16 v[16:19], v[84:87], v[56:59], v[16:19]
    ds_read_b64_tr_b16 v[72:73], v114 offset:120
    ds_read_b64_tr_b16 v[74:75], v114 offset:2680
    v_mfma_f32_16x16x32_bf16 v[20:23], v[88:91], v[52:55], v[20:23]
    ds_read_b64_tr_b16 v[76:77], v118 offset:0
    ds_read_b64_tr_b16 v[78:79], v118 offset:2560
    v_mfma_f32_16x16x32_bf16 v[24:27], v[88:91], v[56:59], v[24:27]
    v_mfma_f32_16x16x32_bf16 v[28:31], v[92:95], v[52:55], v[28:31]
    v_mfma_f32_16x16x32_bf16 v[32:35], v[92:95], v[56:59], v[32:35]
    v_mfma_f32_16x16x32_bf16 v[36:39], v[96:99], v[52:55], v[36:39]
    v_mfma_f32_16x16x32_bf16 v[40:43], v[96:99], v[56:59], v[40:43]
    ds_read_b128 v[52:55], v107 offset:0
    ds_read_b128 v[56:59], v107 offset:2048
    s_waitcnt lgkmcnt(10)
    v_mfma_f32_16x16x32_bf16 v[4:7], v[60:63], v[44:47], v[4:7]
    ds_read_b64_tr_b16 v[80:81], v114 offset:10240
    ds_read_b64_tr_b16 v[82:83], v114 offset:12800
    v_mfma_f32_16x16x32_bf16 v[8:11], v[60:63], v[48:51], v[8:11]
    ds_read_b64_tr_b16 v[84:85], v114 offset:10280
    ds_read_b64_tr_b16 v[86:87], v114 offset:12840
    s_waitcnt lgkmcnt(12)
    v_mfma_f32_16x16x32_bf16 v[12:15], v[64:67], v[44:47], v[12:15]
    ds_read_b64_tr_b16 v[88:89], v114 offset:10320
    ds_read_b64_tr_b16 v[90:91], v114 offset:12880
    v_mfma_f32_16x16x32_bf16 v[16:19], v[64:67], v[48:51], v[16:19]
    ds_read_b64_tr_b16 v[92:93], v114 offset:10360
    ds_read_b64_tr_b16 v[94:95], v114 offset:12920
    s_waitcnt lgkmcnt(14)
    v_mfma_f32_16x16x32_bf16 v[20:23], v[68:71], v[44:47], v[20:23]
    ds_read_b64_tr_b16 v[96:97], v118 offset:10240
    ds_read_b64_tr_b16 v[98:99], v118 offset:12800
    v_mfma_f32_16x16x32_bf16 v[24:27], v[68:71], v[48:51], v[24:27]
    s_waitcnt lgkmcnt(14)
    v_mfma_f32_16x16x32_bf16 v[28:31], v[72:75], v[44:47], v[28:31]
    v_mfma_f32_16x16x32_bf16 v[32:35], v[72:75], v[48:51], v[32:35]
    s_waitcnt lgkmcnt(12)
    v_mfma_f32_16x16x32_bf16 v[36:39], v[76:79], v[44:47], v[36:39]
    v_mfma_f32_16x16x32_bf16 v[40:43], v[76:79], v[48:51], v[40:43]
    s_waitcnt lgkmcnt(0)
    s_waitcnt vmcnt(1)
    s_barrier
    ds_read_b128 v[44:47], v108 offset:0
    ds_read_b128 v[48:51], v108 offset:2048
    v_mfma_f32_16x16x32_bf16 v[4:7], v[80:83], v[52:55], v[4:7]
    ds_read_b64_tr_b16 v[60:61], v115 offset:0
    ds_read_b64_tr_b16 v[62:63], v115 offset:2560
    v_mfma_f32_16x16x32_bf16 v[8:11], v[80:83], v[56:59], v[8:11]
    ds_read_b64_tr_b16 v[64:65], v115 offset:40
    ds_read_b64_tr_b16 v[66:67], v115 offset:2600
    v_mfma_f32_16x16x32_bf16 v[12:15], v[84:87], v[52:55], v[12:15]
    ds_read_b64_tr_b16 v[68:69], v115 offset:80
    ds_read_b64_tr_b16 v[70:71], v115 offset:2640
    v_mfma_f32_16x16x32_bf16 v[16:19], v[84:87], v[56:59], v[16:19]
    ds_read_b64_tr_b16 v[72:73], v115 offset:120
    ds_read_b64_tr_b16 v[74:75], v115 offset:2680
    v_mfma_f32_16x16x32_bf16 v[20:23], v[88:91], v[52:55], v[20:23]
    ds_read_b64_tr_b16 v[76:77], v119 offset:0
    ds_read_b64_tr_b16 v[78:79], v119 offset:2560
    v_mfma_f32_16x16x32_bf16 v[24:27], v[88:91], v[56:59], v[24:27]
    v_mfma_f32_16x16x32_bf16 v[28:31], v[92:95], v[52:55], v[28:31]
    v_mfma_f32_16x16x32_bf16 v[32:35], v[92:95], v[56:59], v[32:35]
    v_mfma_f32_16x16x32_bf16 v[36:39], v[96:99], v[52:55], v[36:39]
    v_mfma_f32_16x16x32_bf16 v[40:43], v[96:99], v[56:59], v[40:43]
    ds_read_b128 v[52:55], v109 offset:0
    ds_read_b128 v[56:59], v109 offset:2048
    s_waitcnt lgkmcnt(10)
    v_mfma_f32_16x16x32_bf16 v[4:7], v[60:63], v[44:47], v[4:7]
    ds_read_b64_tr_b16 v[80:81], v115 offset:10240
    ds_read_b64_tr_b16 v[82:83], v115 offset:12800
    v_mfma_f32_16x16x32_bf16 v[8:11], v[60:63], v[48:51], v[8:11]
    ds_read_b64_tr_b16 v[84:85], v115 offset:10280
    ds_read_b64_tr_b16 v[86:87], v115 offset:12840
    s_waitcnt lgkmcnt(12)
    v_mfma_f32_16x16x32_bf16 v[12:15], v[64:67], v[44:47], v[12:15]
    ds_read_b64_tr_b16 v[88:89], v115 offset:10320
    ds_read_b64_tr_b16 v[90:91], v115 offset:12880
    v_mfma_f32_16x16x32_bf16 v[16:19], v[64:67], v[48:51], v[16:19]
    ds_read_b64_tr_b16 v[92:93], v115 offset:10360
    ds_read_b64_tr_b16 v[94:95], v115 offset:12920
    s_waitcnt lgkmcnt(14)
    v_mfma_f32_16x16x32_bf16 v[20:23], v[68:71], v[44:47], v[20:23]
    ds_read_b64_tr_b16 v[96:97], v119 offset:10240
    ds_read_b64_tr_b16 v[98:99], v119 offset:12800
    v_mfma_f32_16x16x32_bf16 v[24:27], v[68:71], v[48:51], v[24:27]
    s_waitcnt lgkmcnt(14)
    v_mfma_f32_16x16x32_bf16 v[28:31], v[72:75], v[44:47], v[28:31]
    v_mfma_f32_16x16x32_bf16 v[32:35], v[72:75], v[48:51], v[32:35]
    s_waitcnt lgkmcnt(12)
    v_mfma_f32_16x16x32_bf16 v[36:39], v[76:79], v[44:47], v[36:39]
    v_mfma_f32_16x16x32_bf16 v[40:43], v[76:79], v[48:51], v[40:43]
    s_waitcnt lgkmcnt(8)
    v_mfma_f32_16x16x32_bf16 v[4:7], v[80:83], v[52:55], v[4:7]
    v_mfma_f32_16x16x32_bf16 v[8:11], v[80:83], v[56:59], v[8:11]
    s_waitcnt lgkmcnt(6)
    v_mfma_f32_16x16x32_bf16 v[12:15], v[84:87], v[52:55], v[12:15]
    v_mfma_f32_16x16x32_bf16 v[16:19], v[84:87], v[56:59], v[16:19]
    s_waitcnt lgkmcnt(4)
    v_mfma_f32_16x16x32_bf16 v[20:23], v[88:91], v[52:55], v[20:23]
    v_mfma_f32_16x16x32_bf16 v[24:27], v[88:91], v[56:59], v[24:27]
    s_waitcnt lgkmcnt(2)
    v_mfma_f32_16x16x32_bf16 v[28:31], v[92:95], v[52:55], v[28:31]
    v_mfma_f32_16x16x32_bf16 v[32:35], v[92:95], v[56:59], v[32:35]
    s_waitcnt lgkmcnt(0)
    v_mfma_f32_16x16x32_bf16 v[36:39], v[96:99], v[52:55], v[36:39]
    v_mfma_f32_16x16x32_bf16 v[40:43], v[96:99], v[56:59], v[40:43]
    s_waitcnt vmcnt(0)
    v_cmp_ne_u32 vcc, 1, v134
    s_cmp_eq_u64 vcc, 0
    s_cbranch_scc1 L13
    s_mov_b32 s95, 0x8000
L14:
    s_sub_u32 s95, s95, 1
    s_cbranch_scc1 L13
    s_sleep 2
    buffer_load_dword v134, v135, s[40:43], 0 offen offset:128 sc1
    s_waitcnt vmcnt(0)
    v_cmp_ne_u32 vcc, 1, v134
    s_cmp_eq_u64 vcc, 0
    s_cbranch_scc0 L14
L13:
    s_and_b32 s101, s2, 15
    s_lshl_b32 s101, s101, 9
    s_add_u32 s101, s101, 0xc34000
    v_and_b32 v145, 7, v0
    v_lshlrev_b32 v145, 6, v145
    buffer_load_dword v144, v145, s[36:39], s101 offen sc1
    v_mul_f32 v60, s85, v4
    v_mul_f32 v61, s85, v5
    v_mul_f32 v62, s85, v6
    v_mul_f32 v63, s85, v7
    v_exp_f32_e64 v60, v60 clamp
    v_exp_f32_e64 v61, v61 clamp
    v_exp_f32_e64 v62, v62 clamp
    v_exp_f32_e64 v63, v63 clamp
    v_max_f32 v4, s86, v4
    v_max_f32 v5, s86, v5
    v_max_f32 v6, s86, v6
    v_max_f32 v7, s86, v7
    v_add_f32 v4, v4, v60
    v_add_f32 v5, v5, v61
    v_add_f32 v6, v6, v62
    v_add_f32 v7, v7, v63
    v_mul_f32 v64, s85, v12
    v_mul_f32 v65, s85, v13
    v_mul_f32 v66, s85, v14
    v_mul_f32 v67, s85, v15
    v_exp_f32_e64 v64, v64 clamp
    v_exp_f32_e64 v65, v65 clamp
    v_exp_f32_e64 v66, v66 clamp
    v_exp_f32_e64 v67, v67 clamp
    v_max_f32 v12, s86, v12
    v_max_f32 v13, s86, v13
    v_max_f32 v14, s86, v14
    v_max_f32 v15, s86, v15
    v_add_f32 v12, v12, v64
    v_add_f32 v13, v13, v65
    v_add_f32 v14, v14, v66
    v_add_f32 v15, v15, v67
    v_mul_f32 v68, s85, v20
    v_mul_f32 v69, s85, v21
    v_mul_f32 v70, s85, v22
    v_mul_f32 v71, s85, v23
    v_exp_f32_e64 v68, v68 clamp
    v_exp_f32_e64 v69, v69 clamp
    v_exp_f32_e64 v70, v70 clamp
    v_exp_f32_e64 v71, v71 clamp
    v_max_f32 v20, s86, v20
    v_max_f32 v21, s86, v21
    v_max_f32 v22, s86, v22
    v_max_f32 v23, s86, v23
    v_add_f32 v20, v20, v68
    v_add_f32 v21, v21, v69
    v_add_f32 v22, v22, v70
    v_add_f32 v23, v23, v71
    v_mul_f32 v72, s85, v28
    v_mul_f32 v73, s85, v29
    v_mul_f32 v74, s85, v30
    v_mul_f32 v75, s85, v31
    v_exp_f32_e64 v72, v72 clamp
    v_exp_f32_e64 v73, v73 clamp
    v_exp_f32_e64 v74, v74 clamp
    v_exp_f32_e64 v75, v75 clamp
    v_max_f32 v28, s86, v28
    v_max_f32 v29, s86, v29
    v_max_f32 v30, s86, v30
    v_max_f32 v31, s86, v31
    v_add_f32 v28, v28, v72
    v_add_f32 v29, v29, v73
    v_add_f32 v30, v30, v74
    v_add_f32 v31, v31, v75
    v_mul_f32 v76, s85, v36
    v_mul_f32 v77, s85, v37
    v_mul_f32 v78, s85, v38
    v_mul_f32 v79, s85, v39
    v_exp_f32_e64 v76, v76 clamp
    v_exp_f32_e64 v77, v77 clamp
    v_exp_f32_e64 v78, v78 clamp
    v_exp_f32_e64 v79, v79 clamp
    v_max_f32 v36, s86, v36
    v_max_f32 v37, s86, v37
    v_max_f32 v38, s86, v38
    v_max_f32 v39, s86, v39
    v_add_f32 v36, v36, v76
    v_add_f32 v37, v37, v77
    v_add_f32 v38, v38, v78
    v_add_f32 v39, v39, v79
    s_nop 0
    v_permlane32_swap_b32 v36, v38
    v_permlane32_swap_b32 v37, v39
    s_nop 1
    v_permlane16_swap_b32 v36, v37
    v_permlane16_swap_b32 v38, v39
    v_cvt_pk_bf16_f32 v80, v4, v5
    v_cvt_pk_bf16_f32 v81, v6, v7
    v_cvt_pk_bf16_f32 v83, v12, v13
    v_cvt_pk_bf16_f32 v84, v14, v15
    v_cvt_pk_bf16_f32 v85, v20, v21
    v_cvt_pk_bf16_f32 v86, v22, v23
    v_cvt_pk_bf16_f32 v88, v28, v29
    v_cvt_pk_bf16_f32 v89, v30, v31
    v_cvt_pk_bf16_f32 v82, v36, v37
    v_cvt_pk_bf16_f32 v87, v38, v39
    v_mul_f32 v60, s85, v8
    v_mul_f32 v61, s85, v9
    v_mul_f32 v62, s85, v10
    v_mul_f32 v63, s85, v11
    v_exp_f32_e64 v60, v60 clamp
    v_exp_f32_e64 v61, v61 clamp
    v_exp_f32_e64 v62, v62 clamp
    v_exp_f32_e64 v63, v63 clamp
    v_max_f32 v8, s86, v8
    v_max_f32 v9, s86, v9
    v_max_f32 v10, s86, v10
    v_max_f32 v11, s86, v11
    v_add_f32 v8, v8, v60
    v_add_f32 v9, v9, v61
    v_add_f32 v10, v10, v62
    v_add_f32 v11, v11, v63
    v_mul_f32 v64, s85, v16
    v_mul_f32 v65, s85, v17
    v_mul_f32 v66, s85, v18
    v_mul_f32 v67, s85, v19
    v_exp_f32_e64 v64, v64 clamp
    v_exp_f32_e64 v65, v65 clamp
    v_exp_f32_e64 v66, v66 clamp
    v_exp_f32_e64 v67, v67 clamp
    v_max_f32 v16, s86, v16
    v_max_f32 v17, s86, v17
    v_max_f32 v18, s86, v18
    v_max_f32 v19, s86, v19
    v_add_f32 v16, v16, v64
    v_add_f32 v17, v17, v65
    v_add_f32 v18, v18, v66
    v_add_f32 v19, v19, v67
    v_mul_f32 v68, s85, v24
    v_mul_f32 v69, s85, v25
    v_mul_f32 v70, s85, v26
    v_mul_f32 v71, s85, v27
    v_exp_f32_e64 v68, v68 clamp
    v_exp_f32_e64 v69, v69 clamp
    v_exp_f32_e64 v70, v70 clamp
    v_exp_f32_e64 v71, v71 clamp
    v_max_f32 v24, s86, v24
    v_max_f32 v25, s86, v25
    v_max_f32 v26, s86, v26
    v_max_f32 v27, s86, v27
    v_add_f32 v24, v24, v68
    v_add_f32 v25, v25, v69
    v_add_f32 v26, v26, v70
    v_add_f32 v27, v27, v71
    v_mul_f32 v72, s85, v32
    v_mul_f32 v73, s85, v33
    v_mul_f32 v74, s85, v34
    v_mul_f32 v75, s85, v35
    v_exp_f32_e64 v72, v72 clamp
    v_exp_f32_e64 v73, v73 clamp
    v_exp_f32_e64 v74, v74 clamp
    v_exp_f32_e64 v75, v75 clamp
    v_max_f32 v32, s86, v32
    v_max_f32 v33, s86, v33
    v_max_f32 v34, s86, v34
    v_max_f32 v35, s86, v35
    v_add_f32 v32, v32, v72
    v_add_f32 v33, v33, v73
    v_add_f32 v34, v34, v74
    v_add_f32 v35, v35, v75
    v_mul_f32 v76, s85, v40
    v_mul_f32 v77, s85, v41
    v_mul_f32 v78, s85, v42
    v_mul_f32 v79, s85, v43
    v_exp_f32_e64 v76, v76 clamp
    v_exp_f32_e64 v77, v77 clamp
    v_exp_f32_e64 v78, v78 clamp
    v_exp_f32_e64 v79, v79 clamp
    v_max_f32 v40, s86, v40
    v_max_f32 v41, s86, v41
    v_max_f32 v42, s86, v42
    v_max_f32 v43, s86, v43
    v_add_f32 v40, v40, v76
    v_add_f32 v41, v41, v77
    v_add_f32 v42, v42, v78
    v_add_f32 v43, v43, v79
    s_nop 0
    v_permlane32_swap_b32 v40, v42
    v_permlane32_swap_b32 v41, v43
    s_nop 1
    v_permlane16_swap_b32 v40, v41
    v_permlane16_swap_b32 v42, v43
    v_cvt_pk_bf16_f32 v90, v8, v9
    v_cvt_pk_bf16_f32 v91, v10, v11
    v_cvt_pk_bf16_f32 v93, v16, v17
    v_cvt_pk_bf16_f32 v94, v18, v19
    v_cvt_pk_bf16_f32 v95, v24, v25
    v_cvt_pk_bf16_f32 v96, v26, v27
    v_cvt_pk_bf16_f32 v98, v32, v33
    v_cvt_pk_bf16_f32 v99, v34, v35
    v_cvt_pk_bf16_f32 v92, v40, v41
    v_cvt_pk_bf16_f32 v97, v42, v43
    v_mov_b32 v145, 0
    ds_write_b32 v145, v145 offset:0
    ds_write_b32 v145, v145 offset:4
    ds_write_b32 v145, v145 offset:8
    ds_write_b32 v145, v145 offset:12
    ds_write_b32 v145, v145 offset:16
    s_waitcnt vmcnt(0)
    v_cmp_ne_u32 vcc, 8, v144
    s_cmp_eq_u64 vcc, 0
    s_cselect_b32 s101, 64, 0
    s_mov_b32 s74, 20480
    buffer_store_dwordx4 v[80:83], v130, s[36:39], 0 offen sc1
    buffer_store_dwordx4 v[84:87], v130, s[36:39], 0 offen offset:1024 sc1
    buffer_store_dwordx2 v[88:89], v132, s[36:39], 0 offen offset:2048 sc1
    buffer_store_dwordx4 v[90:93], v130, s[36:39], s74 offen sc1
    buffer_store_dwordx4 v[94:97], v130, s[36:39], s74 offen offset:1024 sc1
    buffer_store_dwordx2 v[98:99], v132, s[36:39], s74 offen offset:2048 sc1
    s_lshl_b32 s79, s4, 3
    s_lshl_b32 s78, s91, 1
    s_add_u32 s78, s79, s78
    s_lshl_b32 s78, s78, 6
    s_add_u32 s89, s78, 0xc30000
    s_waitcnt vmcnt(0) lgkmcnt(0)
    s_barrier
    s_cmp_lg_u32 s3, 7
    s_cbranch_scc1 L15
    v_mov_b32 v123, 1
    v_mov_b32 v122, 0
    s_mov_b64 exec, 1
    buffer_store_dword v123, v122, s[36:39], s89 offen sc1
    s_mov_b64 exec, -1
L15:
    s_and_b32 s79, s2, 7
    s_lshl_b32 s79, s79, 2
    s_lshr_b32 s78, s2, 3
    s_and_b32 s78, s78, 3
    s_add_u32 s4, s79, s78
    s_lshr_b32 s5, s2, 5
    s_mov_b32 s100, 0
    s_cmp_lt_u32 s3, 4
    s_cbranch_scc1 FINAL_A
    s_branch FINAL_D
K1_F:
    s_and_b32 s80, s3, 3
    s_lshr_b32 s84, s3, 2
    s_sub_u32 s83, s2, 0xc0
    s_and_b32 s79, s83, 3
    s_lshl_b32 s79, s79, 4
    s_lshr_b32 s78, s83, 2
    s_and_b32 s78, s78, 1
    s_lshl_b32 s78, s78, 3
    s_add_u32 s78, s79, s78
    s_lshr_b32 s79, s83, 3
    s_add_u32 s81, s78, s79
    s_lshr_b32 s82, s83, 1
    s_and_b32 s7, s83, 1
    v_lshlrev_b32 v6, 4, v0
    v_lshlrev_b32 v15, 4, v0
    v_add_u32 v7, 0x400, v15
    s_lshl_b32 s79, s3, 8
    s_add_u32 s79, s79, s81
    s_mul_i32 s85, s79, 0x500
    s_mul_i32 s79, s3, 0x1440
    s_add_u32 s87, s79, 0x600
    v_lshlrev_b32 v12, 2, v0
    v_mov_b32 v20, 0
    ds_write_b32 v12, v20
    s_getpc_b64 s[92:93]
L16:
    s_add_u32 s92, s92, F_TAB-L16
    s_addc_u32 s93, s93, 0
    s_mov_b32 s32, s92
    s_and_b32 s33, s93, 0xffff
    s_mov_b32 s34, 0x7800
    s_mov_b32 s35, 0x20000
    s_waitcnt lgkmcnt(0)
    s_mov_b32 s28, s8
    s_and_b32 s29, s9, 0xffff
    s_mov_b32 s30, 0x280000
    s_mov_b32 s31, 0x20000
    s_add_u32 m0, s87, 0
    s_add_u32 s88, s85, 0
    buffer_load_dwordx4 v6, s[28:31], s88 offen lds
    s_add_u32 m0, s87, 1296
    s_add_u32 s88, s85, 81920
    buffer_load_dwordx4 v6, s[28:31], s88 offen lds
    s_add_u32 m0, s87, 2592
    s_add_u32 s88, s85, 163840
    buffer_load_dwordx4 v6, s[28:31], s88 offen lds
    s_add_u32 m0, s87, 3888
    s_add_u32 s88, s85, 245760
    buffer_load_dwordx4 v6, s[28:31], s88 offen lds
    s_mov_b64 exec, 0xffff
    s_add_u32 m0, s87, 1024
    s_add_u32 s88, s85, 0
    buffer_load_dwordx4 v7, s[28:31], s88 offen lds
    s_add_u32 m0, s87, 2320
    s_add_u32 s88, s85, 81920
    buffer_load_dwordx4 v7, s[28:31], s88 offen lds
    s_add_u32 m0, s87, 3616
    s_add_u32 s88, s85, 163840
    buffer_load_dwordx4 v7, s[28:31], s88 offen lds
    s_add_u32 m0, s87, 4912
    s_add_u32 s88, s85, 245760
    buffer_load_dwordx4 v7, s[28:31], s88 offen lds
    s_mov_b64 exec, -1
    s_barrier
    s_mov_b32 s56, s20
    s_and_b32 s57, s21, 0xffff
    s_mov_b32 s58, 0x500
    s_mov_b32 s59, 0x20000
    s_cmp_eq_u32 s3, 7
    s_cselect_b32 s52, s56, s32
    s_cselect_b32 s53, s57, s33
    s_cselect_b32 s54, s58, s34
    s_mov_b32 s55, 0x20000
    s_lshl_b32 s88, s3, 11
    s_lshl_b32 s79, s3, 11
    s_add_u32 s89, s79, 0x20520
    s_cmp_eq_u32 s3, 7
    s_cselect_b32 s88, 0, s88
    s_cselect_b32 s89, 256, s89
    s_mov_b32 m0, s89
    s_nop 0
    buffer_load_dwordx4 v6, s[52:55], s88 offen lds
    s_cselect_b64 exec, 0xffff, -1
    s_add_u32 m0, s89, 1024
    s_nop 0
    buffer_load_dwordx4 v7, s[52:55], s88 offen lds
    s_mov_b64 exec, -1
    s_lshl_b32 s79, s83, 3
    s_add_u32 s79, s79, s3
    s_mul_i32 s79, s79, 0xcd
    s_lshr_b32 s4, s79, 10
    s_lshl_b32 s79, s83, 3
    s_add_u32 s79, s79, s3
    s_mul_i32 s78, s4, 5
    s_sub_u32 s6, s79, s78
    s_min_u32 s5, s4, 79
    s_mov_b32 s60, s12
    s_and_b32 s61, s13, 0xffff
    s_mov_b32 s62, 0xc8000
    s_mov_b32 s63, 0x20000
    s_mul_i32 s79, s5, 0xcd
    s_lshr_b32 s79, s79, 12
    s_mul_i32 s87, s79, 0x32000
    s_mul_i32 s79, s5, 0xcd
    s_lshr_b32 s79, s79, 12
    s_mul_i32 s79, s79, 20
    s_sub_u32 s79, s5, s79
    s_lshl_b32 s86, s79, 4
    v_and_b32 v15, 15, v0
    v_add_u32 v18, s86, v15
    v_mul_u32_u24 v15, 0xcd, v18
    v_lshrrev_b32 v19, 12, v15
    v_and_b32 v15, 1, v19
    v_mul_u32_u24 v15, 0x230, v15
    v_lshl_add_u32 v15, v18, 2, v15
    v_lshrrev_b32 v14, 1, v19
    v_mul_u32_u24 v14, 0x50, v14
    v_sub_u32 v14, v15, v14
    v_add_u32 v38, s87, v14
    v_lshrrev_b32 v18, 4, v0
    s_mov_b32 s100, 0x16510080
    s_mov_b32 s101, 0xfbce2aa
    s_mov_b32 s36, s26
    s_and_b32 s37, s27, 0xffff
    s_mov_b32 s38, 0xc40000
    s_mov_b32 s39, 0x20000
    s_mov_b32 s40, s24
    s_and_b32 s41, s25, 0xffff
    s_mov_b32 s42, 0x100
    s_mov_b32 s43, 0x20000
    v_mov_b32 v244, -1
    v_mov_b32 v245, -1
    v_mov_b32 v246, -1
    v_mov_b32 v247, -1
    v_and_b32 v15, 3, v0
    v_lshrrev_b32 v14, 2, v0
    v_mul_u32_u24 v14, 0x16580, v14
    v_lshl_add_u32 v24, v15, 4, v14
    s_and_b32 s79, s81, 1
    s_lshl_b32 s79, s79, 5
    s_lshr_b32 s78, s81, 1
    s_add_u32 s78, s79, s78
    s_lshl_b32 s78, s78, 6
    s_mul_i32 s79, s3, 0x1100
    s_add_u32 s79, s78, s79
    s_add_u32 s96, s79, 0x280000
    s_add_u32 s97, s96, 34816
    s_add_u32 s98, s96, 69632
    s_cmp_lt_u32 s3, 5
    s_cselect_b32 s98, s98, 0x40000000
    s_cmp_eq_u32 s84, 0
    s_cselect_b32 s88, s16, s18
    s_cselect_b32 s89, s17, s19
    s_mov_b32 s44, s88
    s_and_b32 s45, s89, 0xffff
    s_mov_b32 s46, 0x141000
    s_mov_b32 s47, 0x20000
    v_mul_u32_u24 v32, 49, v0
    v_lshrrev_b32 v32, 10, v32
    v_mul_u32_u24 v32, 20208, v32
    v_add_u32 v32, v32, v6
    s_cmp_ge_u32 s3, 4
    s_cbranch_scc1 L17
    s_lshl_b32 s74, s6, 2
    s_add_u32 s74, s74, 0
    s_cmp_ge_u32 s74, 10
    s_cselect_b32 s75, 80, 0
    s_cselect_b32 s76, 10, 0
    s_sub_u32 s74, s74, s76
    s_mul_i32 s76, s74, 6
    s_lshr_b64 s[78:79], s[100:101], s76
    s_and_b32 s78, s78, 63
    s_add_u32 s78, s78, s75
    s_bitcmp1_b32 0x84, s74
    s_cselect_b32 s75, 20, 1
    s_cselect_b32 s76, 1, 4
    s_add_u32 s79, s78, s75
    s_mul_i32 s78, s78, 1280
    s_mul_i32 s79, s79, 1280
    s_mul_i32 s76, s76, 1280
    v_mad_u32_u24 v204, v18, s76, v38
    buffer_load_dword v236, v204, s[60:63], s78 offen
    buffer_load_dword v237, v204, s[60:63], s79 offen
    s_lshl_b32 s74, s6, 2
    s_add_u32 s74, s74, 1
    s_cmp_ge_u32 s74, 10
    s_cselect_b32 s75, 80, 0
    s_cselect_b32 s76, 10, 0
    s_sub_u32 s74, s74, s76
    s_mul_i32 s76, s74, 6
    s_lshr_b64 s[78:79], s[100:101], s76
    s_and_b32 s78, s78, 63
    s_add_u32 s78, s78, s75
    s_bitcmp1_b32 0x84, s74
    s_cselect_b32 s75, 20, 1
    s_cselect_b32 s76, 1, 4
    s_add_u32 s79, s78, s75
    s_mul_i32 s78, s78, 1280
    s_mul_i32 s79, s79, 1280
    s_mul_i32 s76, s76, 1280
    v_mad_u32_u24 v205, v18, s76, v38
    buffer_load_dword v238, v205, s[60:63], s78 offen
    buffer_load_dword v239, v205, s[60:63], s79 offen
    s_lshl_b32 s74, s6, 2
    s_add_u32 s74, s74, 2
    s_cmp_ge_u32 s74, 10
    s_cselect_b32 s75, 80, 0
    s_cselect_b32 s76, 10, 0
    s_sub_u32 s74, s74, s76
    s_mul_i32 s76, s74, 6
    s_lshr_b64 s[78:79], s[100:101], s76
    s_and_b32 s78, s78, 63
    s_add_u32 s78, s78, s75
    s_bitcmp1_b32 0x84, s74
    s_cselect_b32 s75, 20, 1
    s_cselect_b32 s76, 1, 4
    s_add_u32 s79, s78, s75
    s_mul_i32 s78, s78, 1280
    s_mul_i32 s79, s79, 1280
    s_mul_i32 s76, s76, 1280
    v_mad_u32_u24 v206, v18, s76, v38
    buffer_load_dword v240, v206, s[60:63], s78 offen
    buffer_load_dword v241, v206, s[60:63], s79 offen
    s_lshl_b32 s74, s6, 2
    s_add_u32 s74, s74, 3
    s_cmp_ge_u32 s74, 10
    s_cselect_b32 s75, 80, 0
    s_cselect_b32 s76, 10, 0
    s_sub_u32 s74, s74, s76
    s_mul_i32 s76, s74, 6
    s_lshr_b64 s[78:79], s[100:101], s76
    s_and_b32 s78, s78, 63
    s_add_u32 s78, s78, s75
    s_bitcmp1_b32 0x84, s74
    s_cselect_b32 s75, 20, 1
    s_cselect_b32 s76, 1, 4
    s_add_u32 s79, s78, s75
    s_mul_i32 s78, s78, 1280
    s_mul_i32 s79, s79, 1280
    s_mul_i32 s76, s76, 1280
    v_mad_u32_u24 v207, v18, s76, v38
    buffer_load_dword v242, v207, s[60:63], s78 offen
    buffer_load_dword v243, v207, s[60:63], s79 offen
    v_and_b32 v15, 15, v0
    v_lshrrev_b32 v14, 4, v0
    v_mul_u32_u24 v14, 0xa0, v14
    v_add_u32 v14, v15, v14
    v_mul_u32_u24 v14, 0x90, v14
    s_lshl_b32 s79, s80, 4
    s_mul_i32 s78, s84, 0x900
    s_add_u32 s78, s79, s78
    s_add_u32 s78, s78, 0x15000
    v_add_u32 v2, s78, v14
    s_lshl_b32 s79, s80, 5
    s_add_u32 s74, s79, 0x40800
    v_add_u32 v5, 17280, v2
    v_sub_u32 v189, s74, v5
    v_min_u32 v5, v5, v189
    v_add_u32 v4, 11520, v2
    v_sub_u32 v188, s74, v4
    v_min_u32 v4, v4, v188
    v_add_u32 v3, 5760, v2
    v_sub_u32 v189, s74, v3
    v_min_u32 v3, v3, v189
    v_sub_u32 v188, s74, v2
    v_min_u32 v2, v2, v188
    s_cmp_eq_u32 s84, 0
    s_mov_b32 s48, 0x1f001f
    s_cselect_b32 s48, 0xffffffff, s48
    s_mov_b32 s49, 0xf000f
    s_cselect_b32 s49, 0xfffeffff, s49
    s_mov_b32 s50, 0x1f001f
    s_cselect_b32 s50, 0xffffffff, s50
    s_mov_b32 s51, 0xf000f
    s_cselect_b32 s51, 0xfffefffe, s51
    s_mov_b32 s56, 0x1f001f
    s_cselect_b32 s56, 0xffffffff, s56
    s_mov_b32 s57, 0xf000f
    s_cselect_b32 s57, 0xfffefffe, s57
    s_mov_b32 s58, 0x1f001f
    s_cselect_b32 s58, 0xffffffff, s58
    s_mov_b32 s59, 0xf000f
    s_cselect_b32 s59, 0xfffefffe, s59
    v_lshrrev_b32 v15, 5, v0
    v_lshrrev_b32 v14, 4, v0
    v_and_b32 v14, 1, v14
    v_lshrrev_b32 v13, 2, v0
    v_and_b32 v13, 3, v13
    v_lshl_add_u32 v13, v14, 2, v13
    v_lshl_add_u32 v13, v15, 4, v13
    v_and_b32 v15, 3, v0
    v_lshlrev_b32 v15, 3, v15
    v_lshl_add_u32 v15, v13, 5, v15
    s_mul_i32 s79, s80, 0x2880
    s_add_u32 s79, s79, 0x600
    v_add_u32 v8, s79, v15
    v_lshrrev_b32 v15, 4, v0
    v_and_b32 v15, 1, v15
    v_lshrrev_b32 v14, 2, v0
    v_and_b32 v14, 3, v14
    v_lshl_add_u32 v14, v15, 2, v14
    v_and_b32 v15, 3, v0
    v_lshlrev_b32 v15, 3, v15
    v_lshl_add_u32 v15, v14, 5, v15
    s_mul_i32 s79, s80, 0x2880
    s_add_u32 s79, s79, 0xa00
    v_add_u32 v9, s79, v15
    v_lshrrev_b32 v15, 4, v0
    s_and_b32 s79, s3, 1
    s_lshl_b32 s79, s79, 4
    v_and_b32 v14, 15, v0
    v_add_u32 v14, s79, v14
    v_mul_u32_u24 v14, 0x510, v14
    v_lshl_add_u32 v14, v15, 4, v14
    s_lshr_b32 s79, s3, 1
    s_mul_i32 s79, s79, 0x140
    s_add_u32 s79, s79, 0x600
    v_add_u32 v192, s79, v14
    v_lshrrev_b32 v15, 4, v0
    s_lshr_b32 s79, s3, 1
    s_mul_i32 s79, s79, 0x140
    s_add_u32 s79, s79, 0x100
    v_lshl_add_u32 v193, v15, 4, s79
    s_mul_i32 s79, s84, 0x1800
    s_add_u32 s79, s79, 0x20520
    v_lshl_add_u32 v11, v0, 4, s79
    v_lshlrev_b32 v15, 4, v0
    v_add_u32 v10, 0x23520, v15
    v_mov_b32 v20, 0
    v_mov_b32 v21, 0
    v_mov_b32 v22, 0
    v_mov_b32 v23, 0
    v_and_b32 v15, 7, v0
    v_lshlrev_b32 v15, 4, v15
    v_add_u32 v16, 0x20490, v15
    ds_write_b128 v16, v[20:23]
    v_lshrrev_b32 v15, 4, v0
    s_lshl_b32 s79, s3, 6
    s_add_u32 s79, s79, s81
    v_lshl_add_u32 v15, v15, 9, s79
    v_and_b32 v16, 15, v0
    v_mul_u32_u24 v92, v16, v15
    v_lshl_add_u32 v93, v15, 4, v92
    s_lshl_b32 s79, s3, 1
    s_add_u32 s74, s79, 0x19000
    v_add_u32 v100, s74, v6
    v_add_u32 v19, 102400, v6
    v_cvt_f32_u32 v92, v92
    v_cvt_f32_u32 v93, v93
    v_mul_f32 v92, 0x3a000000, v92
    v_mul_f32 v93, 0x3a000000, v93
    v_cos_f32 v94, v92
    v_sin_f32 v96, v92
    v_cos_f32 v95, v93
    v_sin_f32 v97, v93
    v_cvt_pk_bf16_f32 v92, v94, v96
    v_xor_b32 v94, 0x80000000, v92
    ds_write_b16 v100, v92 offset:0
    ds_write_b16_d16_hi v100, v92 offset:1024
    ds_write_b16_d16_hi v100, v94 offset:2048
    v_cvt_pk_bf16_f32 v93, v95, v97
    v_xor_b32 v95, 0x80000000, v93
    ds_write_b16 v100, v93 offset:3072
    ds_write_b16_d16_hi v100, v93 offset:4096
    ds_write_b16_d16_hi v100, v95 offset:5120
    v_lshrrev_b32 v15, 4, v0
    v_and_b32 v14, 15, v0
    v_mul_u32_u24 v14, 0x120, v14
    v_lshl_add_u32 v14, v15, 4, v14
    s_lshr_b32 s79, s3, 1
    s_lshl_b32 s79, s79, 5
    s_and_b32 s78, s3, 1
    s_add_u32 s78, s79, s78
    s_mul_i32 s78, s78, 0x90
    s_add_u32 s78, s78, 0x15000
    v_add_u32 v28, s78, v14
    v_lshrrev_b32 v15, 4, v0
    v_lshlrev_b32 v15, 4, v15
    v_add_u32 v29, 0x20490, v15
    v_add_u32 v16, 36864, v28
    s_cmp_eq_u32 s3, 4
    s_cselect_b32 vcc_lo, 0x00010001, -1
    s_cselect_b32 vcc_hi, 0x00010001, -1
    v_cndmask_b32 v29, v29, v16, vcc
    v_and_b32 v15, 15, v0
    v_lshrrev_b32 v14, 4, v0
    v_lshrrev_b32 v13, 2, v0
    v_and_b32 v13, 3, v13
    v_xor_b32 v13, v14, v13
    v_lshlrev_b32 v13, 4, v13
    v_lshl_add_u32 v40, v15, 6, v13
    v_lshrrev_b32 v15, 2, v0
    v_and_b32 v14, 3, v0
    v_lshrrev_b32 v13, 4, v0
    v_and_b32 v13, 3, v13
    v_xor_b32 v13, v14, v13
    v_lshlrev_b32 v13, 4, v13
    v_lshl_add_u32 v41, v15, 6, v13
    v_and_b32 v15, 7, v0
    v_lshrrev_b32 v14, 3, v0
    v_and_b32 v14, 1, v14
    v_lshrrev_b32 v13, 4, v0
    v_lshlrev_b32 v13, 8, v13
    v_lshl_add_u32 v13, v14, 10, v13
    v_lshl_add_u32 v13, v15, 5, v13
    s_lshl_b32 s79, s3, 11
    s_add_u32 s79, s79, 0x15000
    v_add_u32 v16, s79, v13
    s_lshl_b32 s79, s3, 11
    s_add_u32 s79, s79, 0x15000
    v_lshl_add_u32 v17, v0, 4, s79
    s_mul_i32 s79, s5, 0xcd
    s_lshr_b32 s79, s79, 12
    s_mul_i32 s79, s79, 20
    s_sub_u32 s79, s5, s79
    s_lshl_b32 s86, s79, 1
    s_lshl_b32 s79, s6, 10
    s_mul_i32 s78, s86, 0xcd
    s_lshr_b32 s78, s78, 10
    s_mul_i32 s78, s78, 0x19000
    s_mul_i32 s77, s86, 0xcd
    s_lshr_b32 s77, s77, 10
    s_mul_i32 s77, s77, 5
    s_sub_u32 s77, s86, s77
    s_mul_i32 s77, s77, 0x1400
    s_add_u32 s77, s78, s77
    s_mul_i32 s78, s5, 0xcd
    s_lshr_b32 s78, s78, 12
    s_mul_i32 s78, s78, 0x6400
    s_add_u32 s78, s77, s78
    s_add_u32 s78, s79, s78
    s_add_u32 s87, s78, 0x7c0000
    s_cmp_lt_u32 s4, 80
    s_cselect_b32 s87, s87, 0x40000000
    s_lshl_b32 s79, s6, 10
    s_add_u32 s78, s86, 1
    s_mul_i32 s78, s78, 0xcd
    s_lshr_b32 s78, s78, 10
    s_mul_i32 s78, s78, 0x19000
    s_add_u32 s77, s86, 1
    s_mul_i32 s76, s77, 0xcd
    s_lshr_b32 s76, s76, 10
    s_mul_i32 s76, s76, 5
    s_sub_u32 s76, s77, s76
    s_mul_i32 s76, s76, 0x1400
    s_add_u32 s76, s78, s76
    s_mul_i32 s78, s5, 0xcd
    s_lshr_b32 s78, s78, 12
    s_mul_i32 s78, s78, 0x6400
    s_add_u32 s78, s76, s78
    s_add_u32 s78, s79, s78
    s_add_u32 s88, s78, 0x7c0000
    s_cmp_lt_u32 s4, 80
    s_cselect_b32 s88, s88, 0x40000000
    s_branch L18
L17:
    v_and_b32 v15, 15, v0
    v_lshrrev_b32 v14, 4, v0
    v_mul_u32_u24 v14, 0xa0, v14
    v_add_u32 v14, v15, v14
    v_mul_u32_u24 v14, 0x90, v14
    s_lshl_b32 s79, s80, 4
    s_mul_i32 s78, s84, 0x900
    s_add_u32 s78, s79, s78
    s_add_u32 s78, s78, 0x15000
    v_add_u32 v2, s78, v14
    s_lshl_b32 s79, s80, 5
    s_add_u32 s74, s79, 0x40800
    v_add_u32 v5, 17280, v2
    v_sub_u32 v189, s74, v5
    v_min_u32 v5, v5, v189
    v_add_u32 v4, 11520, v2
    v_sub_u32 v188, s74, v4
    v_min_u32 v4, v4, v188
    v_add_u32 v3, 5760, v2
    v_sub_u32 v189, s74, v3
    v_min_u32 v3, v3, v189
    v_sub_u32 v188, s74, v2
    v_min_u32 v2, v2, v188
    s_cmp_eq_u32 s84, 0
    s_mov_b32 s48, 0x1f001f
    s_cselect_b32 s48, 0xffffffff, s48
    s_mov_b32 s49, 0xf000f
    s_cselect_b32 s49, 0xfffeffff, s49
    s_mov_b32 s50, 0x1f001f
    s_cselect_b32 s50, 0xffffffff, s50
    s_mov_b32 s51, 0xf000f
    s_cselect_b32 s51, 0xfffefffe, s51
    s_mov_b32 s56, 0x1f001f
    s_cselect_b32 s56, 0xffffffff, s56
    s_mov_b32 s57, 0xf000f
    s_cselect_b32 s57, 0xfffefffe, s57
    s_mov_b32 s58, 0x1f001f
    s_cselect_b32 s58, 0xffffffff, s58
    s_mov_b32 s59, 0xf000f
    s_cselect_b32 s59, 0xfffefffe, s59
    v_lshrrev_b32 v15, 5, v0
    v_lshrrev_b32 v14, 4, v0
    v_and_b32 v14, 1, v14
    v_lshrrev_b32 v13, 2, v0
    v_and_b32 v13, 3, v13
    v_lshl_add_u32 v13, v14, 2, v13
    v_lshl_add_u32 v13, v15, 4, v13
    v_and_b32 v15, 3, v0
    v_lshlrev_b32 v15, 3, v15
    v_lshl_add_u32 v15, v13, 5, v15
    s_mul_i32 s79, s80, 0x2880
    s_add_u32 s79, s79, 0x600
    v_add_u32 v8, s79, v15
    v_lshrrev_b32 v15, 4, v0
    v_and_b32 v15, 1, v15
    v_lshrrev_b32 v14, 2, v0
    v_and_b32 v14, 3, v14
    v_lshl_add_u32 v14, v15, 2, v14
    v_and_b32 v15, 3, v0
    v_lshlrev_b32 v15, 3, v15
    v_lshl_add_u32 v15, v14, 5, v15
    s_mul_i32 s79, s80, 0x2880
    s_add_u32 s79, s79, 0xa00
    v_add_u32 v9, s79, v15
    v_lshrrev_b32 v15, 4, v0
    s_and_b32 s79, s3, 1
    s_lshl_b32 s79, s79, 4
    v_and_b32 v14, 15, v0
    v_add_u32 v14, s79, v14
    v_mul_u32_u24 v14, 0x510, v14
    v_lshl_add_u32 v14, v15, 4, v14
    s_lshr_b32 s79, s3, 1
    s_mul_i32 s79, s79, 0x140
    s_add_u32 s79, s79, 0x600
    v_add_u32 v192, s79, v14
    v_lshrrev_b32 v15, 4, v0
    s_lshr_b32 s79, s3, 1
    s_mul_i32 s79, s79, 0x140
    s_add_u32 s79, s79, 0x100
    v_lshl_add_u32 v193, v15, 4, s79
    s_mul_i32 s79, s84, 0x1800
    s_add_u32 s79, s79, 0x20520
    v_lshl_add_u32 v11, v0, 4, s79
    v_lshlrev_b32 v15, 4, v0
    v_add_u32 v10, 0x23520, v15
    v_mov_b32 v20, 0
    v_mov_b32 v21, 0
    v_mov_b32 v22, 0
    v_mov_b32 v23, 0
    v_and_b32 v15, 7, v0
    v_lshlrev_b32 v15, 4, v15
    v_add_u32 v16, 0x20490, v15
    ds_write_b128 v16, v[20:23]
    v_lshrrev_b32 v15, 4, v0
    s_lshl_b32 s79, s3, 6
    s_add_u32 s79, s79, s81
    v_lshl_add_u32 v15, v15, 9, s79
    v_and_b32 v16, 15, v0
    v_mul_u32_u24 v92, v16, v15
    v_lshl_add_u32 v93, v15, 4, v92
    s_lshl_b32 s79, s3, 1
    s_add_u32 s74, s79, 0x19000
    v_add_u32 v100, s74, v6
    v_add_u32 v19, 102400, v6
    v_cvt_f32_u32 v92, v92
    v_cvt_f32_u32 v93, v93
    v_mul_f32 v92, 0x3a000000, v92
    v_mul_f32 v93, 0x3a000000, v93
    v_cos_f32 v94, v92
    v_sin_f32 v96, v92
    v_cos_f32 v95, v93
    v_sin_f32 v97, v93
    v_cvt_pk_bf16_f32 v92, v94, v96
    v_xor_b32 v94, 0x80000000, v92
    ds_write_b16 v100, v92 offset:0
    ds_write_b16_d16_hi v100, v92 offset:1024
    ds_write_b16_d16_hi v100, v94 offset:2048
    v_cvt_pk_bf16_f32 v93, v95, v97
    v_xor_b32 v95, 0x80000000, v93
    ds_write_b16 v100, v93 offset:3072
    ds_write_b16_d16_hi v100, v93 offset:4096
    ds_write_b16_d16_hi v100, v95 offset:5120
    v_lshrrev_b32 v15, 4, v0
    v_and_b32 v14, 15, v0
    v_mul_u32_u24 v14, 0x120, v14
    v_lshl_add_u32 v14, v15, 4, v14
    s_lshr_b32 s79, s3, 1
    s_lshl_b32 s79, s79, 5
    s_and_b32 s78, s3, 1
    s_add_u32 s78, s79, s78
    s_mul_i32 s78, s78, 0x90
    s_add_u32 s78, s78, 0x15000
    v_add_u32 v28, s78, v14
    v_lshrrev_b32 v15, 4, v0
    v_lshlrev_b32 v15, 4, v15
    v_add_u32 v29, 0x20490, v15
    v_add_u32 v16, 36864, v28
    s_cmp_eq_u32 s3, 4
    s_cselect_b32 vcc_lo, 0x00010001, -1
    s_cselect_b32 vcc_hi, 0x00010001, -1
    v_cndmask_b32 v29, v29, v16, vcc
    v_and_b32 v15, 15, v0
    v_lshrrev_b32 v14, 4, v0
    v_lshrrev_b32 v13, 2, v0
    v_and_b32 v13, 3, v13
    v_xor_b32 v13, v14, v13
    v_lshlrev_b32 v13, 4, v13
    v_lshl_add_u32 v40, v15, 6, v13
    v_lshrrev_b32 v15, 2, v0
    v_and_b32 v14, 3, v0
    v_lshrrev_b32 v13, 4, v0
    v_and_b32 v13, 3, v13
    v_xor_b32 v13, v14, v13
    v_lshlrev_b32 v13, 4, v13
    v_lshl_add_u32 v41, v15, 6, v13
    v_and_b32 v15, 7, v0
    v_lshrrev_b32 v14, 3, v0
    v_and_b32 v14, 1, v14
    v_lshrrev_b32 v13, 4, v0
    v_lshlrev_b32 v13, 8, v13
    v_lshl_add_u32 v13, v14, 10, v13
    v_lshl_add_u32 v13, v15, 5, v13
    s_lshl_b32 s79, s3, 11
    s_add_u32 s79, s79, 0x15000
    v_add_u32 v16, s79, v13
    s_lshl_b32 s79, s3, 11
    s_add_u32 s79, s79, 0x15000
    v_lshl_add_u32 v17, v0, 4, s79
    s_mul_i32 s79, s5, 0xcd
    s_lshr_b32 s79, s79, 12
    s_mul_i32 s79, s79, 20
    s_sub_u32 s79, s5, s79
    s_lshl_b32 s86, s79, 1
    s_lshl_b32 s79, s6, 10
    s_mul_i32 s78, s86, 0xcd
    s_lshr_b32 s78, s78, 10
    s_mul_i32 s78, s78, 0x19000
    s_mul_i32 s77, s86, 0xcd
    s_lshr_b32 s77, s77, 10
    s_mul_i32 s77, s77, 5
    s_sub_u32 s77, s86, s77
    s_mul_i32 s77, s77, 0x1400
    s_add_u32 s77, s78, s77
    s_mul_i32 s78, s5, 0xcd
    s_lshr_b32 s78, s78, 12
    s_mul_i32 s78, s78, 0x6400
    s_add_u32 s78, s77, s78
    s_add_u32 s78, s79, s78
    s_add_u32 s87, s78, 0x7c0000
    s_cmp_lt_u32 s4, 80
    s_cselect_b32 s87, s87, 0x40000000
    s_lshl_b32 s79, s6, 10
    s_add_u32 s78, s86, 1
    s_mul_i32 s78, s78, 0xcd
    s_lshr_b32 s78, s78, 10
    s_mul_i32 s78, s78, 0x19000
    s_add_u32 s77, s86, 1
    s_mul_i32 s76, s77, 0xcd
    s_lshr_b32 s76, s76, 10
    s_mul_i32 s76, s76, 5
    s_sub_u32 s76, s77, s76
    s_mul_i32 s76, s76, 0x1400
    s_add_u32 s76, s78, s76
    s_mul_i32 s78, s5, 0xcd
    s_lshr_b32 s78, s78, 12
    s_mul_i32 s78, s78, 0x6400
    s_add_u32 s78, s76, s78
    s_add_u32 s78, s79, s78
    s_add_u32 s88, s78, 0x7c0000
    s_cmp_lt_u32 s4, 80
    s_cselect_b32 s88, s88, 0x40000000
    s_lshl_b32 s74, s6, 2
    s_add_u32 s74, s74, 0
    s_cmp_ge_u32 s74, 10
    s_cselect_b32 s75, 80, 0
    s_cselect_b32 s76, 10, 0
    s_sub_u32 s74, s74, s76
    s_mul_i32 s76, s74, 6
    s_lshr_b64 s[78:79], s[100:101], s76
    s_and_b32 s78, s78, 63
    s_add_u32 s78, s78, s75
    s_bitcmp1_b32 0x84, s74
    s_cselect_b32 s75, 20, 1
    s_cselect_b32 s76, 1, 4
    s_add_u32 s79, s78, s75
    s_mul_i32 s78, s78, 1280
    s_mul_i32 s79, s79, 1280
    s_mul_i32 s76, s76, 1280
    v_mad_u32_u24 v204, v18, s76, v38
    buffer_load_dword v236, v204, s[60:63], s78 offen
    buffer_load_dword v237, v204, s[60:63], s79 offen
    s_lshl_b32 s74, s6, 2
    s_add_u32 s74, s74, 1
    s_cmp_ge_u32 s74, 10
    s_cselect_b32 s75, 80, 0
    s_cselect_b32 s76, 10, 0
    s_sub_u32 s74, s74, s76
    s_mul_i32 s76, s74, 6
    s_lshr_b64 s[78:79], s[100:101], s76
    s_and_b32 s78, s78, 63
    s_add_u32 s78, s78, s75
    s_bitcmp1_b32 0x84, s74
    s_cselect_b32 s75, 20, 1
    s_cselect_b32 s76, 1, 4
    s_add_u32 s79, s78, s75
    s_mul_i32 s78, s78, 1280
    s_mul_i32 s79, s79, 1280
    s_mul_i32 s76, s76, 1280
    v_mad_u32_u24 v205, v18, s76, v38
    buffer_load_dword v238, v205, s[60:63], s78 offen
    buffer_load_dword v239, v205, s[60:63], s79 offen
    s_lshl_b32 s74, s6, 2
    s_add_u32 s74, s74, 2
    s_cmp_ge_u32 s74, 10
    s_cselect_b32 s75, 80, 0
    s_cselect_b32 s76, 10, 0
    s_sub_u32 s74, s74, s76
    s_mul_i32 s76, s74, 6
    s_lshr_b64 s[78:79], s[100:101], s76
    s_and_b32 s78, s78, 63
    s_add_u32 s78, s78, s75
    s_bitcmp1_b32 0x84, s74
    s_cselect_b32 s75, 20, 1
    s_cselect_b32 s76, 1, 4
    s_add_u32 s79, s78, s75
    s_mul_i32 s78, s78, 1280
    s_mul_i32 s79, s79, 1280
    s_mul_i32 s76, s76, 1280
    v_mad_u32_u24 v206, v18, s76, v38
    buffer_load_dword v240, v206, s[60:63], s78 offen
    buffer_load_dword v241, v206, s[60:63], s79 offen
    s_lshl_b32 s74, s6, 2
    s_add_u32 s74, s74, 3
    s_cmp_ge_u32 s74, 10
    s_cselect_b32 s75, 80, 0
    s_cselect_b32 s76, 10, 0
    s_sub_u32 s74, s74, s76
    s_mul_i32 s76, s74, 6
    s_lshr_b64 s[78:79], s[100:101], s76
    s_and_b32 s78, s78, 63
    s_add_u32 s78, s78, s75
    s_bitcmp1_b32 0x84, s74
    s_cselect_b32 s75, 20, 1
    s_cselect_b32 s76, 1, 4
    s_add_u32 s79, s78, s75
    s_mul_i32 s78, s78, 1280
    s_mul_i32 s79, s79, 1280
    s_mul_i32 s76, s76, 1280
    v_mad_u32_u24 v207, v18, s76, v38
    buffer_load_dword v242, v207, s[60:63], s78 offen
    buffer_load_dword v243, v207, s[60:63], s79 offen
L18:
    s_waitcnt vmcnt(8)
    s_waitcnt lgkmcnt(0)
    s_barrier
    ds_read_b128 v[156:159], v11 offset:0
    ds_read_b128 v[160:163], v11 offset:1024
    ds_read_b128 v[164:167], v11 offset:2048
    ds_read_b128 v[168:171], v11 offset:3072
    ds_read_b64_tr_b16 v[44:45], v8 offset:0
    ds_read_b64_tr_b16 v[46:47], v8 offset:256
    ds_read_b64_tr_b16 v[48:49], v9 offset:0
    ds_read_b64_tr_b16 v[50:51], v8 offset:1296
    ds_read_b64_tr_b16 v[52:53], v8 offset:1552
    ds_read_b64_tr_b16 v[54:55], v9 offset:1296
    ds_read_b64_tr_b16 v[56:57], v8 offset:2592
    ds_read_b64_tr_b16 v[58:59], v8 offset:2848
    ds_read_b64_tr_b16 v[60:61], v9 offset:2592
    ds_read_b128 v[172:175], v11 offset:4096
    ds_read_b128 v[176:179], v11 offset:5120
    ds_read_b128 v[180:183], v10 offset:0
    ds_read_b128 v[184:187], v10 offset:1024
    s_waitcnt lgkmcnt(11)
    v_mfma_f32_16x16x32_bf16 v[92:95], v[44:47], v[156:159], 0
    v_mfma_f32_16x16x32_bf16 v[96:99], v[44:47], v[160:163], 0
    s_waitcnt lgkmcnt(10)
    v_mfma_f32_16x16x32_bf16 v[92:95], v[46:49], v[164:167], v[92:95]
    v_mfma_f32_16x16x32_bf16 v[96:99], v[46:49], v[168:171], v[96:99]
    ds_read_b128 v[116:119], v192 offset:0
    ds_read_b128 v[136:139], v193 offset:0
    ds_read_b128 v[120:123], v192 offset:64
    ds_read_b128 v[140:143], v193 offset:64
    ds_read_b128 v[124:127], v192 offset:128
    ds_read_b128 v[144:147], v193 offset:128
    ds_read_b128 v[128:131], v192 offset:192
    ds_read_b128 v[148:151], v193 offset:192
    ds_read_b128 v[132:135], v192 offset:256
    ds_read_b128 v[152:155], v193 offset:256
    s_waitcnt lgkmcnt(15)
    v_mfma_f32_16x16x32_bf16 v[100:103], v[50:53], v[156:159], 0
    v_mfma_f32_16x16x32_bf16 v[104:107], v[50:53], v[160:163], 0
    v_mfma_f32_16x16x32_bf16 v[100:103], v[52:55], v[164:167], v[100:103]
    v_mfma_f32_16x16x32_bf16 v[104:107], v[52:55], v[168:171], v[104:107]
    ds_read_b64_tr_b16 v[62:63], v8 offset:3888
    ds_read_b64_tr_b16 v[64:65], v8 offset:4144
    ds_read_b64_tr_b16 v[66:67], v9 offset:3888
    ds_read_b64_tr_b16 v[68:69], v8 offset:5184
    ds_read_b64_tr_b16 v[70:71], v8 offset:5440
    ds_read_b64_tr_b16 v[72:73], v9 offset:5184
    ds_read_b64_tr_b16 v[74:75], v8 offset:6480
    ds_read_b64_tr_b16 v[76:77], v8 offset:6736
    ds_read_b64_tr_b16 v[78:79], v9 offset:6480
    ds_read_b64_tr_b16 v[80:81], v8 offset:7776
    ds_read_b64_tr_b16 v[82:83], v8 offset:8032
    ds_read_b64_tr_b16 v[84:85], v9 offset:7776
    ds_read_b64_tr_b16 v[86:87], v8 offset:9072
    ds_read_b64_tr_b16 v[88:89], v8 offset:9328
    ds_read_b64_tr_b16 v[90:91], v9 offset:9072
    v_mfma_f32_16x16x32_bf16 v[108:111], v[56:59], v[156:159], 0
    v_mfma_f32_16x16x32_bf16 v[112:115], v[56:59], v[160:163], 0
    s_waitcnt lgkmcnt(15)
    v_mfma_f32_16x16x32_bf16 v[108:111], v[58:61], v[164:167], v[108:111]
    v_mfma_f32_16x16x32_bf16 v[112:115], v[58:61], v[168:171], v[112:115]
    ds_read_b128 v[212:215], v19 offset:0
    ds_read_b128 v[216:219], v19 offset:1024
    ds_read_b128 v[220:223], v19 offset:2048
    ds_read_b128 v[224:227], v19 offset:3072
    ds_read_b128 v[228:231], v19 offset:4096
    ds_read_b128 v[232:235], v19 offset:5120
    v_mfma_f32_16x16x32_bf16 v[20:23], v[116:119], v[136:139], 0
    v_mfma_f32_16x16x32_bf16 v[20:23], v[120:123], v[140:143], v[20:23]
    v_mfma_f32_16x16x32_bf16 v[20:23], v[124:127], v[144:147], v[20:23]
    v_mfma_f32_16x16x32_bf16 v[20:23], v[128:131], v[148:151], v[20:23]
    v_mfma_f32_16x16x32_bf16 v[20:23], v[132:135], v[152:155], v[20:23]
    v_lshrrev_b32 v15, 4, v0
    s_and_b32 s79, s3, 1
    s_lshl_b32 s79, s79, 6
    s_add_u32 s79, s79, 64
    v_lshl_add_u32 v192, v15, 4, s79
    v_mov_b32 v194, 0
    v_mov_b32 v195, 1
    v_pk_mul_f32 v[188:189], v[96:97], v[176:177]
    v_pk_mul_f32 v[196:197], v[92:93], v[176:177]
    v_pk_mul_f32 v[190:191], v[98:99], v[178:179]
    v_pk_mul_f32 v[198:199], v[94:95], v[178:179]
    v_pk_fma_f32 v[188:189], v[92:93], v[172:173], v[188:189] neg_lo:[0,0,1] neg_hi:[0,0,1]
    v_pk_fma_f32 v[196:197], v[96:97], v[172:173], v[196:197]
    v_pk_fma_f32 v[190:191], v[94:95], v[174:175], v[190:191] neg_lo:[0,0,1] neg_hi:[0,0,1]
    v_pk_fma_f32 v[198:199], v[98:99], v[174:175], v[198:199]
    v_cvt_pk_bf16_f32 v204, v188, v189
    v_cvt_pk_bf16_f32 v206, v196, v197
    v_cvt_pk_bf16_f32 v205, v190, v191
    v_cvt_pk_bf16_f32 v207, v198, v199
    s_waitcnt lgkmcnt(15)
    v_mfma_f32_16x16x32_bf16 v[116:119], v[62:65], v[156:159], 0
    v_mfma_f32_16x16x32_bf16 v[120:123], v[62:65], v[160:163], 0
    v_mfma_f32_16x16x32_bf16 v[116:119], v[64:67], v[164:167], v[116:119]
    v_mfma_f32_16x16x32_bf16 v[120:123], v[64:67], v[168:171], v[120:123]
    s_mul_i32 s79, s82, 0x282
    s_mul_i32 s78, s7, 0x134
    s_add_u32 s78, s79, s78
    s_and_b32 s79, s82, 1
    s_lshl_b32 s79, s79, 1
    s_sub_u32 s79, s78, s79
    s_mul_i32 s78, s80, 0xf0c0
    s_add_u32 s90, s79, s78
    s_mul_i32 s79, s84, 0x5400
    s_mul_i32 s78, s80, 0x3f0
    s_add_u32 s78, s79, s78
    s_add_u32 s91, s78, 0xa800
    s_add_u32 m0, s91, 0
    s_nop 0
    buffer_load_dwordx4 v32, s[44:47], s90 offen lds
    s_add_u32 s90, s90, 246528
    s_add_u32 m0, s91, 4032
    s_nop 0
    buffer_load_dwordx4 v32, s[44:47], s90 offen lds
    s_mov_b32 s74, 0x05040100
    s_mov_b32 s75, 0x07060302
    s_waitcnt vmcnt(8)
    v_perm_b32 v244, v237, v236, s74
    v_perm_b32 v236, v237, v236, s75
    s_waitcnt vmcnt(6)
    v_perm_b32 v245, v239, v238, s74
    v_perm_b32 v237, v239, v238, s75
    s_waitcnt vmcnt(4)
    v_perm_b32 v246, v241, v240, s74
    v_perm_b32 v238, v241, v240, s75
    s_waitcnt vmcnt(2)
    v_perm_b32 v247, v243, v242, s74
    v_perm_b32 v239, v243, v242, s75
    ds_write_b128 v16, v[244:247] offset:0
    ds_write_b128 v16, v[236:239] offset:16
    v_mfma_f32_16x16x32_bf16 v[92:95], v[180:183], v[204:207], 0
    v_mfma_f32_16x16x32_bf16 v[96:99], v[184:187], v[204:207], 0
    v_pk_mul_f32 v[188:189], v[104:105], v[176:177]
    v_pk_mul_f32 v[196:197], v[100:101], v[176:177]
    v_pk_mul_f32 v[190:191], v[106:107], v[178:179]
    v_pk_mul_f32 v[198:199], v[102:103], v[178:179]
    v_pk_fma_f32 v[188:189], v[100:101], v[172:173], v[188:189] neg_lo:[0,0,1] neg_hi:[0,0,1]
    v_pk_fma_f32 v[196:197], v[104:105], v[172:173], v[196:197]
    v_pk_fma_f32 v[190:191], v[102:103], v[174:175], v[190:191] neg_lo:[0,0,1] neg_hi:[0,0,1]
    v_pk_fma_f32 v[198:199], v[106:107], v[174:175], v[198:199]
    v_cvt_pk_bf16_f32 v208, v188, v189
    v_cvt_pk_bf16_f32 v210, v196, v197
    v_cvt_pk_bf16_f32 v209, v190, v191
    v_cvt_pk_bf16_f32 v211, v198, v199
    v_mfma_f32_16x16x32_bf16 v[124:127], v[68:71], v[156:159], 0
    v_mfma_f32_16x16x32_bf16 v[128:131], v[68:71], v[160:163], 0
    v_mfma_f32_16x16x32_bf16 v[124:127], v[70:73], v[164:167], v[124:127]
    v_mfma_f32_16x16x32_bf16 v[128:131], v[70:73], v[168:171], v[128:131]
    s_add_u32 s90, s90, 246528
    s_add_u32 m0, s91, 8064
    s_nop 0
    buffer_load_dwordx4 v32, s[44:47], s90 offen lds
    s_add_u32 s90, s90, 246528
    s_add_u32 m0, s91, 12096
    s_nop 0
    buffer_load_dwordx4 v32, s[44:47], s90 offen lds
    ds_read_b128 v[236:239], v17 offset:0
    ds_read_b128 v[240:243], v17 offset:1024
    v_mfma_f32_16x16x32_bf16 v[100:103], v[180:183], v[208:211], 0
    v_mfma_f32_16x16x32_bf16 v[104:107], v[184:187], v[208:211], 0
    s_mov_b32 exec_lo, 0x00010001
    s_mov_b32 exec_hi, 0x00010001
    ds_add_f32 v192, v20 offset:0
    ds_add_f32 v192, v21 offset:4
    ds_add_f32 v192, v22 offset:8
    ds_add_f32 v192, v23 offset:12
    s_mov_b64 exec, 1
    ds_add_rtn_u32 v38, v194, v195 offset:48
    s_mov_b64 exec, -1
    v_pk_mul_f32 v[188:189], v[112:113], v[176:177]
    v_pk_mul_f32 v[196:197], v[108:109], v[176:177]
    v_pk_mul_f32 v[190:191], v[114:115], v[178:179]
    v_pk_mul_f32 v[198:199], v[110:111], v[178:179]
    v_pk_fma_f32 v[188:189], v[108:109], v[172:173], v[188:189] neg_lo:[0,0,1] neg_hi:[0,0,1]
    v_pk_fma_f32 v[196:197], v[112:113], v[172:173], v[196:197]
    v_pk_fma_f32 v[190:191], v[110:111], v[174:175], v[190:191] neg_lo:[0,0,1] neg_hi:[0,0,1]
    v_pk_fma_f32 v[198:199], v[114:115], v[174:175], v[198:199]
    v_cvt_pk_bf16_f32 v204, v188, v189
    v_cvt_pk_bf16_f32 v206, v196, v197
    v_cvt_pk_bf16_f32 v205, v190, v191
    v_cvt_pk_bf16_f32 v207, v198, v199
    s_waitcnt lgkmcnt(15)
    v_mfma_f32_16x16x32_bf16 v[132:135], v[74:77], v[156:159], 0
    v_mfma_f32_16x16x32_bf16 v[136:139], v[74:77], v[160:163], 0
    v_mfma_f32_16x16x32_bf16 v[132:135], v[76:79], v[164:167], v[132:135]
    v_mfma_f32_16x16x32_bf16 v[136:139], v[76:79], v[168:171], v[136:139]
    s_add_u32 s90, s90, 246528
    s_add_u32 m0, s91, 16128
    s_nop 0
    buffer_load_dwordx4 v32, s[44:47], s90 offen lds
    s_add_u32 s90, s90, 246528
    s_cmp_eq_u32 s80, 1
    s_cselect_b32 exec_lo, 0x1fffff, 0
    s_mov_b32 exec_hi, 0
    s_cmp_eq_u32 s80, 0
    s_cselect_b64 exec, -1, exec
    s_add_u32 m0, s91, 20160
    s_nop 0
    buffer_load_dwordx4 v32, s[44:47], s90 offen lds
    s_mov_b64 exec, -1
    s_waitcnt lgkmcnt(6)
    buffer_store_dwordx4 v[236:239], v6, s[36:39], s87 offen sc1
    s_waitcnt lgkmcnt(5)
    buffer_store_dwordx4 v[240:243], v6, s[36:39], s88 offen sc1
    v_mfma_f32_16x16x32_bf16 v[108:111], v[180:183], v[204:207], 0
    v_mfma_f32_16x16x32_bf16 v[112:115], v[184:187], v[204:207], 0
    v_pk_mul_f32 v[188:189], v[120:121], v[176:177]
    v_pk_mul_f32 v[196:197], v[116:117], v[176:177]
    v_pk_mul_f32 v[190:191], v[122:123], v[178:179]
    v_pk_mul_f32 v[198:199], v[118:119], v[178:179]
    v_pk_fma_f32 v[188:189], v[116:117], v[172:173], v[188:189] neg_lo:[0,0,1] neg_hi:[0,0,1]
    v_pk_fma_f32 v[196:197], v[120:121], v[172:173], v[196:197]
    v_pk_fma_f32 v[190:191], v[118:119], v[174:175], v[190:191] neg_lo:[0,0,1] neg_hi:[0,0,1]
    v_pk_fma_f32 v[198:199], v[122:123], v[174:175], v[198:199]
    v_cvt_pk_bf16_f32 v208, v188, v189
    v_cvt_pk_bf16_f32 v210, v196, v197
    v_cvt_pk_bf16_f32 v209, v190, v191
    v_cvt_pk_bf16_f32 v211, v198, v199
    v_mfma_f32_16x16x32_bf16 v[140:143], v[80:83], v[156:159], 0
    v_mfma_f32_16x16x32_bf16 v[144:147], v[80:83], v[160:163], 0
    v_mfma_f32_16x16x32_bf16 v[140:143], v[82:85], v[164:167], v[140:143]
    v_mfma_f32_16x16x32_bf16 v[144:147], v[82:85], v[168:171], v[144:147]
    s_lshl_b32 s79, s3, 11
    s_add_u32 s94, s79, 0x3800
    s_lshl_b32 s79, s3, 11
    s_add_u32 s95, s79, 0x23d20
    s_mov_b32 m0, s95
    s_nop 0
    buffer_load_dwordx4 v6, s[32:35], s94 offen lds
    s_add_u32 m0, s95, 1024
    s_nop 0
    buffer_load_dwordx4 v7, s[32:35], s94 offen lds
    v_and_b32 v19, 7, v0
    v_lshlrev_b32 v19, 2, v19
    buffer_load_dword v18, v19, s[40:43], 0 offen offset:128 sc1
    v_mfma_f32_16x16x32_bf16 v[116:119], v[180:183], v[208:211], 0
    v_mfma_f32_16x16x32_bf16 v[120:123], v[184:187], v[208:211], 0
    v_cvt_pk_bf16_f32 v44, v92, v100
    v_cvt_pk_bf16_f32 v48, v96, v104
    v_cvt_pk_bf16_f32 v52, v93, v101
    v_cvt_pk_bf16_f32 v56, v97, v105
    v_cvt_pk_bf16_f32 v60, v94, v102
    v_cvt_pk_bf16_f32 v64, v98, v106
    v_cvt_pk_bf16_f32 v68, v95, v103
    v_cvt_pk_bf16_f32 v72, v99, v107
    s_waitcnt lgkmcnt(0)
    v_readfirstlane_b32 s74, v38
    s_cmp_lg_u32 s74, 7
    s_cbranch_scc1 L19
    v_lshlrev_b32 v192, 2, v0
    ds_read_b32 v193, v192 offset:64
    s_waitcnt lgkmcnt(0)
    s_waitcnt lgkmcnt(0)
    v_mul_f32 v193, 0xbfb8aa3b, v193
    v_exp_f32 v193, v193
    s_nop 0
    v_add_f32 v193, 1.0, v193
    v_rcp_f32 v193, v193
    s_lshl_b32 s79, s81, 7
    s_add_u32 s87, s79, 0xb50000
    s_mov_b32 exec_hi, 0
    buffer_store_dword v193, v192, s[36:39], s87 offen sc1
    s_mov_b64 exec, -1
L19:
    v_pk_mul_f32 v[188:189], v[128:129], v[176:177]
    v_pk_mul_f32 v[196:197], v[124:125], v[176:177]
    v_pk_mul_f32 v[190:191], v[130:131], v[178:179]
    v_pk_mul_f32 v[198:199], v[126:127], v[178:179]
    v_pk_fma_f32 v[188:189], v[124:125], v[172:173], v[188:189] neg_lo:[0,0,1] neg_hi:[0,0,1]
    v_pk_fma_f32 v[196:197], v[128:129], v[172:173], v[196:197]
    v_pk_fma_f32 v[190:191], v[126:127], v[174:175], v[190:191] neg_lo:[0,0,1] neg_hi:[0,0,1]
    v_pk_fma_f32 v[198:199], v[130:131], v[174:175], v[198:199]
    v_cvt_pk_bf16_f32 v204, v188, v189
    v_cvt_pk_bf16_f32 v206, v196, v197
    v_cvt_pk_bf16_f32 v205, v190, v191
    v_cvt_pk_bf16_f32 v207, v198, v199
    v_mfma_f32_16x16x32_bf16 v[148:151], v[86:89], v[156:159], 0
    v_mfma_f32_16x16x32_bf16 v[152:155], v[86:89], v[160:163], 0
    v_mfma_f32_16x16x32_bf16 v[148:151], v[88:91], v[164:167], v[148:151]
    v_mfma_f32_16x16x32_bf16 v[152:155], v[88:91], v[168:171], v[152:155]
    v_mfma_f32_16x16x32_bf16 v[124:127], v[180:183], v[204:207], 0
    v_mfma_f32_16x16x32_bf16 v[128:131], v[184:187], v[204:207], 0
    v_pk_mul_f32 v[188:189], v[136:137], v[176:177]
    v_pk_mul_f32 v[196:197], v[132:133], v[176:177]
    v_pk_mul_f32 v[190:191], v[138:139], v[178:179]
    v_pk_mul_f32 v[198:199], v[134:135], v[178:179]
    v_pk_fma_f32 v[188:189], v[132:133], v[172:173], v[188:189] neg_lo:[0,0,1] neg_hi:[0,0,1]
    v_pk_fma_f32 v[196:197], v[136:137], v[172:173], v[196:197]
    v_pk_fma_f32 v[190:191], v[134:135], v[174:175], v[190:191] neg_lo:[0,0,1] neg_hi:[0,0,1]
    v_pk_fma_f32 v[198:199], v[138:139], v[174:175], v[198:199]
    v_cvt_pk_bf16_f32 v208, v188, v189
    v_cvt_pk_bf16_f32 v210, v196, v197
    v_cvt_pk_bf16_f32 v209, v190, v191
    v_cvt_pk_bf16_f32 v211, v198, v199
    s_nop 1
    v_mfma_f32_16x16x32_bf16 v[132:135], v[180:183], v[208:211], 0
    v_mfma_f32_16x16x32_bf16 v[136:139], v[184:187], v[208:211], 0
    v_cvt_pk_bf16_f32 v45, v108, v116
    v_cvt_pk_bf16_f32 v49, v112, v120
    v_cvt_pk_bf16_f32 v53, v109, v117
    v_cvt_pk_bf16_f32 v57, v113, v121
    v_cvt_pk_bf16_f32 v61, v110, v118
    v_cvt_pk_bf16_f32 v65, v114, v122
    v_cvt_pk_bf16_f32 v69, v111, v119
    v_cvt_pk_bf16_f32 v73, v115, v123
    v_pk_mul_f32 v[188:189], v[144:145], v[176:177]
    v_pk_mul_f32 v[196:197], v[140:141], v[176:177]
    v_pk_mul_f32 v[190:191], v[146:147], v[178:179]
    v_pk_mul_f32 v[198:199], v[142:143], v[178:179]
    v_pk_fma_f32 v[188:189], v[140:141], v[172:173], v[188:189] neg_lo:[0,0,1] neg_hi:[0,0,1]
    v_pk_fma_f32 v[196:197], v[144:145], v[172:173], v[196:197]
    v_pk_fma_f32 v[190:191], v[142:143], v[174:175], v[190:191] neg_lo:[0,0,1] neg_hi:[0,0,1]
    v_pk_fma_f32 v[198:199], v[146:147], v[174:175], v[198:199]
    v_cvt_pk_bf16_f32 v204, v188, v189
    v_cvt_pk_bf16_f32 v206, v196, v197
    v_cvt_pk_bf16_f32 v205, v190, v191
    v_cvt_pk_bf16_f32 v207, v198, v199
    s_nop 1
    v_mfma_f32_16x16x32_bf16 v[140:143], v[180:183], v[204:207], 0
    v_mfma_f32_16x16x32_bf16 v[144:147], v[184:187], v[204:207], 0
    ds_read_b32 v38, v194 offset:48
    v_pk_mul_f32 v[188:189], v[152:153], v[176:177]
    v_pk_mul_f32 v[196:197], v[148:149], v[176:177]
    v_pk_mul_f32 v[190:191], v[154:155], v[178:179]
    v_pk_mul_f32 v[198:199], v[150:151], v[178:179]
    v_pk_fma_f32 v[188:189], v[148:149], v[172:173], v[188:189] neg_lo:[0,0,1] neg_hi:[0,0,1]
    v_pk_fma_f32 v[196:197], v[152:153], v[172:173], v[196:197]
    v_pk_fma_f32 v[190:191], v[150:151], v[174:175], v[190:191] neg_lo:[0,0,1] neg_hi:[0,0,1]
    v_pk_fma_f32 v[198:199], v[154:155], v[174:175], v[198:199]
    v_cvt_pk_bf16_f32 v208, v188, v189
    v_cvt_pk_bf16_f32 v210, v196, v197
    v_cvt_pk_bf16_f32 v209, v190, v191
    v_cvt_pk_bf16_f32 v211, v198, v199
    s_nop 1
    v_mfma_f32_16x16x32_bf16 v[148:151], v[180:183], v[208:211], 0
    v_mfma_f32_16x16x32_bf16 v[152:155], v[184:187], v[208:211], 0
    v_cvt_pk_bf16_f32 v46, v124, v132
    v_cvt_pk_bf16_f32 v50, v128, v136
    v_cvt_pk_bf16_f32 v54, v125, v133
    v_cvt_pk_bf16_f32 v58, v129, v137
    v_cvt_pk_bf16_f32 v62, v126, v134
    v_cvt_pk_bf16_f32 v66, v130, v138
    v_cvt_pk_bf16_f32 v70, v127, v135
    v_cvt_pk_bf16_f32 v74, v131, v139
    v_cvt_pk_bf16_f32 v47, v140, v148
    v_cvt_pk_bf16_f32 v51, v144, v152
    v_cvt_pk_bf16_f32 v55, v141, v149
    v_cvt_pk_bf16_f32 v59, v145, v153
    v_cvt_pk_bf16_f32 v63, v142, v150
    v_cvt_pk_bf16_f32 v67, v146, v154
    v_cvt_pk_bf16_f32 v71, v143, v151
    v_cvt_pk_bf16_f32 v75, v147, v155
    s_lshl_b32 s79, s3, 12
    s_add_u32 s86, s79, 0x600
    s_waitcnt lgkmcnt(0)
    v_readfirstlane_b32 s74, v38
    s_cmp_eq_u32 s74, 8
    s_cbranch_scc1 L20
    s_nop 2
    s_mov_b32 s75, 0x40000
L22:
    s_sub_u32 s75, s75, 1
    s_cbranch_scc1 L21
    ds_read_b32 v38, v194 offset:48
    s_waitcnt lgkmcnt(0)
    v_readfirstlane_b32 s74, v38
    s_cmp_ge_u32 s74, 8
    s_cbranch_scc0 L22
    s_nop 2
L21:
L20:
    s_mov_b64 exec, s[48:49]
    ds_write_b128 v2, v[44:47]
    ds_write_b128 v2, v[48:51] offset:64
    s_mov_b64 exec, s[50:51]
    ds_write_b128 v3, v[52:55]
    ds_write_b128 v3, v[56:59] offset:64
    s_mov_b64 exec, s[56:57]
    ds_write_b128 v4, v[60:63]
    ds_write_b128 v4, v[64:67] offset:64
    s_mov_b64 exec, s[58:59]
    ds_write_b128 v5, v[68:71]
    ds_write_b128 v5, v[72:75] offset:64
    s_mov_b64 exec, -1
    v_mov_b32 v34, v32
    v_add_u32 v32, s86, v40
    v_add_u32 v33, s86, v41
    s_waitcnt vmcnt(0)
    v_cmp_ne_u32 vcc, 1, v18
    s_cmp_eq_u64 vcc, 0
    s_cbranch_scc1 L23
    s_mov_b32 s87, 0x8000
L24:
    s_sub_u32 s87, s87, 1
    s_cbranch_scc1 L23
    s_sleep 2
    buffer_load_dword v18, v19, s[40:43], 0 offen offset:128 sc1
    s_waitcnt vmcnt(0)
    v_cmp_ne_u32 vcc, 1, v18
    s_cmp_eq_u64 vcc, 0
    s_cbranch_scc0 L24
L23:
    s_waitcnt vmcnt(0) lgkmcnt(0)
    s_nop 1
    s_barrier
    ds_read_b128 v[44:47], v28 offset:0
    ds_read_b128 v[48:51], v28 offset:64
    ds_read_b128 v[52:55], v28 offset:18432
    ds_read_b128 v[56:59], v28 offset:18496
    ds_read_b128 v[60:63], v29 offset:0
    ds_read_b128 v[64:67], v29 offset:64
    s_cmp_lg_u32 s3, 7
    s_cbranch_scc1 L25
    s_and_b32 s79, s83, 7
    s_lshl_b32 s79, s79, 6
    s_add_u32 s88, s79, 0xc34000
    v_mov_b32 v13, 1
    v_lshlrev_b32 v12, 9, v0
    s_mov_b64 exec, 0xffff
    buffer_atomic_add v13, v12, s[36:39], s88 offen sc1
    s_mov_b64 exec, -1
L25:
    s_waitcnt lgkmcnt(5)
    v_mfma_f32_16x16x32_bf16 v[92:95], v[44:47], v[212:215], 0
    s_waitcnt lgkmcnt(4)
    v_mfma_f32_16x16x32_bf16 v[96:99], v[48:51], v[212:215], 0
    v_mfma_f32_16x16x32_bf16 v[100:103], v[44:47], v[224:227], 0
    v_mfma_f32_16x16x32_bf16 v[104:107], v[48:51], v[224:227], 0
    v_mfma_f32_16x16x32_bf16 v[92:95], v[48:51], v[216:219], v[92:95]
    v_mfma_f32_16x16x32_bf16 v[96:99], v[44:47], v[220:223], v[96:99]
    v_mfma_f32_16x16x32_bf16 v[100:103], v[48:51], v[228:231], v[100:103]
    v_mfma_f32_16x16x32_bf16 v[104:107], v[44:47], v[232:235], v[104:107]
    s_waitcnt lgkmcnt(3)
    v_mfma_f32_16x16x32_bf16 v[108:111], v[52:55], v[212:215], 0
    s_waitcnt lgkmcnt(2)
    v_mfma_f32_16x16x32_bf16 v[112:115], v[56:59], v[212:215], 0
    v_mfma_f32_16x16x32_bf16 v[116:119], v[52:55], v[224:227], 0
    v_mfma_f32_16x16x32_bf16 v[120:123], v[56:59], v[224:227], 0
    v_mfma_f32_16x16x32_bf16 v[108:111], v[56:59], v[216:219], v[108:111]
    v_mfma_f32_16x16x32_bf16 v[112:115], v[52:55], v[220:223], v[112:115]
    v_mfma_f32_16x16x32_bf16 v[116:119], v[56:59], v[228:231], v[116:119]
    v_mfma_f32_16x16x32_bf16 v[120:123], v[52:55], v[232:235], v[120:123]
    v_cvt_pk_bf16_f32 v92, v92, v93
    v_cvt_pk_bf16_f32 v93, v94, v95
    v_cvt_pk_bf16_f32 v94, v96, v97
    v_cvt_pk_bf16_f32 v95, v98, v99
    ds_write_b128 v32, v[92:95] offset:0
    v_cvt_pk_bf16_f32 v100, v100, v101
    v_cvt_pk_bf16_f32 v101, v102, v103
    v_cvt_pk_bf16_f32 v102, v104, v105
    v_cvt_pk_bf16_f32 v103, v106, v107
    ds_write_b128 v32, v[100:103] offset:1024
    ds_read_b128 v[68:71], v33 offset:0
    ds_read_b128 v[72:75], v33 offset:1024
    s_waitcnt lgkmcnt(5)
    v_mfma_f32_16x16x32_bf16 v[124:127], v[60:63], v[212:215], 0
    s_waitcnt lgkmcnt(4)
    v_mfma_f32_16x16x32_bf16 v[128:131], v[64:67], v[212:215], 0
    v_mfma_f32_16x16x32_bf16 v[132:135], v[60:63], v[224:227], 0
    v_mfma_f32_16x16x32_bf16 v[136:139], v[64:67], v[224:227], 0
    v_mfma_f32_16x16x32_bf16 v[124:127], v[64:67], v[216:219], v[124:127]
    v_mfma_f32_16x16x32_bf16 v[128:131], v[60:63], v[220:223], v[128:131]
    v_mfma_f32_16x16x32_bf16 v[132:135], v[64:67], v[228:231], v[132:135]
    v_mfma_f32_16x16x32_bf16 v[136:139], v[60:63], v[232:235], v[136:139]
    v_cvt_pk_bf16_f32 v108, v108, v109
    v_cvt_pk_bf16_f32 v109, v110, v111
    v_cvt_pk_bf16_f32 v110, v112, v113
    v_cvt_pk_bf16_f32 v111, v114, v115
    ds_write_b128 v32, v[108:111] offset:2048
    v_cvt_pk_bf16_f32 v116, v116, v117
    v_cvt_pk_bf16_f32 v117, v118, v119
    v_cvt_pk_bf16_f32 v118, v120, v121
    v_cvt_pk_bf16_f32 v119, v122, v123
    ds_write_b128 v32, v[116:119] offset:3072
    ds_read_b128 v[76:79], v33 offset:2048
    ds_read_b128 v[80:83], v33 offset:3072
    s_waitcnt lgkmcnt(5)
    buffer_store_dwordx4 v[68:71], v24, s[36:39], s96 offen sc1
    s_add_u32 s74, s96, 1464320
    s_waitcnt lgkmcnt(4)
    buffer_store_dwordx4 v[72:75], v24, s[36:39], s74 offen sc1
    v_cvt_pk_bf16_f32 v124, v124, v125
    v_cvt_pk_bf16_f32 v125, v126, v127
    v_cvt_pk_bf16_f32 v126, v128, v129
    v_cvt_pk_bf16_f32 v127, v130, v131
    ds_write_b128 v32, v[124:127] offset:0
    v_cvt_pk_bf16_f32 v132, v132, v133
    v_cvt_pk_bf16_f32 v133, v134, v135
    v_cvt_pk_bf16_f32 v134, v136, v137
    v_cvt_pk_bf16_f32 v135, v138, v139
    ds_write_b128 v32, v[132:135] offset:1024
    ds_read_b128 v[68:71], v33 offset:0
    ds_read_b128 v[72:75], v33 offset:1024
    s_waitcnt lgkmcnt(5)
    buffer_store_dwordx4 v[76:79], v24, s[36:39], s97 offen sc1
    s_add_u32 s74, s97, 1464320
    s_waitcnt lgkmcnt(4)
    buffer_store_dwordx4 v[80:83], v24, s[36:39], s74 offen sc1
    s_waitcnt lgkmcnt(1)
    buffer_store_dwordx4 v[68:71], v24, s[36:39], s98 offen sc1
    s_add_u32 s74, s98, 1464320
    s_waitcnt lgkmcnt(0)
    buffer_store_dwordx4 v[72:75], v24, s[36:39], s74 offen sc1
    s_waitcnt vmcnt(0)
    s_and_b32 s79, s83, 7
    s_lshl_b32 s79, s79, 6
    s_add_u32 s88, s79, 0xc20000
    v_mov_b32 v12, 40
    v_mov_b32 v13, 1
    s_mov_b64 exec, 1
    ds_add_rtn_u32 v14, v12, v13
    s_mov_b64 exec, -1
    s_waitcnt lgkmcnt(0)
    v_readfirstlane_b32 s87, v14
    s_cmp_lg_u32 s87, 7
    s_cbranch_scc1 L26
    v_mov_b32 v13, 1
    v_lshlrev_b32 v12, 9, v0
    buffer_atomic_add v13, v12, s[36:39], s88 offen sc1
    s_mov_b64 exec, -1
L26:
    s_mov_b32 s100, 4
    s_cmp_lt_u32 s3, 4
    s_cbranch_scc1 L27
    s_and_b32 s79, s2, 7
    s_lshl_b32 s79, s79, 2
    s_lshr_b32 s78, s2, 3
    s_and_b32 s78, s78, 3
    s_add_u32 s4, s79, s78
    s_lshr_b32 s5, s2, 5
    s_mov_b32 s101, 0
    s_branch FINAL_D
L27:
    s_and_b32 s79, s83, 63
    s_lshl_b32 s79, s79, 9
    s_add_u32 s88, s79, 0xc20000
    v_and_b32 v19, 7, v0
    v_lshlrev_b32 v19, 6, v19
    s_mov_b32 s4, -2.0
    s_mov_b32 s5, -2.0
    v_lshlrev_b32 v15, 4, v0
    v_add_u32 v35, 0x23d20, v15
    ds_read_b128 v[44:47], v35 offset:0
    ds_read_b128 v[48:51], v35 offset:1024
    ds_read_b128 v[52:55], v35 offset:2048
    ds_read_b128 v[56:59], v35 offset:3072
    ds_read_b128 v[60:63], v35 offset:4096
    ds_read_b128 v[64:67], v35 offset:5120
    ds_read_b128 v[68:71], v35 offset:6144
    ds_read_b128 v[72:75], v35 offset:7168
    ds_read_b128 v[76:79], v35 offset:8192
    ds_read_b128 v[80:83], v35 offset:9216
    ds_read_b128 v[84:87], v35 offset:10240
    ds_read_b128 v[88:91], v35 offset:11264
    ds_read_b128 v[92:95], v35 offset:12288
    ds_read_b128 v[96:99], v35 offset:13312
    ds_read_b128 v[100:103], v35 offset:14336
    ds_read_b128 v[104:107], v35 offset:15360
    s_mul_i32 s79, s7, 10
    s_add_u32 s79, s79, s80
    s_mov_b32 s92, s79
    s_mul_i32 s79, s7, 10
    s_add_u32 s79, s79, s80
    s_add_u32 s93, s79, 4
    s_mul_i32 s79, s7, 10
    s_add_u32 s79, s79, s80
    s_add_u32 s94, s79, 8
    s_add_u32 s99, s7, 2
    s_cmp_lt_u32 s80, s99
    s_cselect_b32 s99, 1, 0
    v_and_b32 v15, 15, v0
    v_lshrrev_b32 v14, 4, v0
    v_mul_u32_u24 v14, 0x540, v14
    v_lshl_add_u32 v14, v15, 2, v14
    s_lshr_b32 s79, s92, 1
    s_lshl_b32 s79, s79, 6
    s_and_b32 s78, s92, 1
    s_lshl_b32 s78, s78, 1
    s_add_u32 s78, s79, s78
    s_and_b32 s79, s82, 1
    s_lshl_b32 s79, s79, 1
    s_add_u32 s79, s78, s79
    s_mul_i32 s78, s7, 0x134
    s_sub_u32 s78, s79, s78
    s_add_u32 s78, s78, 0xa800
    v_add_u32 v32, s78, v14
    v_mov_b32 v108, 0
    v_mov_b32 v109, 0
    v_mov_b32 v110, 0
    v_mov_b32 v111, 0
    v_mov_b32 v112, 0
    v_mov_b32 v113, 0
    v_mov_b32 v114, 0
    v_mov_b32 v115, 0
    v_mov_b32 v116, 0
    v_mov_b32 v117, 0
    v_mov_b32 v118, 0
    v_mov_b32 v119, 0
    v_mov_b32 v120, 0
    v_mov_b32 v121, 0
    v_mov_b32 v122, 0
    v_mov_b32 v123, 0
    v_mov_b32 v124, 0
    v_mov_b32 v125, 0
    v_mov_b32 v126, 0
    v_mov_b32 v127, 0
    v_mov_b32 v128, 0
    v_mov_b32 v129, 0
    v_mov_b32 v130, 0
    v_mov_b32 v131, 0
    v_mov_b32 v132, 0
    v_mov_b32 v133, 0
    v_mov_b32 v134, 0
    v_mov_b32 v135, 0
    v_mov_b32 v136, 0
    v_mov_b32 v137, 0
    v_mov_b32 v138, 0
    v_mov_b32 v139, 0
    v_mov_b32 v140, 0
    v_mov_b32 v141, 0
    v_mov_b32 v142, 0
    v_mov_b32 v143, 0
    v_mov_b32 v144, 0
    v_mov_b32 v145, 0
    v_mov_b32 v146, 0
    v_mov_b32 v147, 0
    v_mov_b32 v148, 0
    v_mov_b32 v149, 0
    v_mov_b32 v150, 0
    v_mov_b32 v151, 0
    v_mov_b32 v152, 0
    v_mov_b32 v153, 0
    v_mov_b32 v154, 0
    v_mov_b32 v155, 0
    v_mov_b32 v156, 0
    v_mov_b32 v157, 0
    v_mov_b32 v158, 0
    v_mov_b32 v159, 0
    v_mov_b32 v160, 0
    v_mov_b32 v161, 0
    v_mov_b32 v162, 0
    v_mov_b32 v163, 0
    v_mov_b32 v164, 0
    v_mov_b32 v165, 0
    v_mov_b32 v166, 0
    v_mov_b32 v167, 0
    v_mov_b32 v168, 0
    v_mov_b32 v169, 0
    v_mov_b32 v170, 0
    v_mov_b32 v171, 0
    ds_read_u16_d16_hi v108, v32 offset:0
    ds_read_u16_d16_hi v109, v32 offset:336
    ds_read_u16_d16_hi v110, v32 offset:672
    ds_read_u16_d16_hi v111, v32 offset:1008
    ds_read_u16_d16_hi v112, v32 offset:5376
    ds_read_u16_d16_hi v113, v32 offset:5712
    ds_read_u16_d16_hi v114, v32 offset:6048
    ds_read_u16_d16_hi v115, v32 offset:6384
    ds_read_u16_d16_hi v116, v32 offset:10752
    ds_read_u16_d16_hi v117, v32 offset:11088
    ds_read_u16_d16_hi v118, v32 offset:11424
    ds_read_u16_d16_hi v119, v32 offset:11760
    ds_read_u16_d16_hi v120, v32 offset:16128
    ds_read_u16_d16_hi v121, v32 offset:16464
    ds_read_u16_d16_hi v122, v32 offset:16800
    ds_read_u16_d16_hi v123, v32 offset:17136
    ds_read_u16_d16_hi v124, v32 offset:21504
    ds_read_u16_d16_hi v125, v32 offset:21840
    ds_read_u16_d16_hi v126, v32 offset:22176
    ds_read_u16_d16_hi v127, v32 offset:22512
    ds_read_u16_d16_hi v128, v32 offset:26880
    ds_read_u16_d16_hi v129, v32 offset:27216
    ds_read_u16_d16_hi v130, v32 offset:27552
    ds_read_u16_d16_hi v131, v32 offset:27888
    ds_read_u16_d16_hi v132, v32 offset:32256
    ds_read_u16_d16_hi v133, v32 offset:32592
    ds_read_u16_d16_hi v134, v32 offset:32928
    ds_read_u16_d16_hi v135, v32 offset:33264
    ds_read_u16_d16_hi v136, v32 offset:37632
    ds_read_u16_d16_hi v137, v32 offset:37968
    ds_read_u16_d16_hi v138, v32 offset:38304
    ds_read_u16_d16_hi v139, v32 offset:38640
    ds_read_u16_d16_hi v140, v32 offset:128
    ds_read_u16_d16_hi v141, v32 offset:464
    ds_read_u16_d16_hi v142, v32 offset:800
    ds_read_u16_d16_hi v143, v32 offset:1136
    ds_read_u16_d16_hi v144, v32 offset:5504
    ds_read_u16_d16_hi v145, v32 offset:5840
    ds_read_u16_d16_hi v146, v32 offset:6176
    ds_read_u16_d16_hi v147, v32 offset:6512
    ds_read_u16_d16_hi v148, v32 offset:10880
    ds_read_u16_d16_hi v149, v32 offset:11216
    ds_read_u16_d16_hi v150, v32 offset:11552
    ds_read_u16_d16_hi v151, v32 offset:11888
    ds_read_u16_d16_hi v152, v32 offset:16256
    ds_read_u16_d16_hi v153, v32 offset:16592
    ds_read_u16_d16_hi v154, v32 offset:16928
    ds_read_u16_d16_hi v155, v32 offset:17264
    ds_read_u16_d16_hi v156, v32 offset:21632
    ds_read_u16_d16_hi v157, v32 offset:21968
    ds_read_u16_d16_hi v158, v32 offset:22304
    ds_read_u16_d16_hi v159, v32 offset:22640
    ds_read_u16_d16_hi v160, v32 offset:27008
    ds_read_u16_d16_hi v161, v32 offset:27344
    ds_read_u16_d16_hi v162, v32 offset:27680
    ds_read_u16_d16_hi v163, v32 offset:28016
    ds_read_u16_d16_hi v164, v32 offset:32384
    ds_read_u16_d16_hi v165, v32 offset:32720
    ds_read_u16_d16_hi v166, v32 offset:33056
    ds_read_u16_d16_hi v167, v32 offset:33392
    ds_read_u16_d16_hi v168, v32 offset:37760
    ds_read_u16_d16_hi v169, v32 offset:38096
    ds_read_u16_d16_hi v170, v32 offset:38432
    ds_read_u16_d16_hi v171, v32 offset:38768
    v_and_b32 v15, 3, v0
    v_lshrrev_b32 v14, 2, v0
    v_mul_u32_u24 v14, 0xa080, v14
    v_lshl_add_u32 v26, v15, 4, v14
    v_lshrrev_b32 v15, 2, v0
    v_and_b32 v14, 3, v0
    v_lshlrev_b32 v14, 28, v14
    v_lshl_add_u32 v27, v15, 9, v14
    s_lshr_b32 s79, s82, 1
    s_lshl_b32 s79, s79, 6
    s_lshl_b32 s78, s92, 11
    s_and_b32 s77, s82, 1
    s_lshl_b32 s77, s77, 10
    s_add_u32 s77, s78, s77
    s_add_u32 s77, s79, s77
    s_add_u32 s90, s77, 0x8b0000
    s_lshr_b32 s79, s82, 1
    s_lshl_b32 s79, s79, 6
    s_lshl_b32 s78, s93, 11
    s_and_b32 s77, s82, 1
    s_lshl_b32 s77, s77, 10
    s_add_u32 s77, s78, s77
    s_add_u32 s77, s79, s77
    s_add_u32 s91, s77, 0x8b0000
    s_lshr_b32 s79, s82, 1
    s_lshl_b32 s79, s79, 6
    s_lshl_b32 s78, s94, 11
    s_and_b32 s77, s82, 1
    s_lshl_b32 s77, s77, 10
    s_add_u32 s77, s78, s77
    s_add_u32 s77, s79, s77
    s_add_u32 s95, s77, 0x8b0000
    s_and_b32 s79, s82, 1
    s_lshl_b32 s79, s79, 8
    s_lshr_b32 s78, s82, 1
    s_lshl_b32 s78, s78, 4
    s_add_u32 s78, s79, s78
    s_add_u32 s74, s78, 0x560000
    s_cmp_eq_u32 s94, 20
    s_cselect_b32 s95, s74, s95
    s_mov_b32 s101, 8192
    s_cselect_b32 s101, s101, 657408
    s_cselect_b64 vcc, -1, 0
    v_cndmask_b32 v27, v26, v27, vcc
    v_lshrrev_b32 v15, 4, v0
    v_lshrrev_b32 v14, 2, v0
    v_and_b32 v14, 3, v14
    v_lshl_add_u32 v14, v15, 2, v14
    v_and_b32 v15, 3, v0
    v_lshlrev_b32 v15, 4, v15
    v_lshl_add_u32 v15, v14, 6, v15
    s_lshl_b32 s79, s80, 12
    s_add_u32 s79, s79, 0x15000
    v_add_u32 v30, s79, v15
    s_mul_i32 s79, s82, 0x16580
    s_mul_i32 s78, s92, 0x1100
    s_add_u32 s78, s79, s78
    s_add_u32 s96, s78, 0x280000
    s_mul_i32 s79, s82, 0x16580
    s_mul_i32 s78, s93, 0x1100
    s_add_u32 s78, s79, s78
    s_add_u32 s97, s78, 0x280000
    s_mul_i32 s79, s82, 0x16580
    s_mul_i32 s78, s94, 0x1100
    s_add_u32 s78, s79, s78
    s_add_u32 s98, s78, 0x280000
    s_cmp_lg_u32 s99, 0
    s_cselect_b32 s98, s98, 0x40000000
    s_lshl_b32 s79, s80, 12
    s_add_u32 s86, s79, 0x15000
    s_mov_b32 s89, 2000
    v_add_u32 v40, s86, v40
    v_add_u32 v41, s86, v41
    v_mov_b32 v36, 1
    v_mov_b32 v37, 0
    s_waitcnt lgkmcnt(0)
    s_nop 0
    s_cmp_lg_u32 s3, 0
    s_cbranch_scc1 L28
    buffer_load_dword v18, v19, s[36:39], s88 offen offset:0 sc1
    s_waitcnt vmcnt(0)
    v_cmp_ne_u32 vcc, 8, v18
    s_cmp_eq_u64 vcc, 0
    s_cbranch_scc1 L30
    s_mov_b32 s87, 0x8000
L31:
    s_sub_u32 s87, s87, 1
    s_cbranch_scc1 L30
    s_sleep 1
    buffer_load_dword v18, v19, s[36:39], s88 offen offset:0 sc1
    s_waitcnt vmcnt(0)
    v_cmp_ne_u32 vcc, 8, v18
    s_cmp_eq_u64 vcc, 0
    s_cbranch_scc0 L31
L30:
    ds_write_b32 v37, v36 offset:56
    s_nop 1
    s_branch L29
L28:
    s_mov_b32 s87, 0x100000
L32:
    s_sub_u32 s87, s87, 1
    s_cbranch_scc1 L29
    ds_read_b32 v18, v37 offset:56
    s_waitcnt lgkmcnt(0)
    v_readfirstlane_b32 s74, v18
    s_cmp_eq_u32 s74, 0
    s_cbranch_scc1 L32
    s_nop 2
L29:
    s_add_u32 m0, s86, 0
    s_nop 0
    buffer_load_dwordx4 v6, s[36:39], s96 offen offset:0 sc1 lds
    buffer_load_dwordx4 v6, s[36:39], s96 offen offset:1024 sc1 lds
    buffer_load_dwordx4 v6, s[36:39], s96 offen offset:2048 sc1 lds
    buffer_load_dwordx4 v6, s[36:39], s96 offen offset:3072 sc1 lds
    s_add_u32 m0, s86, 16384
    s_nop 0
    buffer_load_dwordx4 v6, s[36:39], s97 offen offset:0 sc1 lds
    buffer_load_dwordx4 v6, s[36:39], s97 offen offset:1024 sc1 lds
    buffer_load_dwordx4 v6, s[36:39], s97 offen offset:2048 sc1 lds
    buffer_load_dwordx4 v6, s[36:39], s97 offen offset:3072 sc1 lds
    s_add_u32 m0, s86, 32768
    s_nop 0
    buffer_load_dwordx4 v6, s[36:39], s98 offen offset:0 sc1 lds
    buffer_load_dwordx4 v6, s[36:39], s98 offen offset:1024 sc1 lds
    buffer_load_dwordx4 v6, s[36:39], s98 offen offset:2048 sc1 lds
    buffer_load_dwordx4 v6, s[36:39], s98 offen offset:3072 sc1 lds
    s_waitcnt vmcnt(8)
    ds_read_b64_tr_b16 v[172:173], v30 offset:0
    ds_read_b64_tr_b16 v[174:175], v30 offset:1024
    ds_read_b64_tr_b16 v[176:177], v30 offset:8
    ds_read_b64_tr_b16 v[178:179], v30 offset:1032
    ds_read_b64_tr_b16 v[180:181], v30 offset:2048
    ds_read_b64_tr_b16 v[182:183], v30 offset:3072
    ds_read_b64_tr_b16 v[184:185], v30 offset:2056
    ds_read_b64_tr_b16 v[186:187], v30 offset:3080
    s_waitcnt lgkmcnt(7)
    v_xor_b32 v188, 0x80008000, v172
    v_xor_b32 v189, 0x80008000, v173
    s_waitcnt lgkmcnt(6)
    v_xor_b32 v190, 0x80008000, v174
    v_xor_b32 v191, 0x80008000, v175
    s_waitcnt lgkmcnt(3)
    v_xor_b32 v192, 0x80008000, v180
    v_xor_b32 v193, 0x80008000, v181
    s_waitcnt lgkmcnt(2)
    v_xor_b32 v194, 0x80008000, v182
    v_xor_b32 v195, 0x80008000, v183
    v_mfma_f32_16x16x32_bf16 v[196:199], v[44:47], v[172:175], 0
    v_mfma_f32_16x16x32_bf16 v[200:203], v[44:47], v[176:179], 0
    v_mfma_f32_16x16x32_bf16 v[212:215], v[48:51], v[180:183], 0
    s_waitcnt lgkmcnt(0)
    v_mfma_f32_16x16x32_bf16 v[216:219], v[48:51], v[184:187], 0
    v_mfma_f32_16x16x32_bf16 v[196:199], v[60:63], v[176:179], v[196:199]
    v_mfma_f32_16x16x32_bf16 v[200:203], v[60:63], v[188:191], v[200:203]
    v_mfma_f32_16x16x32_bf16 v[212:215], v[64:67], v[184:187], v[212:215]
    v_mfma_f32_16x16x32_bf16 v[216:219], v[64:67], v[192:195], v[216:219]
    v_mfma_f32_16x16x32_bf16 v[204:207], v[52:55], v[172:175], 0
    v_mfma_f32_16x16x32_bf16 v[208:211], v[52:55], v[176:179], 0
    v_mfma_f32_16x16x32_bf16 v[220:223], v[56:59], v[180:183], 0
    v_mfma_f32_16x16x32_bf16 v[224:227], v[56:59], v[184:187], 0
    v_mfma_f32_16x16x32_bf16 v[204:207], v[68:71], v[176:179], v[204:207]
    v_mfma_f32_16x16x32_bf16 v[208:211], v[68:71], v[188:191], v[208:211]
    v_mfma_f32_16x16x32_bf16 v[220:223], v[72:75], v[184:187], v[220:223]
    v_mfma_f32_16x16x32_bf16 v[224:227], v[72:75], v[192:195], v[224:227]
    v_pk_add_f32 v[196:197], v[196:197], v[212:213]
    v_pk_add_f32 v[198:199], v[198:199], v[214:215]
    v_pk_add_f32 v[200:201], v[200:201], v[216:217]
    v_pk_add_f32 v[202:203], v[202:203], v[218:219]
    v_pk_fma_f32 v[212:213], v[212:213], s[4:5], v[196:197]
    v_pk_fma_f32 v[214:215], v[214:215], s[4:5], v[198:199]
    v_pk_fma_f32 v[216:217], v[216:217], s[4:5], v[200:201]
    v_pk_fma_f32 v[218:219], v[218:219], s[4:5], v[202:203]
    v_pk_add_f32 v[204:205], v[204:205], v[220:221]
    v_pk_add_f32 v[206:207], v[206:207], v[222:223]
    v_pk_add_f32 v[208:209], v[208:209], v[224:225]
    v_pk_add_f32 v[210:211], v[210:211], v[226:227]
    v_pk_fma_f32 v[220:221], v[220:221], s[4:5], v[204:205]
    v_pk_fma_f32 v[222:223], v[222:223], s[4:5], v[206:207]
    v_pk_fma_f32 v[224:225], v[224:225], s[4:5], v[208:209]
    v_pk_fma_f32 v[226:227], v[226:227], s[4:5], v[210:211]
    s_waitcnt vmcnt(4)
    ds_read_b64_tr_b16 v[172:173], v30 offset:16384
    ds_read_b64_tr_b16 v[174:175], v30 offset:17408
    ds_read_b64_tr_b16 v[176:177], v30 offset:16392
    ds_read_b64_tr_b16 v[178:179], v30 offset:17416
    ds_read_b64_tr_b16 v[180:181], v30 offset:18432
    ds_read_b64_tr_b16 v[182:183], v30 offset:19456
    ds_read_b64_tr_b16 v[184:185], v30 offset:18440
    ds_read_b64_tr_b16 v[186:187], v30 offset:19464
    v_pk_mul_f32 v[188:189], v[200:201], v[124:125]
    v_pk_mul_f32 v[192:193], v[196:197], v[124:125]
    v_pk_mul_f32 v[190:191], v[202:203], v[126:127]
    v_pk_mul_f32 v[194:195], v[198:199], v[126:127]
    v_pk_fma_f32 v[188:189], v[196:197], v[108:109], v[188:189] neg_lo:[0,0,1] neg_hi:[0,0,1]
    v_pk_fma_f32 v[192:193], v[200:201], v[108:109], v[192:193]
    v_pk_fma_f32 v[190:191], v[198:199], v[110:111], v[190:191] neg_lo:[0,0,1] neg_hi:[0,0,1]
    v_pk_fma_f32 v[194:195], v[202:203], v[110:111], v[194:195]
    v_cvt_pk_bf16_f32 v228, v188, v190
    v_cvt_pk_bf16_f32 v236, v192, v194
    v_cvt_pk_bf16_f32 v244, -v192, -v194
    v_cvt_pk_bf16_f32 v232, v189, v191
    v_cvt_pk_bf16_f32 v240, v193, v195
    v_cvt_pk_bf16_f32 v248, -v193, -v195
    v_pk_mul_f32 v[188:189], v[208:209], v[128:129]
    v_pk_mul_f32 v[192:193], v[204:205], v[128:129]
    v_pk_mul_f32 v[190:191], v[210:211], v[130:131]
    v_pk_mul_f32 v[194:195], v[206:207], v[130:131]
    v_pk_fma_f32 v[188:189], v[204:205], v[112:113], v[188:189] neg_lo:[0,0,1] neg_hi:[0,0,1]
    v_pk_fma_f32 v[192:193], v[208:209], v[112:113], v[192:193]
    v_pk_fma_f32 v[190:191], v[206:207], v[114:115], v[190:191] neg_lo:[0,0,1] neg_hi:[0,0,1]
    v_pk_fma_f32 v[194:195], v[210:211], v[114:115], v[194:195]
    v_cvt_pk_bf16_f32 v229, v188, v190
    v_cvt_pk_bf16_f32 v237, v192, v194
    v_cvt_pk_bf16_f32 v245, -v192, -v194
    v_cvt_pk_bf16_f32 v233, v189, v191
    v_cvt_pk_bf16_f32 v241, v193, v195
    v_cvt_pk_bf16_f32 v249, -v193, -v195
    v_pk_mul_f32 v[188:189], v[216:217], v[132:133]
    v_pk_mul_f32 v[192:193], v[212:213], v[132:133]
    v_pk_mul_f32 v[190:191], v[218:219], v[134:135]
    v_pk_mul_f32 v[194:195], v[214:215], v[134:135]
    v_pk_fma_f32 v[188:189], v[212:213], v[116:117], v[188:189] neg_lo:[0,0,1] neg_hi:[0,0,1]
    v_pk_fma_f32 v[192:193], v[216:217], v[116:117], v[192:193]
    v_pk_fma_f32 v[190:191], v[214:215], v[118:119], v[190:191] neg_lo:[0,0,1] neg_hi:[0,0,1]
    v_pk_fma_f32 v[194:195], v[218:219], v[118:119], v[194:195]
    v_cvt_pk_bf16_f32 v230, v188, v190
    v_cvt_pk_bf16_f32 v238, v192, v194
    v_cvt_pk_bf16_f32 v246, -v192, -v194
    v_cvt_pk_bf16_f32 v234, v189, v191
    v_cvt_pk_bf16_f32 v242, v193, v195
    v_cvt_pk_bf16_f32 v250, -v193, -v195
    v_pk_mul_f32 v[188:189], v[224:225], v[136:137]
    v_pk_mul_f32 v[192:193], v[220:221], v[136:137]
    v_pk_mul_f32 v[190:191], v[226:227], v[138:139]
    v_pk_mul_f32 v[194:195], v[222:223], v[138:139]
    v_pk_fma_f32 v[188:189], v[220:221], v[120:121], v[188:189] neg_lo:[0,0,1] neg_hi:[0,0,1]
    v_pk_fma_f32 v[192:193], v[224:225], v[120:121], v[192:193]
    v_pk_fma_f32 v[190:191], v[222:223], v[122:123], v[190:191] neg_lo:[0,0,1] neg_hi:[0,0,1]
    v_pk_fma_f32 v[194:195], v[226:227], v[122:123], v[194:195]
    v_cvt_pk_bf16_f32 v231, v188, v190
    v_cvt_pk_bf16_f32 v239, v192, v194
    v_cvt_pk_bf16_f32 v247, -v192, -v194
    v_cvt_pk_bf16_f32 v235, v189, v191
    v_cvt_pk_bf16_f32 v243, v193, v195
    v_cvt_pk_bf16_f32 v251, -v193, -v195
    v_mfma_f32_16x16x32_bf16 v[196:199], v[228:231], v[76:79], 0
    v_mfma_f32_16x16x32_bf16 v[200:203], v[236:239], v[76:79], 0
    v_mfma_f32_16x16x32_bf16 v[212:215], v[232:235], v[80:83], 0
    v_mfma_f32_16x16x32_bf16 v[216:219], v[240:243], v[80:83], 0
    v_mfma_f32_16x16x32_bf16 v[196:199], v[244:247], v[92:95], v[196:199]
    v_mfma_f32_16x16x32_bf16 v[200:203], v[228:231], v[92:95], v[200:203]
    v_mfma_f32_16x16x32_bf16 v[212:215], v[248:251], v[96:99], v[212:215]
    v_mfma_f32_16x16x32_bf16 v[216:219], v[232:235], v[96:99], v[216:219]
    s_cmp_eq_u32 s94, 20
    s_cselect_b32 exec_lo, 0x00010001, -1
    s_cselect_b32 exec_hi, 0x00010001, -1
    ds_read_u16_d16_hi v108, v32 offset:256
    ds_read_u16_d16_hi v109, v32 offset:592
    ds_read_u16_d16_hi v110, v32 offset:928
    ds_read_u16_d16_hi v111, v32 offset:1264
    ds_read_u16_d16_hi v112, v32 offset:5632
    ds_read_u16_d16_hi v113, v32 offset:5968
    ds_read_u16_d16_hi v114, v32 offset:6304
    ds_read_u16_d16_hi v115, v32 offset:6640
    ds_read_u16_d16_hi v116, v32 offset:11008
    ds_read_u16_d16_hi v117, v32 offset:11344
    ds_read_u16_d16_hi v118, v32 offset:11680
    ds_read_u16_d16_hi v119, v32 offset:12016
    ds_read_u16_d16_hi v120, v32 offset:16384
    ds_read_u16_d16_hi v121, v32 offset:16720
    ds_read_u16_d16_hi v122, v32 offset:17056
    ds_read_u16_d16_hi v123, v32 offset:17392
    ds_read_u16_d16_hi v124, v32 offset:21760
    ds_read_u16_d16_hi v125, v32 offset:22096
    ds_read_u16_d16_hi v126, v32 offset:22432
    ds_read_u16_d16_hi v127, v32 offset:22768
    ds_read_u16_d16_hi v128, v32 offset:27136
    ds_read_u16_d16_hi v129, v32 offset:27472
    ds_read_u16_d16_hi v130, v32 offset:27808
    ds_read_u16_d16_hi v131, v32 offset:28144
    ds_read_u16_d16_hi v132, v32 offset:32512
    ds_read_u16_d16_hi v133, v32 offset:32848
    ds_read_u16_d16_hi v134, v32 offset:33184
    ds_read_u16_d16_hi v135, v32 offset:33520
    ds_read_u16_d16_hi v136, v32 offset:37888
    ds_read_u16_d16_hi v137, v32 offset:38224
    ds_read_u16_d16_hi v138, v32 offset:38560
    ds_read_u16_d16_hi v139, v32 offset:38896
    s_mov_b64 exec, -1
    v_mfma_f32_16x16x32_bf16 v[204:207], v[228:231], v[84:87], 0
    v_mfma_f32_16x16x32_bf16 v[208:211], v[236:239], v[84:87], 0
    v_mfma_f32_16x16x32_bf16 v[220:223], v[232:235], v[88:91], 0
    v_mfma_f32_16x16x32_bf16 v[224:227], v[240:243], v[88:91], 0
    v_mfma_f32_16x16x32_bf16 v[204:207], v[244:247], v[100:103], v[204:207]
    v_mfma_f32_16x16x32_bf16 v[208:211], v[228:231], v[100:103], v[208:211]
    v_mfma_f32_16x16x32_bf16 v[220:223], v[248:251], v[104:107], v[220:223]
    v_mfma_f32_16x16x32_bf16 v[224:227], v[232:235], v[104:107], v[224:227]
    v_pk_add_f32 v[196:197], v[196:197], v[212:213]
    v_pk_add_f32 v[198:199], v[198:199], v[214:215]
    v_pk_add_f32 v[200:201], v[200:201], v[216:217]
    v_pk_add_f32 v[202:203], v[202:203], v[218:219]
    v_pk_fma_f32 v[212:213], v[212:213], s[4:5], v[196:197]
    v_pk_fma_f32 v[214:215], v[214:215], s[4:5], v[198:199]
    v_pk_fma_f32 v[216:217], v[216:217], s[4:5], v[200:201]
    v_pk_fma_f32 v[218:219], v[218:219], s[4:5], v[202:203]
    v_cvt_pk_bf16_f32 v196, v196, v197
    v_cvt_pk_bf16_f32 v197, v198, v199
    v_cvt_pk_bf16_f32 v198, v200, v201
    v_cvt_pk_bf16_f32 v199, v202, v203
    ds_write_b128 v40, v[196:199] offset:0
    v_cvt_pk_bf16_f32 v212, v212, v213
    v_cvt_pk_bf16_f32 v213, v214, v215
    v_cvt_pk_bf16_f32 v214, v216, v217
    v_cvt_pk_bf16_f32 v215, v218, v219
    ds_write_b128 v40, v[212:215] offset:2048
    ds_read_b128 v[228:231], v41 offset:0
    ds_read_b128 v[236:239], v41 offset:2048
    v_pk_add_f32 v[204:205], v[204:205], v[220:221]
    v_pk_add_f32 v[206:207], v[206:207], v[222:223]
    v_pk_add_f32 v[208:209], v[208:209], v[224:225]
    v_pk_add_f32 v[210:211], v[210:211], v[226:227]
    v_pk_fma_f32 v[220:221], v[220:221], s[4:5], v[204:205]
    v_pk_fma_f32 v[222:223], v[222:223], s[4:5], v[206:207]
    v_pk_fma_f32 v[224:225], v[224:225], s[4:5], v[208:209]
    v_pk_fma_f32 v[226:227], v[226:227], s[4:5], v[210:211]
    v_cvt_pk_bf16_f32 v204, v204, v205
    v_cvt_pk_bf16_f32 v205, v206, v207
    v_cvt_pk_bf16_f32 v206, v208, v209
    v_cvt_pk_bf16_f32 v207, v210, v211
    ds_write_b128 v40, v[204:207] offset:1024
    v_cvt_pk_bf16_f32 v220, v220, v221
    v_cvt_pk_bf16_f32 v221, v222, v223
    v_cvt_pk_bf16_f32 v222, v224, v225
    v_cvt_pk_bf16_f32 v223, v226, v227
    ds_write_b128 v40, v[220:223] offset:3072
    ds_read_b128 v[232:235], v41 offset:1024
    ds_read_b128 v[240:243], v41 offset:3072
    s_waitcnt vmcnt(0)
    s_mov_b32 s74, s90
    s_waitcnt lgkmcnt(5)
    buffer_store_dwordx4 v[228:231], v26, s[36:39], s74 offen sc1
    s_add_u32 s74, s74, 657408
    s_waitcnt lgkmcnt(1)
    buffer_store_dwordx4 v[232:235], v26, s[36:39], s74 offen sc1
    s_add_u32 s74, s74, 657408
    buffer_store_dwordx4 v[236:239], v26, s[36:39], s74 offen sc1
    s_add_u32 s74, s74, 657408
    s_waitcnt lgkmcnt(0)
    buffer_store_dwordx4 v[240:243], v26, s[36:39], s74 offen sc1
    v_xor_b32 v188, 0x80008000, v172
    v_xor_b32 v189, 0x80008000, v173
    v_xor_b32 v190, 0x80008000, v174
    v_xor_b32 v191, 0x80008000, v175
    v_xor_b32 v192, 0x80008000, v180
    v_xor_b32 v193, 0x80008000, v181
    v_xor_b32 v194, 0x80008000, v182
    v_xor_b32 v195, 0x80008000, v183
    v_mfma_f32_16x16x32_bf16 v[196:199], v[44:47], v[172:175], 0
    v_mfma_f32_16x16x32_bf16 v[200:203], v[44:47], v[176:179], 0
    v_mfma_f32_16x16x32_bf16 v[212:215], v[48:51], v[180:183], 0
    v_mfma_f32_16x16x32_bf16 v[216:219], v[48:51], v[184:187], 0
    v_mfma_f32_16x16x32_bf16 v[196:199], v[60:63], v[176:179], v[196:199]
    v_mfma_f32_16x16x32_bf16 v[200:203], v[60:63], v[188:191], v[200:203]
    v_mfma_f32_16x16x32_bf16 v[212:215], v[64:67], v[184:187], v[212:215]
    v_mfma_f32_16x16x32_bf16 v[216:219], v[64:67], v[192:195], v[216:219]
    v_mfma_f32_16x16x32_bf16 v[204:207], v[52:55], v[172:175], 0
    v_mfma_f32_16x16x32_bf16 v[208:211], v[52:55], v[176:179], 0
    v_mfma_f32_16x16x32_bf16 v[220:223], v[56:59], v[180:183], 0
    v_mfma_f32_16x16x32_bf16 v[224:227], v[56:59], v[184:187], 0
    v_mfma_f32_16x16x32_bf16 v[204:207], v[68:71], v[176:179], v[204:207]
    v_mfma_f32_16x16x32_bf16 v[208:211], v[68:71], v[188:191], v[208:211]
    v_mfma_f32_16x16x32_bf16 v[220:223], v[72:75], v[184:187], v[220:223]
    v_mfma_f32_16x16x32_bf16 v[224:227], v[72:75], v[192:195], v[224:227]
    s_mov_b64 exec, 1
    ds_add_u32 v37, v36 offset:52
    s_mov_b64 exec, -1
    v_pk_add_f32 v[196:197], v[196:197], v[212:213]
    v_pk_add_f32 v[198:199], v[198:199], v[214:215]
    v_pk_add_f32 v[200:201], v[200:201], v[216:217]
    v_pk_add_f32 v[202:203], v[202:203], v[218:219]
    v_pk_fma_f32 v[212:213], v[212:213], s[4:5], v[196:197]
    v_pk_fma_f32 v[214:215], v[214:215], s[4:5], v[198:199]
    v_pk_fma_f32 v[216:217], v[216:217], s[4:5], v[200:201]
    v_pk_fma_f32 v[218:219], v[218:219], s[4:5], v[202:203]
    v_pk_add_f32 v[204:205], v[204:205], v[220:221]
    v_pk_add_f32 v[206:207], v[206:207], v[222:223]
    v_pk_add_f32 v[208:209], v[208:209], v[224:225]
    v_pk_add_f32 v[210:211], v[210:211], v[226:227]
    v_pk_fma_f32 v[220:221], v[220:221], s[4:5], v[204:205]
    v_pk_fma_f32 v[222:223], v[222:223], s[4:5], v[206:207]
    v_pk_fma_f32 v[224:225], v[224:225], s[4:5], v[208:209]
    v_pk_fma_f32 v[226:227], v[226:227], s[4:5], v[210:211]
    ds_read_b64_tr_b16 v[172:173], v30 offset:32768
    ds_read_b64_tr_b16 v[174:175], v30 offset:33792
    ds_read_b64_tr_b16 v[176:177], v30 offset:32776
    ds_read_b64_tr_b16 v[178:179], v30 offset:33800
    ds_read_b64_tr_b16 v[180:181], v30 offset:34816
    ds_read_b64_tr_b16 v[182:183], v30 offset:35840
    ds_read_b64_tr_b16 v[184:185], v30 offset:34824
    ds_read_b64_tr_b16 v[186:187], v30 offset:35848
    v_pk_mul_f32 v[188:189], v[200:201], v[156:157]
    v_pk_mul_f32 v[192:193], v[196:197], v[156:157]
    v_pk_mul_f32 v[190:191], v[202:203], v[158:159]
    v_pk_mul_f32 v[194:195], v[198:199], v[158:159]
    v_pk_fma_f32 v[188:189], v[196:197], v[140:141], v[188:189] neg_lo:[0,0,1] neg_hi:[0,0,1]
    v_pk_fma_f32 v[192:193], v[200:201], v[140:141], v[192:193]
    v_pk_fma_f32 v[190:191], v[198:199], v[142:143], v[190:191] neg_lo:[0,0,1] neg_hi:[0,0,1]
    v_pk_fma_f32 v[194:195], v[202:203], v[142:143], v[194:195]
    v_cvt_pk_bf16_f32 v228, v188, v190
    v_cvt_pk_bf16_f32 v236, v192, v194
    v_cvt_pk_bf16_f32 v244, -v192, -v194
    v_cvt_pk_bf16_f32 v232, v189, v191
    v_cvt_pk_bf16_f32 v240, v193, v195
    v_cvt_pk_bf16_f32 v248, -v193, -v195
    v_pk_mul_f32 v[188:189], v[208:209], v[160:161]
    v_pk_mul_f32 v[192:193], v[204:205], v[160:161]
    v_pk_mul_f32 v[190:191], v[210:211], v[162:163]
    v_pk_mul_f32 v[194:195], v[206:207], v[162:163]
    v_pk_fma_f32 v[188:189], v[204:205], v[144:145], v[188:189] neg_lo:[0,0,1] neg_hi:[0,0,1]
    v_pk_fma_f32 v[192:193], v[208:209], v[144:145], v[192:193]
    v_pk_fma_f32 v[190:191], v[206:207], v[146:147], v[190:191] neg_lo:[0,0,1] neg_hi:[0,0,1]
    v_pk_fma_f32 v[194:195], v[210:211], v[146:147], v[194:195]
    v_cvt_pk_bf16_f32 v229, v188, v190
    v_cvt_pk_bf16_f32 v237, v192, v194
    v_cvt_pk_bf16_f32 v245, -v192, -v194
    v_cvt_pk_bf16_f32 v233, v189, v191
    v_cvt_pk_bf16_f32 v241, v193, v195
    v_cvt_pk_bf16_f32 v249, -v193, -v195
    v_pk_mul_f32 v[188:189], v[216:217], v[164:165]
    v_pk_mul_f32 v[192:193], v[212:213], v[164:165]
    v_pk_mul_f32 v[190:191], v[218:219], v[166:167]
    v_pk_mul_f32 v[194:195], v[214:215], v[166:167]
    v_pk_fma_f32 v[188:189], v[212:213], v[148:149], v[188:189] neg_lo:[0,0,1] neg_hi:[0,0,1]
    v_pk_fma_f32 v[192:193], v[216:217], v[148:149], v[192:193]
    v_pk_fma_f32 v[190:191], v[214:215], v[150:151], v[190:191] neg_lo:[0,0,1] neg_hi:[0,0,1]
    v_pk_fma_f32 v[194:195], v[218:219], v[150:151], v[194:195]
    v_cvt_pk_bf16_f32 v230, v188, v190
    v_cvt_pk_bf16_f32 v238, v192, v194
    v_cvt_pk_bf16_f32 v246, -v192, -v194
    v_cvt_pk_bf16_f32 v234, v189, v191
    v_cvt_pk_bf16_f32 v242, v193, v195
    v_cvt_pk_bf16_f32 v250, -v193, -v195
    v_pk_mul_f32 v[188:189], v[224:225], v[168:169]
    v_pk_mul_f32 v[192:193], v[220:221], v[168:169]
    v_pk_mul_f32 v[190:191], v[226:227], v[170:171]
    v_pk_mul_f32 v[194:195], v[222:223], v[170:171]
    v_pk_fma_f32 v[188:189], v[220:221], v[152:153], v[188:189] neg_lo:[0,0,1] neg_hi:[0,0,1]
    v_pk_fma_f32 v[192:193], v[224:225], v[152:153], v[192:193]
    v_pk_fma_f32 v[190:191], v[222:223], v[154:155], v[190:191] neg_lo:[0,0,1] neg_hi:[0,0,1]
    v_pk_fma_f32 v[194:195], v[226:227], v[154:155], v[194:195]
    v_cvt_pk_bf16_f32 v231, v188, v190
    v_cvt_pk_bf16_f32 v239, v192, v194
    v_cvt_pk_bf16_f32 v247, -v192, -v194
    v_cvt_pk_bf16_f32 v235, v189, v191
    v_cvt_pk_bf16_f32 v243, v193, v195
    v_cvt_pk_bf16_f32 v251, -v193, -v195
    v_mfma_f32_16x16x32_bf16 v[196:199], v[228:231], v[76:79], 0
    v_mfma_f32_16x16x32_bf16 v[200:203], v[236:239], v[76:79], 0
    v_mfma_f32_16x16x32_bf16 v[212:215], v[232:235], v[80:83], 0
    v_mfma_f32_16x16x32_bf16 v[216:219], v[240:243], v[80:83], 0
    v_mfma_f32_16x16x32_bf16 v[196:199], v[244:247], v[92:95], v[196:199]
    v_mfma_f32_16x16x32_bf16 v[200:203], v[228:231], v[92:95], v[200:203]
    v_mfma_f32_16x16x32_bf16 v[212:215], v[248:251], v[96:99], v[212:215]
    v_mfma_f32_16x16x32_bf16 v[216:219], v[232:235], v[96:99], v[216:219]
    v_mfma_f32_16x16x32_bf16 v[204:207], v[228:231], v[84:87], 0
    v_mfma_f32_16x16x32_bf16 v[208:211], v[236:239], v[84:87], 0
    v_mfma_f32_16x16x32_bf16 v[220:223], v[232:235], v[88:91], 0
    v_mfma_f32_16x16x32_bf16 v[224:227], v[240:243], v[88:91], 0
    v_mfma_f32_16x16x32_bf16 v[204:207], v[244:247], v[100:103], v[204:207]
    v_mfma_f32_16x16x32_bf16 v[208:211], v[228:231], v[100:103], v[208:211]
    v_mfma_f32_16x16x32_bf16 v[220:223], v[248:251], v[104:107], v[220:223]
    v_mfma_f32_16x16x32_bf16 v[224:227], v[232:235], v[104:107], v[224:227]
    v_pk_add_f32 v[196:197], v[196:197], v[212:213]
    v_pk_add_f32 v[198:199], v[198:199], v[214:215]
    v_pk_add_f32 v[200:201], v[200:201], v[216:217]
    v_pk_add_f32 v[202:203], v[202:203], v[218:219]
    v_pk_fma_f32 v[212:213], v[212:213], s[4:5], v[196:197]
    v_pk_fma_f32 v[214:215], v[214:215], s[4:5], v[198:199]
    v_pk_fma_f32 v[216:217], v[216:217], s[4:5], v[200:201]
    v_pk_fma_f32 v[218:219], v[218:219], s[4:5], v[202:203]
    v_cvt_pk_bf16_f32 v196, v196, v197
    v_cvt_pk_bf16_f32 v197, v198, v199
    v_cvt_pk_bf16_f32 v198, v200, v201
    v_cvt_pk_bf16_f32 v199, v202, v203
    ds_write_b128 v40, v[196:199] offset:16384
    v_cvt_pk_bf16_f32 v212, v212, v213
    v_cvt_pk_bf16_f32 v213, v214, v215
    v_cvt_pk_bf16_f32 v214, v216, v217
    v_cvt_pk_bf16_f32 v215, v218, v219
    ds_write_b128 v40, v[212:215] offset:18432
    ds_read_b128 v[228:231], v41 offset:16384
    ds_read_b128 v[236:239], v41 offset:18432
    v_pk_add_f32 v[204:205], v[204:205], v[220:221]
    v_pk_add_f32 v[206:207], v[206:207], v[222:223]
    v_pk_add_f32 v[208:209], v[208:209], v[224:225]
    v_pk_add_f32 v[210:211], v[210:211], v[226:227]
    v_pk_fma_f32 v[220:221], v[220:221], s[4:5], v[204:205]
    v_pk_fma_f32 v[222:223], v[222:223], s[4:5], v[206:207]
    v_pk_fma_f32 v[224:225], v[224:225], s[4:5], v[208:209]
    v_pk_fma_f32 v[226:227], v[226:227], s[4:5], v[210:211]
    v_cvt_pk_bf16_f32 v204, v204, v205
    v_cvt_pk_bf16_f32 v205, v206, v207
    v_cvt_pk_bf16_f32 v206, v208, v209
    v_cvt_pk_bf16_f32 v207, v210, v211
    ds_write_b128 v40, v[204:207] offset:17408
    v_cvt_pk_bf16_f32 v220, v220, v221
    v_cvt_pk_bf16_f32 v221, v222, v223
    v_cvt_pk_bf16_f32 v222, v224, v225
    v_cvt_pk_bf16_f32 v223, v226, v227
    ds_write_b128 v40, v[220:223] offset:19456
    ds_read_b128 v[232:235], v41 offset:17408
    ds_read_b128 v[240:243], v41 offset:19456
    s_mov_b32 s74, s91
    s_waitcnt lgkmcnt(5)
    buffer_store_dwordx4 v[228:231], v26, s[36:39], s74 offen sc1
    s_add_u32 s74, s74, 657408
    s_waitcnt lgkmcnt(1)
    buffer_store_dwordx4 v[232:235], v26, s[36:39], s74 offen sc1
    s_add_u32 s74, s74, 657408
    buffer_store_dwordx4 v[236:239], v26, s[36:39], s74 offen sc1
    s_add_u32 s74, s74, 657408
    s_waitcnt lgkmcnt(0)
    buffer_store_dwordx4 v[240:243], v26, s[36:39], s74 offen sc1
    s_cmp_eq_u32 s99, 0
    s_cbranch_scc1 L33
    v_xor_b32 v188, 0x80008000, v172
    v_xor_b32 v189, 0x80008000, v173
    v_xor_b32 v190, 0x80008000, v174
    v_xor_b32 v191, 0x80008000, v175
    v_xor_b32 v192, 0x80008000, v180
    v_xor_b32 v193, 0x80008000, v181
    v_xor_b32 v194, 0x80008000, v182
    v_xor_b32 v195, 0x80008000, v183
    v_mfma_f32_16x16x32_bf16 v[196:199], v[44:47], v[172:175], 0
    v_mfma_f32_16x16x32_bf16 v[200:203], v[44:47], v[176:179], 0
    v_mfma_f32_16x16x32_bf16 v[212:215], v[48:51], v[180:183], 0
    v_mfma_f32_16x16x32_bf16 v[216:219], v[48:51], v[184:187], 0
    v_mfma_f32_16x16x32_bf16 v[196:199], v[60:63], v[176:179], v[196:199]
    v_mfma_f32_16x16x32_bf16 v[200:203], v[60:63], v[188:191], v[200:203]
    v_mfma_f32_16x16x32_bf16 v[212:215], v[64:67], v[184:187], v[212:215]
    v_mfma_f32_16x16x32_bf16 v[216:219], v[64:67], v[192:195], v[216:219]
    v_mfma_f32_16x16x32_bf16 v[204:207], v[52:55], v[172:175], 0
    v_mfma_f32_16x16x32_bf16 v[208:211], v[52:55], v[176:179], 0
    v_mfma_f32_16x16x32_bf16 v[220:223], v[56:59], v[180:183], 0
    v_mfma_f32_16x16x32_bf16 v[224:227], v[56:59], v[184:187], 0
    v_mfma_f32_16x16x32_bf16 v[204:207], v[68:71], v[176:179], v[204:207]
    v_mfma_f32_16x16x32_bf16 v[208:211], v[68:71], v[188:191], v[208:211]
    v_mfma_f32_16x16x32_bf16 v[220:223], v[72:75], v[184:187], v[220:223]
    v_mfma_f32_16x16x32_bf16 v[224:227], v[72:75], v[192:195], v[224:227]
    v_pk_add_f32 v[196:197], v[196:197], v[212:213]
    v_pk_add_f32 v[198:199], v[198:199], v[214:215]
    v_pk_add_f32 v[200:201], v[200:201], v[216:217]
    v_pk_add_f32 v[202:203], v[202:203], v[218:219]
    v_pk_fma_f32 v[212:213], v[212:213], s[4:5], v[196:197]
    v_pk_fma_f32 v[214:215], v[214:215], s[4:5], v[198:199]
    v_pk_fma_f32 v[216:217], v[216:217], s[4:5], v[200:201]
    v_pk_fma_f32 v[218:219], v[218:219], s[4:5], v[202:203]
    v_pk_add_f32 v[204:205], v[204:205], v[220:221]
    v_pk_add_f32 v[206:207], v[206:207], v[222:223]
    v_pk_add_f32 v[208:209], v[208:209], v[224:225]
    v_pk_add_f32 v[210:211], v[210:211], v[226:227]
    v_pk_fma_f32 v[220:221], v[220:221], s[4:5], v[204:205]
    v_pk_fma_f32 v[222:223], v[222:223], s[4:5], v[206:207]
    v_pk_fma_f32 v[224:225], v[224:225], s[4:5], v[208:209]
    v_pk_fma_f32 v[226:227], v[226:227], s[4:5], v[210:211]
    v_pk_mul_f32 v[188:189], v[200:201], v[124:125]
    v_pk_mul_f32 v[192:193], v[196:197], v[124:125]
    v_pk_mul_f32 v[190:191], v[202:203], v[126:127]
    v_pk_mul_f32 v[194:195], v[198:199], v[126:127]
    v_pk_fma_f32 v[188:189], v[196:197], v[108:109], v[188:189] neg_lo:[0,0,1] neg_hi:[0,0,1]
    v_pk_fma_f32 v[192:193], v[200:201], v[108:109], v[192:193]
    v_pk_fma_f32 v[190:191], v[198:199], v[110:111], v[190:191] neg_lo:[0,0,1] neg_hi:[0,0,1]
    v_pk_fma_f32 v[194:195], v[202:203], v[110:111], v[194:195]
    v_cvt_pk_bf16_f32 v228, v188, v190
    v_cvt_pk_bf16_f32 v236, v192, v194
    v_cvt_pk_bf16_f32 v244, -v192, -v194
    v_cvt_pk_bf16_f32 v232, v189, v191
    v_cvt_pk_bf16_f32 v240, v193, v195
    v_cvt_pk_bf16_f32 v248, -v193, -v195
    v_pk_mul_f32 v[188:189], v[208:209], v[128:129]
    v_pk_mul_f32 v[192:193], v[204:205], v[128:129]
    v_pk_mul_f32 v[190:191], v[210:211], v[130:131]
    v_pk_mul_f32 v[194:195], v[206:207], v[130:131]
    v_pk_fma_f32 v[188:189], v[204:205], v[112:113], v[188:189] neg_lo:[0,0,1] neg_hi:[0,0,1]
    v_pk_fma_f32 v[192:193], v[208:209], v[112:113], v[192:193]
    v_pk_fma_f32 v[190:191], v[206:207], v[114:115], v[190:191] neg_lo:[0,0,1] neg_hi:[0,0,1]
    v_pk_fma_f32 v[194:195], v[210:211], v[114:115], v[194:195]
    v_cvt_pk_bf16_f32 v229, v188, v190
    v_cvt_pk_bf16_f32 v237, v192, v194
    v_cvt_pk_bf16_f32 v245, -v192, -v194
    v_cvt_pk_bf16_f32 v233, v189, v191
    v_cvt_pk_bf16_f32 v241, v193, v195
    v_cvt_pk_bf16_f32 v249, -v193, -v195
    v_pk_mul_f32 v[188:189], v[216:217], v[132:133]
    v_pk_mul_f32 v[192:193], v[212:213], v[132:133]
    v_pk_mul_f32 v[190:191], v[218:219], v[134:135]
    v_pk_mul_f32 v[194:195], v[214:215], v[134:135]
    v_pk_fma_f32 v[188:189], v[212:213], v[116:117], v[188:189] neg_lo:[0,0,1] neg_hi:[0,0,1]
    v_pk_fma_f32 v[192:193], v[216:217], v[116:117], v[192:193]
    v_pk_fma_f32 v[190:191], v[214:215], v[118:119], v[190:191] neg_lo:[0,0,1] neg_hi:[0,0,1]
    v_pk_fma_f32 v[194:195], v[218:219], v[118:119], v[194:195]
    v_cvt_pk_bf16_f32 v230, v188, v190
    v_cvt_pk_bf16_f32 v238, v192, v194
    v_cvt_pk_bf16_f32 v246, -v192, -v194
    v_cvt_pk_bf16_f32 v234, v189, v191
    v_cvt_pk_bf16_f32 v242, v193, v195
    v_cvt_pk_bf16_f32 v250, -v193, -v195
    v_pk_mul_f32 v[188:189], v[224:225], v[136:137]
    v_pk_mul_f32 v[192:193], v[220:221], v[136:137]
    v_pk_mul_f32 v[190:191], v[226:227], v[138:139]
    v_pk_mul_f32 v[194:195], v[222:223], v[138:139]
    v_pk_fma_f32 v[188:189], v[220:221], v[120:121], v[188:189] neg_lo:[0,0,1] neg_hi:[0,0,1]
    v_pk_fma_f32 v[192:193], v[224:225], v[120:121], v[192:193]
    v_pk_fma_f32 v[190:191], v[222:223], v[122:123], v[190:191] neg_lo:[0,0,1] neg_hi:[0,0,1]
    v_pk_fma_f32 v[194:195], v[226:227], v[122:123], v[194:195]
    v_cvt_pk_bf16_f32 v231, v188, v190
    v_cvt_pk_bf16_f32 v239, v192, v194
    v_cvt_pk_bf16_f32 v247, -v192, -v194
    v_cvt_pk_bf16_f32 v235, v189, v191
    v_cvt_pk_bf16_f32 v243, v193, v195
    v_cvt_pk_bf16_f32 v251, -v193, -v195
    v_mfma_f32_16x16x32_bf16 v[196:199], v[228:231], v[76:79], 0
    v_mfma_f32_16x16x32_bf16 v[200:203], v[236:239], v[76:79], 0
    v_mfma_f32_16x16x32_bf16 v[212:215], v[232:235], v[80:83], 0
    v_mfma_f32_16x16x32_bf16 v[216:219], v[240:243], v[80:83], 0
    v_mfma_f32_16x16x32_bf16 v[196:199], v[244:247], v[92:95], v[196:199]
    v_mfma_f32_16x16x32_bf16 v[200:203], v[228:231], v[92:95], v[200:203]
    v_mfma_f32_16x16x32_bf16 v[212:215], v[248:251], v[96:99], v[212:215]
    v_mfma_f32_16x16x32_bf16 v[216:219], v[232:235], v[96:99], v[216:219]
    v_mfma_f32_16x16x32_bf16 v[204:207], v[228:231], v[84:87], 0
    v_mfma_f32_16x16x32_bf16 v[208:211], v[236:239], v[84:87], 0
    v_mfma_f32_16x16x32_bf16 v[220:223], v[232:235], v[88:91], 0
    v_mfma_f32_16x16x32_bf16 v[224:227], v[240:243], v[88:91], 0
    v_mfma_f32_16x16x32_bf16 v[204:207], v[244:247], v[100:103], v[204:207]
    v_mfma_f32_16x16x32_bf16 v[208:211], v[228:231], v[100:103], v[208:211]
    v_mfma_f32_16x16x32_bf16 v[220:223], v[248:251], v[104:107], v[220:223]
    v_mfma_f32_16x16x32_bf16 v[224:227], v[232:235], v[104:107], v[224:227]
    v_pk_add_f32 v[196:197], v[196:197], v[212:213]
    v_pk_add_f32 v[198:199], v[198:199], v[214:215]
    v_pk_add_f32 v[200:201], v[200:201], v[216:217]
    v_pk_add_f32 v[202:203], v[202:203], v[218:219]
    v_pk_fma_f32 v[212:213], v[212:213], s[4:5], v[196:197]
    v_pk_fma_f32 v[214:215], v[214:215], s[4:5], v[198:199]
    v_pk_fma_f32 v[216:217], v[216:217], s[4:5], v[200:201]
    v_pk_fma_f32 v[218:219], v[218:219], s[4:5], v[202:203]
    v_cvt_pk_bf16_f32 v196, v196, v197
    v_cvt_pk_bf16_f32 v197, v198, v199
    v_cvt_pk_bf16_f32 v198, v200, v201
    v_cvt_pk_bf16_f32 v199, v202, v203
    ds_write_b128 v40, v[196:199] offset:32768
    v_cvt_pk_bf16_f32 v212, v212, v213
    v_cvt_pk_bf16_f32 v213, v214, v215
    v_cvt_pk_bf16_f32 v214, v216, v217
    v_cvt_pk_bf16_f32 v215, v218, v219
    ds_write_b128 v40, v[212:215] offset:34816
    ds_read_b128 v[228:231], v41 offset:32768
    ds_read_b128 v[236:239], v41 offset:34816
    v_pk_add_f32 v[204:205], v[204:205], v[220:221]
    v_pk_add_f32 v[206:207], v[206:207], v[222:223]
    v_pk_add_f32 v[208:209], v[208:209], v[224:225]
    v_pk_add_f32 v[210:211], v[210:211], v[226:227]
    v_pk_fma_f32 v[220:221], v[220:221], s[4:5], v[204:205]
    v_pk_fma_f32 v[222:223], v[222:223], s[4:5], v[206:207]
    v_pk_fma_f32 v[224:225], v[224:225], s[4:5], v[208:209]
    v_pk_fma_f32 v[226:227], v[226:227], s[4:5], v[210:211]
    v_cvt_pk_bf16_f32 v204, v204, v205
    v_cvt_pk_bf16_f32 v205, v206, v207
    v_cvt_pk_bf16_f32 v206, v208, v209
    v_cvt_pk_bf16_f32 v207, v210, v211
    ds_write_b128 v40, v[204:207] offset:33792
    v_cvt_pk_bf16_f32 v220, v220, v221
    v_cvt_pk_bf16_f32 v221, v222, v223
    v_cvt_pk_bf16_f32 v222, v224, v225
    v_cvt_pk_bf16_f32 v223, v226, v227
    ds_write_b128 v40, v[220:223] offset:35840
    ds_read_b128 v[232:235], v41 offset:33792
    ds_read_b128 v[240:243], v41 offset:35840
    s_mov_b32 s74, s95
    s_waitcnt lgkmcnt(5)
    buffer_store_dwordx4 v[228:231], v27, s[36:39], s74 offen sc1
    s_add_u32 s74, s74, s101
    s_waitcnt lgkmcnt(1)
    buffer_store_dwordx4 v[232:235], v27, s[36:39], s74 offen sc1
    s_add_u32 s74, s74, s101
    buffer_store_dwordx4 v[236:239], v27, s[36:39], s74 offen sc1
    s_add_u32 s74, s74, s101
    s_waitcnt lgkmcnt(0)
    buffer_store_dwordx4 v[240:243], v27, s[36:39], s74 offen sc1
    s_nop 1
L33:
    s_waitcnt lgkmcnt(0)
    s_waitcnt vmcnt(0)
    s_and_b32 s79, s83, 7
    s_lshl_b32 s79, s79, 6
    s_add_u32 s88, s79, 0xc28000
    v_mov_b32 v12, 44
    v_mov_b32 v13, 1
    s_mov_b64 exec, 1
    ds_add_rtn_u32 v14, v12, v13
    s_mov_b64 exec, -1
    s_waitcnt lgkmcnt(0)
    v_readfirstlane_b32 s87, v14
    s_cmp_lg_u32 s87, 3
    s_cbranch_scc1 L34
    v_mov_b32 v13, 1
    v_lshlrev_b32 v12, 9, v0
    buffer_atomic_add v13, v12, s[36:39], s88 offen sc1
    s_mov_b64 exec, -1
L34:
    s_and_b32 s79, s2, 7
    s_lshl_b32 s79, s79, 2
    s_lshr_b32 s78, s2, 3
    s_and_b32 s78, s78, 3
    s_add_u32 s4, s79, s78
    s_lshr_b32 s5, s2, 5
    s_branch FINAL_L
FINAL_A:
    s_and_b32 s6, s3, 3
    v_mov_b32 v245, 0
    s_setprio 3
    v_mov_b32 v247, 0
    s_lshr_b32 s79, s4, 1
    s_lshl_b32 s79, s79, 3
    s_lshl_b32 s78, s6, 1
    s_add_u32 s78, s79, s78
    s_lshl_b32 s78, s78, 6
    s_add_u32 s88, s78, 0xc30000
    buffer_load_dword v246, v247, s[36:39], s88 offen sc1
    v_lshlrev_b32 v1, 4, v0
    s_mul_i32 s79, s6, 0x3c00
    s_add_u32 s80, s79, 0x8a0000
    s_mul_i32 s79, s6, 0x5000
    s_add_u32 s81, s79, 0x600
    s_mul_i32 s79, s4, 0x14000
    s_mul_i32 s78, s6, 0x1400
    s_add_u32 s78, s79, s78
    s_mov_b32 s82, s78
    s_lshl_b32 s79, s5, 2
    s_add_u32 s79, s79, s6
    s_mul_i32 s79, s79, 0x6400
    s_add_u32 s83, s79, 0x7c0000
    s_lshl_b32 s79, s4, 8
    s_add_u32 s84, s79, 0xb50000
    v_and_b32 v215, 15, v0
    v_lshlrev_b32 v6, 2, v215
    s_mov_b32 s60, s22
    s_and_b32 s61, s23, 0xffff
    s_mov_b32 s62, 0x280000
    s_mov_b32 s63, 0x20000
    v_lshrrev_b32 v215, 4, v0
    v_and_b32 v214, 15, v0
    v_mul_u32_u24 v214, 0xa0, v214
    v_lshl_add_u32 v214, v215, 3, v214
    v_add_u32 v7, s81, v214
    v_mov_b32 v180, 0
    v_mov_b32 v181, 0
    v_mov_b32 v182, 0
    v_mov_b32 v183, 0
    v_mov_b32 v184, 0
    v_mov_b32 v185, 0
    v_mov_b32 v186, 0
    v_mov_b32 v187, 0
    v_mov_b32 v188, 0
    v_mov_b32 v189, 0
    v_mov_b32 v190, 0
    v_mov_b32 v191, 0
    v_mov_b32 v192, 0
    v_mov_b32 v193, 0
    v_mov_b32 v194, 0
    v_mov_b32 v195, 0
    v_mov_b32 v196, 0
    v_mov_b32 v197, 0
    v_mov_b32 v198, 0
    v_mov_b32 v199, 0
    v_mov_b32 v200, 0
    v_mov_b32 v201, 0
    v_mov_b32 v202, 0
    v_mov_b32 v203, 0
    v_mov_b32 v204, 0
    v_mov_b32 v205, 0
    v_mov_b32 v206, 0
    v_mov_b32 v207, 0
    v_mov_b32 v208, 0
    v_mov_b32 v209, 0
    v_mov_b32 v210, 0
    v_mov_b32 v211, 0
    s_lshl_b32 s90, s5, 1
    s_add_u32 s91, s5, 4
    s_cmp_lt_u32 s5, 4
    s_cselect_b32 s90, s90, s91
    s_cselect_b32 s97, 0, 0x40000000
    s_cmp_eq_u32 s5, 2
    s_cselect_b32 s96, 3, 1
    s_add_u32 s91, s90, 1
    s_mul_i32 s79, s4, 6
    s_add_u32 s79, s79, s5
    s_lshl_b32 s79, s79, 12
    s_lshl_b32 s78, s6, 10
    s_add_u32 s78, s79, s78
    s_add_u32 s92, s78, 0xb60000
    s_lshl_b32 s79, s4, 1
    s_mul_i32 s78, s90, 0x667
    s_lshr_b32 s78, s78, 13
    s_add_u32 s94, s79, s78
    s_lshl_b32 s79, s94, 8
    s_lshl_b32 s78, s6, 6
    s_add_u32 s78, s79, s78
    s_add_u32 s94, s78, 0xc36000
    s_mul_i32 s79, s90, 0x667
    s_lshr_b32 s79, s79, 13
    s_mul_i32 s79, s79, 0x12c00
    s_mul_i32 s78, s90, 0x1400
    s_add_u32 s78, s79, s78
    s_mul_i32 s79, s6, 0x6400
    s_add_u32 s79, s78, s79
    s_add_u32 s90, s79, 0x856000
    s_lshl_b32 s79, s4, 1
    s_mul_i32 s78, s91, 0x667
    s_lshr_b32 s78, s78, 13
    s_add_u32 s95, s79, s78
    s_lshl_b32 s79, s95, 8
    s_lshl_b32 s78, s6, 6
    s_add_u32 s78, s79, s78
    s_add_u32 s95, s78, 0xc36000
    s_mul_i32 s79, s91, 0x667
    s_lshr_b32 s79, s79, 13
    s_mul_i32 s79, s79, 0x12c00
    s_mul_i32 s78, s91, 0x1400
    s_add_u32 s78, s79, s78
    s_mul_i32 s79, s6, 0x6400
    s_add_u32 s79, s78, s79
    s_add_u32 s91, s79, 0x856000
    s_add_u32 s91, s91, s97
    s_cmp_eq_u32 s101, 64
    s_cbranch_scc1 L35
    s_and_b32 s87, s2, 15
    s_lshl_b32 s87, s87, 9
    s_add_u32 s87, s87, 0xc34000
    v_and_b32 v245, 7, v0
    v_lshlrev_b32 v245, 6, v245
    s_waitcnt vmcnt(0)
    buffer_load_dword v244, v245, s[36:39], s87 offen offset:0 sc1
    s_waitcnt vmcnt(0)
    v_cmp_ne_u32 vcc, 8, v244
    s_cmp_eq_u64 vcc, 0
    s_cbranch_scc1 L36
    s_mov_b32 s89, 0x8000
L37:
    s_sub_u32 s89, s89, 1
    s_cbranch_scc1 L36
    s_sleep 1
    buffer_load_dword v244, v245, s[36:39], s87 offen offset:0 sc1
    s_waitcnt vmcnt(0)
    v_cmp_ne_u32 vcc, 8, v244
    s_cmp_eq_u64 vcc, 0
    s_cbranch_scc0 L37
L36:
    s_waitcnt vmcnt(0)
    s_nop 1
L35:
    buffer_load_dwordx4 v[88:91], v1, s[36:39], s90 offen offset:0 sc1
    buffer_load_dwordx4 v[92:95], v1, s[36:39], s90 offen offset:1024 sc1
    buffer_load_dwordx4 v[96:99], v1, s[36:39], s90 offen offset:2048 sc1
    buffer_load_dwordx4 v[100:103], v1, s[36:39], s90 offen offset:3072 sc1
    s_add_u32 s90, s90, 4096
    buffer_load_dwordx4 v[104:107], v1, s[36:39], s90 offen offset:0 sc1
    s_add_u32 s90, s90, 1024
    buffer_load_dwordx4 v[108:111], v1, s[36:39], s91 offen offset:0 sc1
    buffer_load_dwordx4 v[112:115], v1, s[36:39], s91 offen offset:1024 sc1
    buffer_load_dwordx4 v[116:119], v1, s[36:39], s91 offen offset:2048 sc1
    buffer_load_dwordx4 v[120:123], v1, s[36:39], s91 offen offset:3072 sc1
    s_add_u32 s91, s91, 4096
    buffer_load_dwordx4 v[124:127], v1, s[36:39], s91 offen offset:0 sc1
    s_add_u32 s91, s91, 1024
    buffer_load_dwordx4 v[128:131], v1, s[36:39], s83 offen offset:0 sc1
    buffer_load_dwordx4 v[132:135], v1, s[36:39], s83 offen offset:1024 sc1
    buffer_load_dwordx4 v[136:139], v1, s[36:39], s83 offen offset:2048 sc1
    buffer_load_dwordx4 v[140:143], v1, s[36:39], s83 offen offset:3072 sc1
    s_add_u32 s83, s83, 4096
    buffer_load_dwordx4 v[144:147], v1, s[36:39], s83 offen offset:0 sc1
    s_add_u32 s83, s83, 1024
    s_lshl_b32 s79, s6, 11
    s_and_b32 s78, s2, 15
    s_lshl_b32 s78, s78, 7
    s_add_u32 s78, s79, s78
    s_add_u32 s87, s78, 0xc32000
    v_and_b32 v245, 1, v0
    v_lshlrev_b32 v245, 6, v245
    s_waitcnt vmcnt(15)
    v_cmp_ne_u32 vcc, 1, v246
    s_cmp_eq_u64 vcc, 0
    s_cbranch_scc1 L38
    s_mov_b32 s89, 0x8000
L39:
    s_sub_u32 s89, s89, 1
    s_cbranch_scc1 L38
    s_sleep 1
    buffer_load_dword v246, v247, s[36:39], s88 offen offset:0 sc1
    s_waitcnt vmcnt(0)
    v_cmp_ne_u32 vcc, 1, v246
    s_cmp_eq_u64 vcc, 0
    s_cbranch_scc0 L39
L38:
    buffer_load_dword v244, v245, s[36:39], s87 offen sc1
    buffer_load_dword v2, v6, s[36:39], s84 offen offset:0 sc1
    buffer_load_dword v3, v6, s[36:39], s84 offen offset:64 sc1
    buffer_load_dword v4, v6, s[36:39], s84 offen offset:128 sc1
    buffer_load_dword v5, v6, s[36:39], s84 offen offset:192 sc1
    v_lshlrev_b32 v212, 3, v0
    buffer_load_dwordx4 v[8:11], v1, s[36:39], s82 offen offset:0 sc1
    buffer_load_dwordx4 v[12:15], v1, s[36:39], s82 offen offset:1024 sc1
    buffer_load_dwordx2 v[16:17], v212, s[36:39], s82 offen offset:2048 sc1
    s_add_u32 s82, s82, 2560
    buffer_load_dwordx4 v[18:21], v1, s[36:39], s82 offen offset:0 sc1
    buffer_load_dwordx4 v[22:25], v1, s[36:39], s82 offen offset:1024 sc1
    buffer_load_dwordx2 v[26:27], v212, s[36:39], s82 offen offset:2048 sc1
    s_add_u32 s82, s82, 17920
    buffer_load_dwordx4 v[28:31], v1, s[36:39], s82 offen offset:0 sc1
    buffer_load_dwordx4 v[32:35], v1, s[36:39], s82 offen offset:1024 sc1
    buffer_load_dwordx2 v[36:37], v212, s[36:39], s82 offen offset:2048 sc1
    s_add_u32 s82, s82, 2560
    buffer_load_dwordx4 v[38:41], v1, s[36:39], s82 offen offset:0 sc1
    buffer_load_dwordx4 v[42:45], v1, s[36:39], s82 offen offset:1024 sc1
    buffer_load_dwordx2 v[46:47], v212, s[36:39], s82 offen offset:2048 sc1
    s_add_u32 s82, s82, 17920
    buffer_load_dwordx4 v[48:51], v1, s[36:39], s82 offen offset:0 sc1
    buffer_load_dwordx4 v[52:55], v1, s[36:39], s82 offen offset:1024 sc1
    buffer_load_dwordx2 v[56:57], v212, s[36:39], s82 offen offset:2048 sc1
    s_add_u32 s82, s82, 2560
    buffer_load_dwordx4 v[58:61], v1, s[36:39], s82 offen offset:0 sc1
    buffer_load_dwordx4 v[62:65], v1, s[36:39], s82 offen offset:1024 sc1
    buffer_load_dwordx2 v[66:67], v212, s[36:39], s82 offen offset:2048 sc1
    s_add_u32 s82, s82, 17920
    buffer_load_dwordx4 v[68:71], v1, s[36:39], s82 offen offset:0 sc1
    buffer_load_dwordx4 v[72:75], v1, s[36:39], s82 offen offset:1024 sc1
    buffer_load_dwordx2 v[76:77], v212, s[36:39], s82 offen offset:2048 sc1
    s_add_u32 s82, s82, 2560
    buffer_load_dwordx4 v[78:81], v1, s[36:39], s82 offen offset:0 sc1
    buffer_load_dwordx4 v[82:85], v1, s[36:39], s82 offen offset:1024 sc1
    buffer_load_dwordx2 v[86:87], v212, s[36:39], s82 offen offset:2048 sc1
    s_add_u32 s82, s82, 17920
    v_lshlrev_b32 v6, 2, v0
    s_waitcnt vmcnt(28)
    v_cmp_ne_u32 vcc, 16, v244
    s_cmp_eq_u64 vcc, 0
    s_cbranch_scc1 L40
    s_mov_b32 s89, 0x8000
L41:
    s_sub_u32 s89, s89, 1
    s_cbranch_scc1 L40
    s_sleep 1
    buffer_load_dword v244, v245, s[36:39], s87 offen offset:0 sc1
    s_waitcnt vmcnt(0)
    v_cmp_ne_u32 vcc, 16, v244
    s_cmp_eq_u64 vcc, 0
    s_cbranch_scc0 L41
L40:
    s_add_u32 s85, s80, 4096
    buffer_load_dword v148, v6, s[36:39], s85 offen offset:3584 sc1
    buffer_load_dword v149, v6, s[36:39], s85 offen offset:3840 sc1
    s_add_u32 s85, s80, 8192
    buffer_load_dword v150, v6, s[36:39], s85 offen offset:0 sc1
    buffer_load_dword v151, v6, s[36:39], s85 offen offset:256 sc1
    buffer_load_dword v152, v6, s[36:39], s85 offen offset:512 sc1
    buffer_load_dword v153, v6, s[36:39], s85 offen offset:768 sc1
    buffer_load_dword v154, v6, s[36:39], s85 offen offset:1024 sc1
    buffer_load_dword v155, v6, s[36:39], s85 offen offset:1280 sc1
    buffer_load_dword v156, v6, s[36:39], s85 offen offset:1536 sc1
    buffer_load_dword v157, v6, s[36:39], s85 offen offset:1792 sc1
    buffer_load_dword v158, v6, s[36:39], s85 offen offset:2048 sc1
    buffer_load_dword v159, v6, s[36:39], s85 offen offset:2304 sc1
    buffer_load_dword v160, v6, s[36:39], s85 offen offset:2560 sc1
    buffer_load_dword v161, v6, s[36:39], s85 offen offset:2816 sc1
    buffer_load_dword v162, v6, s[36:39], s85 offen offset:3072 sc1
    buffer_load_dword v163, v6, s[36:39], s85 offen offset:3328 sc1
    buffer_load_dword v164, v6, s[36:39], s85 offen offset:3584 sc1
    buffer_load_dword v165, v6, s[36:39], s85 offen offset:3840 sc1
    s_add_u32 s85, s80, 12288
    buffer_load_dword v166, v6, s[36:39], s85 offen offset:0 sc1
    buffer_load_dword v167, v6, s[36:39], s85 offen offset:256 sc1
    buffer_load_dword v168, v6, s[36:39], s85 offen offset:512 sc1
    buffer_load_dword v169, v6, s[36:39], s85 offen offset:768 sc1
    buffer_load_dword v170, v6, s[36:39], s85 offen offset:1024 sc1
    buffer_load_dword v171, v6, s[36:39], s85 offen offset:1280 sc1
    buffer_load_dword v172, v6, s[36:39], s85 offen offset:1536 sc1
    buffer_load_dword v173, v6, s[36:39], s85 offen offset:1792 sc1
    buffer_load_dword v174, v6, s[36:39], s85 offen offset:2048 sc1
    buffer_load_dword v175, v6, s[36:39], s85 offen offset:2304 sc1
    buffer_load_dword v176, v6, s[36:39], s85 offen offset:2560 sc1
    buffer_load_dword v177, v6, s[36:39], s85 offen offset:2816 sc1
    s_add_u32 s85, s80, 0
    buffer_load_dword v212, v6, s[36:39], s85 offen offset:0 sc1
    buffer_load_dword v213, v6, s[36:39], s85 offen offset:256 sc1
    buffer_load_dword v214, v6, s[36:39], s85 offen offset:512 sc1
    buffer_load_dword v215, v6, s[36:39], s85 offen offset:768 sc1
    buffer_load_dword v216, v6, s[36:39], s85 offen offset:1024 sc1
    buffer_load_dword v217, v6, s[36:39], s85 offen offset:1280 sc1
    buffer_load_dword v218, v6, s[36:39], s85 offen offset:1536 sc1
    buffer_load_dword v219, v6, s[36:39], s85 offen offset:1792 sc1
    buffer_load_dword v220, v6, s[36:39], s85 offen offset:2048 sc1
    buffer_load_dword v221, v6, s[36:39], s85 offen offset:2304 sc1
    buffer_load_dword v222, v6, s[36:39], s85 offen offset:2560 sc1
    buffer_load_dword v223, v6, s[36:39], s85 offen offset:2816 sc1
    buffer_load_dword v224, v6, s[36:39], s85 offen offset:3072 sc1
    buffer_load_dword v225, v6, s[36:39], s85 offen offset:3328 sc1
    buffer_load_dword v226, v6, s[36:39], s85 offen offset:3584 sc1
    buffer_load_dword v227, v6, s[36:39], s85 offen offset:3840 sc1
    s_add_u32 s85, s80, 4096
    buffer_load_dword v228, v6, s[36:39], s85 offen offset:0 sc1
    buffer_load_dword v229, v6, s[36:39], s85 offen offset:256 sc1
    buffer_load_dword v230, v6, s[36:39], s85 offen offset:512 sc1
    buffer_load_dword v231, v6, s[36:39], s85 offen offset:768 sc1
    buffer_load_dword v232, v6, s[36:39], s85 offen offset:1024 sc1
    buffer_load_dword v233, v6, s[36:39], s85 offen offset:1280 sc1
    buffer_load_dword v234, v6, s[36:39], s85 offen offset:1536 sc1
    buffer_load_dword v235, v6, s[36:39], s85 offen offset:1792 sc1
    buffer_load_dword v236, v6, s[36:39], s85 offen offset:2048 sc1
    buffer_load_dword v237, v6, s[36:39], s85 offen offset:2304 sc1
    buffer_load_dword v238, v6, s[36:39], s85 offen offset:2560 sc1
    buffer_load_dword v239, v6, s[36:39], s85 offen offset:2816 sc1
    buffer_load_dword v240, v6, s[36:39], s85 offen offset:3072 sc1
    buffer_load_dword v241, v6, s[36:39], s85 offen offset:3328 sc1
    s_add_u32 m0, s81, 0
    s_nop 0
    buffer_load_dwordx4 v1, s[36:39], s83 offen sc1 lds
    s_add_u32 s83, s83, 1024
    s_add_u32 m0, s81, 1024
    s_nop 0
    buffer_load_dwordx4 v1, s[36:39], s83 offen sc1 lds
    s_add_u32 s83, s83, 1024
    s_add_u32 m0, s81, 2048
    s_nop 0
    buffer_load_dwordx4 v1, s[36:39], s83 offen sc1 lds
    s_add_u32 s83, s83, 1024
    s_add_u32 m0, s81, 3072
    s_nop 0
    buffer_load_dwordx4 v1, s[36:39], s83 offen sc1 lds
    s_add_u32 s83, s83, 1024
    s_add_u32 m0, s81, 4096
    s_nop 0
    buffer_load_dwordx4 v1, s[36:39], s83 offen sc1 lds
    s_add_u32 s83, s83, 1024
    s_add_u32 m0, s81, 5120
    s_nop 0
    buffer_load_dwordx4 v1, s[36:39], s83 offen sc1 lds
    s_add_u32 s83, s83, 1024
    s_add_u32 m0, s81, 6144
    s_nop 0
    buffer_load_dwordx4 v1, s[36:39], s83 offen sc1 lds
    s_add_u32 s83, s83, 1024
    s_add_u32 m0, s81, 7168
    s_nop 0
    buffer_load_dwordx4 v1, s[36:39], s83 offen sc1 lds
    s_add_u32 s83, s83, 1024
    s_add_u32 m0, s81, 8192
    s_nop 0
    buffer_load_dwordx4 v1, s[36:39], s83 offen sc1 lds
    s_add_u32 s83, s83, 1024
    s_add_u32 m0, s81, 9216
    s_nop 0
    buffer_load_dwordx4 v1, s[36:39], s83 offen sc1 lds
    s_add_u32 s83, s83, 1024
    v_mov_b32 v252, 0x358637bd
    v_mov_b32 v253, 0
    v_mov_b32 v254, 0x358637bd
    v_mov_b32 v255, 0
    v_add_u32 v1, s81, v1
    s_waitcnt vmcnt(63)
    v_cvt_pk_bf16_f32 v180, v148, v149
    v_cvt_pk_bf16_f32 v181, v150, v151
    s_waitcnt vmcnt(45)
    v_cvt_pk_bf16_f32 v182, v172, 0
    v_cvt_pk_bf16_f32 v185, v152, v153
    v_cvt_pk_bf16_f32 v186, v154, v155
    s_waitcnt vmcnt(44)
    v_cvt_pk_bf16_f32 v184, 0, v173
    v_cvt_pk_bf16_f32 v189, v156, v157
    v_cvt_pk_bf16_f32 v190, v158, v159
    s_waitcnt vmcnt(43)
    v_cvt_pk_bf16_f32 v191, v174, 0
    v_cvt_pk_bf16_f32 v194, v160, v161
    v_cvt_pk_bf16_f32 v195, v162, v163
    s_waitcnt vmcnt(42)
    v_cvt_pk_bf16_f32 v193, 0, v175
    s_mov_b32 exec_lo, 0x33333333
    s_mov_b32 exec_hi, 0x33333333
    v_cvt_pk_bf16_f32 v196, v164, v165
    v_cvt_pk_bf16_f32 v197, v166, v167
    s_waitcnt vmcnt(41)
    v_cvt_pk_bf16_f32 v198, v176, 0
    v_cvt_pk_bf16_f32 v205, v168, v169
    v_cvt_pk_bf16_f32 v206, v170, v171
    s_waitcnt vmcnt(40)
    v_cvt_pk_bf16_f32 v207, v177, 0
    s_mov_b32 exec_lo, 0xcccccccc
    s_mov_b32 exec_hi, 0xcccccccc
    v_cvt_pk_bf16_f32 v201, v164, v165
    v_cvt_pk_bf16_f32 v202, v166, v167
    v_cvt_pk_bf16_f32 v200, 0, v176
    v_cvt_pk_bf16_f32 v210, v168, v169
    v_cvt_pk_bf16_f32 v211, v170, v171
    v_cvt_pk_bf16_f32 v209, 0, v177
    s_mov_b64 exec, -1
    v_mov_b32 v151, 0
    v_mov_b32 v155, 0
    v_mov_b32 v156, 0
    v_mov_b32 v160, 0
    v_mov_b32 v164, 0
    v_mov_b32 v165, 0
    v_mov_b32 v166, 0
    v_mov_b32 v167, 0
    v_mov_b32 v168, 0
    v_mov_b32 v169, 0
    v_mov_b32 v170, 0
    v_mov_b32 v171, 0
    v_mov_b32 v172, 0
    v_mov_b32 v173, 0
    v_mov_b32 v174, 0
    v_mov_b32 v175, 0
    v_mov_b32 v176, 0
    v_mov_b32 v177, 0
    v_mov_b32 v178, 0
    v_mov_b32 v179, 0
    s_waitcnt vmcnt(38)
    v_cvt_pk_bf16_f32 v148, v212, v213
    s_waitcnt vmcnt(36)
    v_cvt_pk_bf16_f32 v149, v214, v215
    s_waitcnt vmcnt(15)
    v_cvt_pk_bf16_f32 v150, v236, 0
    v_cvt_pk_bf16_f32 v153, v216, v217
    v_cvt_pk_bf16_f32 v154, v218, v219
    s_waitcnt vmcnt(14)
    v_cvt_pk_bf16_f32 v152, 0, v237
    v_cvt_pk_bf16_f32 v157, v220, v221
    v_cvt_pk_bf16_f32 v158, v222, v223
    s_waitcnt vmcnt(13)
    v_cvt_pk_bf16_f32 v159, v238, 0
    v_cvt_pk_bf16_f32 v162, v224, v225
    v_cvt_pk_bf16_f32 v163, v226, v227
    s_waitcnt vmcnt(12)
    v_cvt_pk_bf16_f32 v161, 0, v239
    s_mov_b32 exec_lo, 0x33333333
    s_mov_b32 exec_hi, 0x33333333
    v_cvt_pk_bf16_f32 v164, v228, v229
    v_cvt_pk_bf16_f32 v165, v230, v231
    s_waitcnt vmcnt(11)
    v_cvt_pk_bf16_f32 v166, v240, 0
    v_cvt_pk_bf16_f32 v173, v232, v233
    v_cvt_pk_bf16_f32 v174, v234, v235
    s_waitcnt vmcnt(10)
    v_cvt_pk_bf16_f32 v175, v241, 0
    s_mov_b32 exec_lo, 0xcccccccc
    s_mov_b32 exec_hi, 0xcccccccc
    v_cvt_pk_bf16_f32 v169, v228, v229
    v_cvt_pk_bf16_f32 v170, v230, v231
    v_cvt_pk_bf16_f32 v168, 0, v240
    v_cvt_pk_bf16_f32 v178, v232, v233
    v_cvt_pk_bf16_f32 v179, v234, v235
    v_cvt_pk_bf16_f32 v177, 0, v241
    s_mov_b64 exec, -1
    v_mfma_f32_16x16x32_bf16 v[212:215], v[148:151], v[8:11], 0
    v_mfma_f32_16x16x32_bf16 v[220:223], v[164:167], v[8:11], v[252:255]
    v_mfma_f32_16x16x32_bf16 v[216:219], v[152:155], v[10:13], 0
    v_mfma_f32_16x16x32_bf16 v[220:223], v[168:171], v[10:13], v[220:223]
    v_mfma_f32_16x16x32_bf16 v[224:227], v[156:159], v[12:15], 0
    v_mfma_f32_16x16x32_bf16 v[232:235], v[172:175], v[12:15], v[252:255]
    v_mfma_f32_16x16x32_bf16 v[228:231], v[160:163], v[14:17], 0
    v_mfma_f32_16x16x32_bf16 v[232:235], v[176:179], v[14:17], v[232:235]
    v_mfma_f32_16x16x32_bf16 v[236:239], v[180:183], v[18:21], 0
    v_mfma_f32_16x16x32_bf16 v[244:247], v[196:199], v[18:21], v[252:255]
    v_mfma_f32_16x16x32_bf16 v[240:243], v[184:187], v[20:23], 0
    v_mfma_f32_16x16x32_bf16 v[244:247], v[200:203], v[20:23], v[244:247]
    v_rcp_f32 v248, v220
    v_rcp_f32 v249, v222
    v_mul_f32 v248, v2, v248
    v_mul_f32 v249, v2, v249
    v_pk_mul_f32 v[212:213], v[212:213], v[248:249] op_sel:[0,0] op_sel_hi:[1,0]
    v_pk_mul_f32 v[216:217], v[216:217], v[248:249] op_sel:[0,1] op_sel_hi:[1,1]
    v_pk_mul_f32 v[214:215], v[214:215], v[248:249] op_sel:[0,0] op_sel_hi:[1,0]
    v_pk_mul_f32 v[218:219], v[218:219], v[248:249] op_sel:[0,1] op_sel_hi:[1,1]
    v_mul_f32 v221, v221, v248
    v_mul_f32 v223, v223, v249
    v_cvt_pk_bf16_f32 v8, v212, v213
    v_cvt_pk_bf16_f32 v9, v214, v215
    v_cvt_pk_bf16_f32 v11, v216, v217
    v_cvt_pk_bf16_f32 v12, v218, v219
    v_cvt_pk_bf16_f32 v10, v221, v223
    v_mfma_f32_16x16x32_bf16 v[212:215], v[188:191], v[22:25], 0
    v_mfma_f32_16x16x32_bf16 v[220:223], v[204:207], v[22:25], v[252:255]
    v_mfma_f32_16x16x32_bf16 v[216:219], v[192:195], v[24:27], 0
    v_mfma_f32_16x16x32_bf16 v[220:223], v[208:211], v[24:27], v[220:223]
    v_rcp_f32 v250, v232
    v_rcp_f32 v251, v234
    v_mul_f32 v250, v2, v250
    v_mul_f32 v251, v2, v251
    v_pk_mul_f32 v[224:225], v[224:225], v[250:251] op_sel:[0,0] op_sel_hi:[1,0]
    v_pk_mul_f32 v[228:229], v[228:229], v[250:251] op_sel:[0,1] op_sel_hi:[1,1]
    v_pk_mul_f32 v[226:227], v[226:227], v[250:251] op_sel:[0,0] op_sel_hi:[1,0]
    v_pk_mul_f32 v[230:231], v[230:231], v[250:251] op_sel:[0,1] op_sel_hi:[1,1]
    v_mul_f32 v233, v233, v250
    v_mul_f32 v235, v235, v251
    v_cvt_pk_bf16_f32 v13, v224, v225
    v_cvt_pk_bf16_f32 v14, v226, v227
    v_cvt_pk_bf16_f32 v16, v228, v229
    v_cvt_pk_bf16_f32 v17, v230, v231
    v_cvt_pk_bf16_f32 v15, v233, v235
    v_mfma_f32_16x16x32_bf16 v[224:227], v[148:151], v[28:31], 0
    v_mfma_f32_16x16x32_bf16 v[232:235], v[164:167], v[28:31], v[252:255]
    v_mfma_f32_16x16x32_bf16 v[228:231], v[152:155], v[30:33], 0
    v_mfma_f32_16x16x32_bf16 v[232:235], v[168:171], v[30:33], v[232:235]
    v_rcp_f32 v248, v244
    v_rcp_f32 v249, v246
    v_mul_f32 v248, v2, v248
    v_mul_f32 v249, v2, v249
    v_pk_mul_f32 v[236:237], v[236:237], v[248:249] op_sel:[0,0] op_sel_hi:[1,0]
    v_pk_mul_f32 v[240:241], v[240:241], v[248:249] op_sel:[0,1] op_sel_hi:[1,1]
    v_pk_mul_f32 v[238:239], v[238:239], v[248:249] op_sel:[0,0] op_sel_hi:[1,0]
    v_pk_mul_f32 v[242:243], v[242:243], v[248:249] op_sel:[0,1] op_sel_hi:[1,1]
    v_mul_f32 v245, v245, v248
    v_mul_f32 v247, v247, v249
    v_cvt_pk_bf16_f32 v18, v236, v237
    v_cvt_pk_bf16_f32 v19, v238, v239
    v_cvt_pk_bf16_f32 v21, v240, v241
    v_cvt_pk_bf16_f32 v22, v242, v243
    v_cvt_pk_bf16_f32 v20, v245, v247
    v_mfma_f32_16x16x32_bf16 v[236:239], v[156:159], v[32:35], 0
    v_mfma_f32_16x16x32_bf16 v[244:247], v[172:175], v[32:35], v[252:255]
    v_mfma_f32_16x16x32_bf16 v[240:243], v[160:163], v[34:37], 0
    v_mfma_f32_16x16x32_bf16 v[244:247], v[176:179], v[34:37], v[244:247]
    v_rcp_f32 v250, v220
    v_rcp_f32 v251, v222
    v_mul_f32 v250, v2, v250
    v_mul_f32 v251, v2, v251
    v_pk_mul_f32 v[212:213], v[212:213], v[250:251] op_sel:[0,0] op_sel_hi:[1,0]
    v_pk_mul_f32 v[216:217], v[216:217], v[250:251] op_sel:[0,1] op_sel_hi:[1,1]
    v_pk_mul_f32 v[214:215], v[214:215], v[250:251] op_sel:[0,0] op_sel_hi:[1,0]
    v_pk_mul_f32 v[218:219], v[218:219], v[250:251] op_sel:[0,1] op_sel_hi:[1,1]
    v_mul_f32 v221, v221, v250
    v_mul_f32 v223, v223, v251
    v_cvt_pk_bf16_f32 v23, v212, v213
    v_cvt_pk_bf16_f32 v24, v214, v215
    v_cvt_pk_bf16_f32 v26, v216, v217
    v_cvt_pk_bf16_f32 v27, v218, v219
    v_cvt_pk_bf16_f32 v25, v221, v223
    v_mfma_f32_16x16x32_bf16 v[212:215], v[180:183], v[38:41], 0
    v_mfma_f32_16x16x32_bf16 v[220:223], v[196:199], v[38:41], v[252:255]
    v_mfma_f32_16x16x32_bf16 v[216:219], v[184:187], v[40:43], 0
    v_mfma_f32_16x16x32_bf16 v[220:223], v[200:203], v[40:43], v[220:223]
    v_rcp_f32 v248, v232
    v_rcp_f32 v249, v234
    v_mul_f32 v248, v3, v248
    v_mul_f32 v249, v3, v249
    v_pk_mul_f32 v[224:225], v[224:225], v[248:249] op_sel:[0,0] op_sel_hi:[1,0]
    v_pk_mul_f32 v[228:229], v[228:229], v[248:249] op_sel:[0,1] op_sel_hi:[1,1]
    v_pk_mul_f32 v[226:227], v[226:227], v[248:249] op_sel:[0,0] op_sel_hi:[1,0]
    v_pk_mul_f32 v[230:231], v[230:231], v[248:249] op_sel:[0,1] op_sel_hi:[1,1]
    v_mul_f32 v233, v233, v248
    v_mul_f32 v235, v235, v249
    v_cvt_pk_bf16_f32 v28, v224, v225
    v_cvt_pk_bf16_f32 v29, v226, v227
    v_cvt_pk_bf16_f32 v31, v228, v229
    v_cvt_pk_bf16_f32 v32, v230, v231
    v_cvt_pk_bf16_f32 v30, v233, v235
    v_mfma_f32_16x16x32_bf16 v[224:227], v[188:191], v[42:45], 0
    v_mfma_f32_16x16x32_bf16 v[232:235], v[204:207], v[42:45], v[252:255]
    v_mfma_f32_16x16x32_bf16 v[228:231], v[192:195], v[44:47], 0
    v_mfma_f32_16x16x32_bf16 v[232:235], v[208:211], v[44:47], v[232:235]
    v_rcp_f32 v250, v244
    v_rcp_f32 v251, v246
    v_mul_f32 v250, v3, v250
    v_mul_f32 v251, v3, v251
    v_pk_mul_f32 v[236:237], v[236:237], v[250:251] op_sel:[0,0] op_sel_hi:[1,0]
    v_pk_mul_f32 v[240:241], v[240:241], v[250:251] op_sel:[0,1] op_sel_hi:[1,1]
    v_pk_mul_f32 v[238:239], v[238:239], v[250:251] op_sel:[0,0] op_sel_hi:[1,0]
    v_pk_mul_f32 v[242:243], v[242:243], v[250:251] op_sel:[0,1] op_sel_hi:[1,1]
    v_mul_f32 v245, v245, v250
    v_mul_f32 v247, v247, v251
    v_cvt_pk_bf16_f32 v33, v236, v237
    v_cvt_pk_bf16_f32 v34, v238, v239
    v_cvt_pk_bf16_f32 v36, v240, v241
    v_cvt_pk_bf16_f32 v37, v242, v243
    v_cvt_pk_bf16_f32 v35, v245, v247
    v_mfma_f32_16x16x32_bf16 v[236:239], v[148:151], v[48:51], 0
    v_mfma_f32_16x16x32_bf16 v[244:247], v[164:167], v[48:51], v[252:255]
    v_mfma_f32_16x16x32_bf16 v[240:243], v[152:155], v[50:53], 0
    v_mfma_f32_16x16x32_bf16 v[244:247], v[168:171], v[50:53], v[244:247]
    v_rcp_f32 v248, v220
    v_rcp_f32 v249, v222
    v_mul_f32 v248, v3, v248
    v_mul_f32 v249, v3, v249
    v_pk_mul_f32 v[212:213], v[212:213], v[248:249] op_sel:[0,0] op_sel_hi:[1,0]
    v_pk_mul_f32 v[216:217], v[216:217], v[248:249] op_sel:[0,1] op_sel_hi:[1,1]
    v_pk_mul_f32 v[214:215], v[214:215], v[248:249] op_sel:[0,0] op_sel_hi:[1,0]
    v_pk_mul_f32 v[218:219], v[218:219], v[248:249] op_sel:[0,1] op_sel_hi:[1,1]
    v_mul_f32 v221, v221, v248
    v_mul_f32 v223, v223, v249
    v_cvt_pk_bf16_f32 v38, v212, v213
    v_cvt_pk_bf16_f32 v39, v214, v215
    v_cvt_pk_bf16_f32 v41, v216, v217
    v_cvt_pk_bf16_f32 v42, v218, v219
    v_cvt_pk_bf16_f32 v40, v221, v223
    v_mfma_f32_16x16x32_bf16 v[212:215], v[156:159], v[52:55], 0
    v_mfma_f32_16x16x32_bf16 v[220:223], v[172:175], v[52:55], v[252:255]
    v_mfma_f32_16x16x32_bf16 v[216:219], v[160:163], v[54:57], 0
    v_mfma_f32_16x16x32_bf16 v[220:223], v[176:179], v[54:57], v[220:223]
    v_rcp_f32 v250, v232
    v_rcp_f32 v251, v234
    v_mul_f32 v250, v3, v250
    v_mul_f32 v251, v3, v251
    v_pk_mul_f32 v[224:225], v[224:225], v[250:251] op_sel:[0,0] op_sel_hi:[1,0]
    v_pk_mul_f32 v[228:229], v[228:229], v[250:251] op_sel:[0,1] op_sel_hi:[1,1]
    v_pk_mul_f32 v[226:227], v[226:227], v[250:251] op_sel:[0,0] op_sel_hi:[1,0]
    v_pk_mul_f32 v[230:231], v[230:231], v[250:251] op_sel:[0,1] op_sel_hi:[1,1]
    v_mul_f32 v233, v233, v250
    v_mul_f32 v235, v235, v251
    v_cvt_pk_bf16_f32 v43, v224, v225
    v_cvt_pk_bf16_f32 v44, v226, v227
    v_cvt_pk_bf16_f32 v46, v228, v229
    v_cvt_pk_bf16_f32 v47, v230, v231
    v_cvt_pk_bf16_f32 v45, v233, v235
    v_mfma_f32_16x16x32_bf16 v[224:227], v[180:183], v[58:61], 0
    v_mfma_f32_16x16x32_bf16 v[232:235], v[196:199], v[58:61], v[252:255]
    v_mfma_f32_16x16x32_bf16 v[228:231], v[184:187], v[60:63], 0
    v_mfma_f32_16x16x32_bf16 v[232:235], v[200:203], v[60:63], v[232:235]
    v_rcp_f32 v248, v244
    v_rcp_f32 v249, v246
    v_mul_f32 v248, v4, v248
    v_mul_f32 v249, v4, v249
    v_pk_mul_f32 v[236:237], v[236:237], v[248:249] op_sel:[0,0] op_sel_hi:[1,0]
    v_pk_mul_f32 v[240:241], v[240:241], v[248:249] op_sel:[0,1] op_sel_hi:[1,1]
    v_pk_mul_f32 v[238:239], v[238:239], v[248:249] op_sel:[0,0] op_sel_hi:[1,0]
    v_pk_mul_f32 v[242:243], v[242:243], v[248:249] op_sel:[0,1] op_sel_hi:[1,1]
    v_mul_f32 v245, v245, v248
    v_mul_f32 v247, v247, v249
    v_cvt_pk_bf16_f32 v48, v236, v237
    v_cvt_pk_bf16_f32 v49, v238, v239
    v_cvt_pk_bf16_f32 v51, v240, v241
    v_cvt_pk_bf16_f32 v52, v242, v243
    v_cvt_pk_bf16_f32 v50, v245, v247
    v_mfma_f32_16x16x32_bf16 v[236:239], v[188:191], v[62:65], 0
    v_mfma_f32_16x16x32_bf16 v[244:247], v[204:207], v[62:65], v[252:255]
    v_mfma_f32_16x16x32_bf16 v[240:243], v[192:195], v[64:67], 0
    v_mfma_f32_16x16x32_bf16 v[244:247], v[208:211], v[64:67], v[244:247]
    v_rcp_f32 v250, v220
    v_rcp_f32 v251, v222
    v_mul_f32 v250, v4, v250
    v_mul_f32 v251, v4, v251
    v_pk_mul_f32 v[212:213], v[212:213], v[250:251] op_sel:[0,0] op_sel_hi:[1,0]
    v_pk_mul_f32 v[216:217], v[216:217], v[250:251] op_sel:[0,1] op_sel_hi:[1,1]
    v_pk_mul_f32 v[214:215], v[214:215], v[250:251] op_sel:[0,0] op_sel_hi:[1,0]
    v_pk_mul_f32 v[218:219], v[218:219], v[250:251] op_sel:[0,1] op_sel_hi:[1,1]
    v_mul_f32 v221, v221, v250
    v_mul_f32 v223, v223, v251
    v_cvt_pk_bf16_f32 v53, v212, v213
    v_cvt_pk_bf16_f32 v54, v214, v215
    v_cvt_pk_bf16_f32 v56, v216, v217
    v_cvt_pk_bf16_f32 v57, v218, v219
    v_cvt_pk_bf16_f32 v55, v221, v223
    v_mfma_f32_16x16x32_bf16 v[212:215], v[148:151], v[68:71], 0
    v_mfma_f32_16x16x32_bf16 v[220:223], v[164:167], v[68:71], v[252:255]
    v_mfma_f32_16x16x32_bf16 v[216:219], v[152:155], v[70:73], 0
    v_mfma_f32_16x16x32_bf16 v[220:223], v[168:171], v[70:73], v[220:223]
    v_rcp_f32 v248, v232
    v_rcp_f32 v249, v234
    v_mul_f32 v248, v4, v248
    v_mul_f32 v249, v4, v249
    v_pk_mul_f32 v[224:225], v[224:225], v[248:249] op_sel:[0,0] op_sel_hi:[1,0]
    v_pk_mul_f32 v[228:229], v[228:229], v[248:249] op_sel:[0,1] op_sel_hi:[1,1]
    v_pk_mul_f32 v[226:227], v[226:227], v[248:249] op_sel:[0,0] op_sel_hi:[1,0]
    v_pk_mul_f32 v[230:231], v[230:231], v[248:249] op_sel:[0,1] op_sel_hi:[1,1]
    v_mul_f32 v233, v233, v248
    v_mul_f32 v235, v235, v249
    v_cvt_pk_bf16_f32 v58, v224, v225
    v_cvt_pk_bf16_f32 v59, v226, v227
    v_cvt_pk_bf16_f32 v61, v228, v229
    v_cvt_pk_bf16_f32 v62, v230, v231
    v_cvt_pk_bf16_f32 v60, v233, v235
    v_mfma_f32_16x16x32_bf16 v[224:227], v[156:159], v[72:75], 0
    v_mfma_f32_16x16x32_bf16 v[232:235], v[172:175], v[72:75], v[252:255]
    v_mfma_f32_16x16x32_bf16 v[228:231], v[160:163], v[74:77], 0
    v_mfma_f32_16x16x32_bf16 v[232:235], v[176:179], v[74:77], v[232:235]
    v_rcp_f32 v250, v244
    v_rcp_f32 v251, v246
    v_mul_f32 v250, v4, v250
    v_mul_f32 v251, v4, v251
    v_pk_mul_f32 v[236:237], v[236:237], v[250:251] op_sel:[0,0] op_sel_hi:[1,0]
    v_pk_mul_f32 v[240:241], v[240:241], v[250:251] op_sel:[0,1] op_sel_hi:[1,1]
    v_pk_mul_f32 v[238:239], v[238:239], v[250:251] op_sel:[0,0] op_sel_hi:[1,0]
    v_pk_mul_f32 v[242:243], v[242:243], v[250:251] op_sel:[0,1] op_sel_hi:[1,1]
    v_mul_f32 v245, v245, v250
    v_mul_f32 v247, v247, v251
    v_cvt_pk_bf16_f32 v63, v236, v237
    v_cvt_pk_bf16_f32 v64, v238, v239
    v_cvt_pk_bf16_f32 v66, v240, v241
    v_cvt_pk_bf16_f32 v67, v242, v243
    v_cvt_pk_bf16_f32 v65, v245, v247
    v_mfma_f32_16x16x32_bf16 v[236:239], v[180:183], v[78:81], 0
    v_mfma_f32_16x16x32_bf16 v[244:247], v[196:199], v[78:81], v[252:255]
    v_mfma_f32_16x16x32_bf16 v[240:243], v[184:187], v[80:83], 0
    v_mfma_f32_16x16x32_bf16 v[244:247], v[200:203], v[80:83], v[244:247]
    v_rcp_f32 v248, v220
    v_rcp_f32 v249, v222
    v_mul_f32 v248, v5, v248
    v_mul_f32 v249, v5, v249
    v_pk_mul_f32 v[212:213], v[212:213], v[248:249] op_sel:[0,0] op_sel_hi:[1,0]
    v_pk_mul_f32 v[216:217], v[216:217], v[248:249] op_sel:[0,1] op_sel_hi:[1,1]
    v_pk_mul_f32 v[214:215], v[214:215], v[248:249] op_sel:[0,0] op_sel_hi:[1,0]
    v_pk_mul_f32 v[218:219], v[218:219], v[248:249] op_sel:[0,1] op_sel_hi:[1,1]
    v_mul_f32 v221, v221, v248
    v_mul_f32 v223, v223, v249
    v_cvt_pk_bf16_f32 v68, v212, v213
    v_cvt_pk_bf16_f32 v69, v214, v215
    v_cvt_pk_bf16_f32 v71, v216, v217
    v_cvt_pk_bf16_f32 v72, v218, v219
    v_cvt_pk_bf16_f32 v70, v221, v223
    v_mfma_f32_16x16x32_bf16 v[212:215], v[188:191], v[82:85], 0
    v_mfma_f32_16x16x32_bf16 v[220:223], v[204:207], v[82:85], v[252:255]
    v_mfma_f32_16x16x32_bf16 v[216:219], v[192:195], v[84:87], 0
    v_mfma_f32_16x16x32_bf16 v[220:223], v[208:211], v[84:87], v[220:223]
    v_rcp_f32 v250, v232
    v_rcp_f32 v251, v234
    v_mul_f32 v250, v5, v250
    v_mul_f32 v251, v5, v251
    v_pk_mul_f32 v[224:225], v[224:225], v[250:251] op_sel:[0,0] op_sel_hi:[1,0]
    v_pk_mul_f32 v[228:229], v[228:229], v[250:251] op_sel:[0,1] op_sel_hi:[1,1]
    v_pk_mul_f32 v[226:227], v[226:227], v[250:251] op_sel:[0,0] op_sel_hi:[1,0]
    v_pk_mul_f32 v[230:231], v[230:231], v[250:251] op_sel:[0,1] op_sel_hi:[1,1]
    v_mul_f32 v233, v233, v250
    v_mul_f32 v235, v235, v251
    v_cvt_pk_bf16_f32 v73, v224, v225
    v_cvt_pk_bf16_f32 v74, v226, v227
    v_cvt_pk_bf16_f32 v76, v228, v229
    v_cvt_pk_bf16_f32 v77, v230, v231
    v_cvt_pk_bf16_f32 v75, v233, v235
    v_rcp_f32 v248, v244
    v_rcp_f32 v249, v246
    v_mul_f32 v248, v5, v248
    v_mul_f32 v249, v5, v249
    v_pk_mul_f32 v[236:237], v[236:237], v[248:249] op_sel:[0,0] op_sel_hi:[1,0]
    v_pk_mul_f32 v[240:241], v[240:241], v[248:249] op_sel:[0,1] op_sel_hi:[1,1]
    v_pk_mul_f32 v[238:239], v[238:239], v[248:249] op_sel:[0,0] op_sel_hi:[1,0]
    v_pk_mul_f32 v[242:243], v[242:243], v[248:249] op_sel:[0,1] op_sel_hi:[1,1]
    v_mul_f32 v245, v245, v248
    v_mul_f32 v247, v247, v249
    v_cvt_pk_bf16_f32 v78, v236, v237
    v_cvt_pk_bf16_f32 v79, v238, v239
    v_cvt_pk_bf16_f32 v81, v240, v241
    v_cvt_pk_bf16_f32 v82, v242, v243
    v_cvt_pk_bf16_f32 v80, v245, v247
    v_rcp_f32 v250, v220
    v_rcp_f32 v251, v222
    v_mul_f32 v250, v5, v250
    v_mul_f32 v251, v5, v251
    v_pk_mul_f32 v[212:213], v[212:213], v[250:251] op_sel:[0,0] op_sel_hi:[1,0]
    v_pk_mul_f32 v[216:217], v[216:217], v[250:251] op_sel:[0,1] op_sel_hi:[1,1]
    v_pk_mul_f32 v[214:215], v[214:215], v[250:251] op_sel:[0,0] op_sel_hi:[1,0]
    v_pk_mul_f32 v[218:219], v[218:219], v[250:251] op_sel:[0,1] op_sel_hi:[1,1]
    v_mul_f32 v221, v221, v250
    v_mul_f32 v223, v223, v251
    v_cvt_pk_bf16_f32 v83, v212, v213
    v_cvt_pk_bf16_f32 v84, v214, v215
    v_cvt_pk_bf16_f32 v86, v216, v217
    v_cvt_pk_bf16_f32 v87, v218, v219
    v_cvt_pk_bf16_f32 v85, v221, v223
    v_lshlrev_b32 v6, 4, v0
    buffer_load_dwordx4 v[148:151], v6, s[36:39], s83 offen offset:0 sc1
    buffer_load_dwordx4 v[152:155], v6, s[36:39], s83 offen offset:1024 sc1
    buffer_load_dwordx4 v[156:159], v6, s[36:39], s83 offen offset:2048 sc1
    buffer_load_dwordx4 v[160:163], v6, s[36:39], s83 offen offset:3072 sc1
    s_add_u32 s83, s83, 4096
    buffer_load_dwordx4 v[164:167], v6, s[36:39], s83 offen offset:0 sc1
    s_add_u32 s83, s83, 1024
    buffer_load_dwordx4 v[168:171], v6, s[36:39], s83 offen offset:0 sc1
    buffer_load_dwordx4 v[172:175], v6, s[36:39], s83 offen offset:1024 sc1
    buffer_load_dwordx4 v[176:179], v6, s[36:39], s83 offen offset:2048 sc1
    buffer_load_dwordx4 v[180:183], v6, s[36:39], s83 offen offset:3072 sc1
    s_add_u32 s83, s83, 4096
    buffer_load_dwordx4 v[184:187], v6, s[36:39], s83 offen offset:0 sc1
    s_add_u32 s83, s83, 1024
    s_lshl_b32 s93, s6, 2
    v_mov_b32 v244, s93
    v_mov_b32 v245, 0
    s_lshl_b32 s79, s6, 10
    s_add_u32 s79, s79, 0x600
    v_lshl_add_u32 v247, v0, 4, s79
    s_mov_b32 s98, 0x3f80
    s_mov_b32 s99, 0x3f800000
    v_mfma_f32_16x16x32_bf16 v[212:215], v[88:91], v[8:11], 0
    v_mfma_f32_16x16x32_bf16 v[216:219], v[88:91], v[28:31], 0
    v_mfma_f32_16x16x32_bf16 v[220:223], v[88:91], v[48:51], 0
    v_mfma_f32_16x16x32_bf16 v[224:227], v[88:91], v[68:71], 0
    v_mfma_f32_16x16x32_bf16 v[212:215], v[92:95], v[12:15], v[212:215]
    v_mfma_f32_16x16x32_bf16 v[216:219], v[92:95], v[32:35], v[216:219]
    v_mfma_f32_16x16x32_bf16 v[220:223], v[92:95], v[52:55], v[220:223]
    v_mfma_f32_16x16x32_bf16 v[224:227], v[92:95], v[72:75], v[224:227]
    v_mfma_f32_16x16x32_bf16 v[212:215], v[96:99], v[16:19], v[212:215]
    v_mfma_f32_16x16x32_bf16 v[216:219], v[96:99], v[36:39], v[216:219]
    v_mfma_f32_16x16x32_bf16 v[220:223], v[96:99], v[56:59], v[220:223]
    v_mfma_f32_16x16x32_bf16 v[224:227], v[96:99], v[76:79], v[224:227]
    v_mfma_f32_16x16x32_bf16 v[212:215], v[100:103], v[20:23], v[212:215]
    v_mfma_f32_16x16x32_bf16 v[216:219], v[100:103], v[40:43], v[216:219]
    v_mfma_f32_16x16x32_bf16 v[220:223], v[100:103], v[60:63], v[220:223]
    v_mfma_f32_16x16x32_bf16 v[224:227], v[100:103], v[80:83], v[224:227]
    v_mfma_f32_16x16x32_bf16 v[212:215], v[104:107], v[24:27], v[212:215]
    v_mfma_f32_16x16x32_bf16 v[216:219], v[104:107], v[44:47], v[216:219]
    v_mfma_f32_16x16x32_bf16 v[220:223], v[104:107], v[64:67], v[220:223]
    v_mfma_f32_16x16x32_bf16 v[224:227], v[104:107], v[84:87], v[224:227]
    v_mfma_f32_16x16x32_bf16 v[188:191], v[108:111], v[8:11], 0
    v_mfma_f32_16x16x32_bf16 v[192:195], v[108:111], v[28:31], 0
    v_mfma_f32_16x16x32_bf16 v[196:199], v[108:111], v[48:51], 0
    v_mfma_f32_16x16x32_bf16 v[200:203], v[108:111], v[68:71], 0
    v_mfma_f32_16x16x32_bf16 v[188:191], v[112:115], v[12:15], v[188:191]
    v_mfma_f32_16x16x32_bf16 v[192:195], v[112:115], v[32:35], v[192:195]
    v_mfma_f32_16x16x32_bf16 v[196:199], v[112:115], v[52:55], v[196:199]
    v_mfma_f32_16x16x32_bf16 v[200:203], v[112:115], v[72:75], v[200:203]
    v_cvt_pk_bf16_f32 v228, v212, v213
    v_cvt_pk_bf16_f32 v229, v214, v215
    v_cvt_pk_bf16_f32 v232, v216, v217
    v_cvt_pk_bf16_f32 v233, v218, v219
    v_cvt_pk_bf16_f32 v236, v220, v221
    v_cvt_pk_bf16_f32 v237, v222, v223
    v_cvt_pk_bf16_f32 v240, v224, v225
    v_cvt_pk_bf16_f32 v241, v226, v227
    s_waitcnt vmcnt(10)
    ds_read_b128 v[88:91], v1 offset:0
    ds_read_b128 v[92:95], v1 offset:1024
    ds_read_b128 v[96:99], v1 offset:2048
    ds_read_b128 v[100:103], v1 offset:3072
    ds_read_b128 v[104:107], v1 offset:4096
    v_mfma_f32_16x16x32_bf16 v[188:191], v[116:119], v[16:19], v[188:191]
    v_mfma_f32_16x16x32_bf16 v[192:195], v[116:119], v[36:39], v[192:195]
    v_mfma_f32_16x16x32_bf16 v[196:199], v[116:119], v[56:59], v[196:199]
    v_mfma_f32_16x16x32_bf16 v[200:203], v[116:119], v[76:79], v[200:203]
    v_mfma_f32_16x16x32_bf16 v[188:191], v[120:123], v[20:23], v[188:191]
    v_mfma_f32_16x16x32_bf16 v[192:195], v[120:123], v[40:43], v[192:195]
    v_mfma_f32_16x16x32_bf16 v[196:199], v[120:123], v[60:63], v[196:199]
    v_mfma_f32_16x16x32_bf16 v[200:203], v[120:123], v[80:83], v[200:203]
    v_mfma_f32_16x16x32_bf16 v[188:191], v[124:127], v[24:27], v[188:191]
    v_mfma_f32_16x16x32_bf16 v[192:195], v[124:127], v[44:47], v[192:195]
    v_mfma_f32_16x16x32_bf16 v[196:199], v[124:127], v[64:67], v[196:199]
    v_mfma_f32_16x16x32_bf16 v[200:203], v[124:127], v[84:87], v[200:203]
    v_mfma_f32_16x16x32_bf16 v[212:215], v[128:131], v[8:11], 0
    v_mfma_f32_16x16x32_bf16 v[216:219], v[128:131], v[28:31], 0
    v_mfma_f32_16x16x32_bf16 v[220:223], v[128:131], v[48:51], 0
    v_mfma_f32_16x16x32_bf16 v[224:227], v[128:131], v[68:71], 0
    v_mfma_f32_16x16x32_bf16 v[212:215], v[132:135], v[12:15], v[212:215]
    v_mfma_f32_16x16x32_bf16 v[216:219], v[132:135], v[32:35], v[216:219]
    v_mfma_f32_16x16x32_bf16 v[220:223], v[132:135], v[52:55], v[220:223]
    v_mfma_f32_16x16x32_bf16 v[224:227], v[132:135], v[72:75], v[224:227]
    v_cvt_pk_bf16_f32 v230, v188, v189
    v_cvt_pk_bf16_f32 v231, v190, v191
    v_cvt_pk_bf16_f32 v234, v192, v193
    v_cvt_pk_bf16_f32 v235, v194, v195
    v_cvt_pk_bf16_f32 v238, v196, v197
    v_cvt_pk_bf16_f32 v239, v198, v199
    v_cvt_pk_bf16_f32 v242, v200, v201
    v_cvt_pk_bf16_f32 v243, v202, v203
    ds_read_b128 v[108:111], v1 offset:5120
    ds_read_b128 v[112:115], v1 offset:6144
    ds_read_b128 v[116:119], v1 offset:7168
    ds_read_b128 v[120:123], v1 offset:8192
    ds_read_b128 v[124:127], v1 offset:9216
    ds_write_b128 v1, v[228:231] offset:0
    ds_write_b128 v1, v[232:235] offset:1024
    ds_write_b128 v1, v[236:239] offset:2048
    ds_write_b128 v1, v[240:243] offset:3072
    v_mov_b32 v246, 1
    ds_write_b32 v244, v246
    ds_read_b128 v[252:255], v245
    v_mfma_f32_16x16x32_bf16 v[212:215], v[136:139], v[16:19], v[212:215]
    v_mfma_f32_16x16x32_bf16 v[216:219], v[136:139], v[36:39], v[216:219]
    v_mfma_f32_16x16x32_bf16 v[220:223], v[136:139], v[56:59], v[220:223]
    v_mfma_f32_16x16x32_bf16 v[224:227], v[136:139], v[76:79], v[224:227]
    v_mfma_f32_16x16x32_bf16 v[212:215], v[140:143], v[20:23], v[212:215]
    v_mfma_f32_16x16x32_bf16 v[216:219], v[140:143], v[40:43], v[216:219]
    v_mfma_f32_16x16x32_bf16 v[220:223], v[140:143], v[60:63], v[220:223]
    v_mfma_f32_16x16x32_bf16 v[224:227], v[140:143], v[80:83], v[224:227]
    v_mfma_f32_16x16x32_bf16 v[212:215], v[144:147], v[24:27], v[212:215]
    v_mfma_f32_16x16x32_bf16 v[216:219], v[144:147], v[44:47], v[216:219]
    v_mfma_f32_16x16x32_bf16 v[220:223], v[144:147], v[64:67], v[220:223]
    v_mfma_f32_16x16x32_bf16 v[224:227], v[144:147], v[84:87], v[224:227]
    s_waitcnt lgkmcnt(0)
    v_min3_u32 v246, v252, v253, v254
    v_min_u32 v246, v246, v255
    s_nop 0
    v_readfirstlane_b32 s74, v246
    s_cmp_ge_u32 s74, 1
    s_cbranch_scc1 L42
    s_mov_b32 s75, 0x40000
L43:
    s_sub_u32 s75, s75, 1
    s_cbranch_scc1 L42
    ds_read_b128 v[252:255], v245
    s_waitcnt lgkmcnt(0)
    v_min3_u32 v246, v252, v253, v254
    v_min_u32 v246, v246, v255
    s_nop 0
    v_readfirstlane_b32 s74, v246
    s_cmp_ge_u32 s74, 1
    s_cbranch_scc0 L43
L42:
    ds_read_b128 v[228:231], v247 offset:0
    ds_read_b128 v[232:235], v247 offset:20480
    ds_read_b128 v[236:239], v247 offset:40960
    ds_read_b128 v[240:243], v247 offset:61440
    v_mfma_f32_16x16x32_bf16 v[188:191], v[88:91], v[8:11], 0
    v_mfma_f32_16x16x32_bf16 v[192:195], v[88:91], v[28:31], 0
    v_mfma_f32_16x16x32_bf16 v[196:199], v[88:91], v[48:51], 0
    v_mfma_f32_16x16x32_bf16 v[200:203], v[88:91], v[68:71], 0
    v_mfma_f32_16x16x32_bf16 v[188:191], v[92:95], v[12:15], v[188:191]
    v_mfma_f32_16x16x32_bf16 v[192:195], v[92:95], v[32:35], v[192:195]
    v_mfma_f32_16x16x32_bf16 v[196:199], v[92:95], v[52:55], v[196:199]
    v_mfma_f32_16x16x32_bf16 v[200:203], v[92:95], v[72:75], v[200:203]
    s_waitcnt lgkmcnt(0)
    v_mov_b32 v246, 2
    ds_write_b32 v244, v246
    ds_read_b128 v[252:255], v245
    v_dot2_f32_bf16 v204, v228, s98, 0
    v_dot2_f32_bf16 v205, v228, s99, 0
    v_dot2_f32_bf16 v206, v229, s98, 0
    v_dot2_f32_bf16 v207, v229, s99, 0
    v_dot2_f32_bf16 v208, v230, s98, 0
    v_dot2_f32_bf16 v209, v230, s99, 0
    v_dot2_f32_bf16 v210, v231, s98, 0
    v_dot2_f32_bf16 v211, v231, s99, 0
    v_dot2_f32_bf16 v204, v232, s98, v204
    v_dot2_f32_bf16 v205, v232, s99, v205
    v_dot2_f32_bf16 v206, v233, s98, v206
    v_dot2_f32_bf16 v207, v233, s99, v207
    v_dot2_f32_bf16 v208, v234, s98, v208
    v_dot2_f32_bf16 v209, v234, s99, v209
    v_dot2_f32_bf16 v210, v235, s98, v210
    v_dot2_f32_bf16 v211, v235, s99, v211
    v_dot2_f32_bf16 v204, v236, s98, v204
    v_dot2_f32_bf16 v205, v236, s99, v205
    v_dot2_f32_bf16 v206, v237, s98, v206
    v_dot2_f32_bf16 v207, v237, s99, v207
    v_dot2_f32_bf16 v208, v238, s98, v208
    v_dot2_f32_bf16 v209, v238, s99, v209
    v_dot2_f32_bf16 v210, v239, s98, v210
    v_dot2_f32_bf16 v211, v239, s99, v211
    v_dot2_f32_bf16 v204, v240, s98, v204
    v_dot2_f32_bf16 v205, v240, s99, v205
    v_dot2_f32_bf16 v206, v241, s98, v206
    v_dot2_f32_bf16 v207, v241, s99, v207
    v_dot2_f32_bf16 v208, v242, s98, v208
    v_dot2_f32_bf16 v209, v242, s99, v209
    v_dot2_f32_bf16 v210, v243, s98, v210
    v_dot2_f32_bf16 v211, v243, s99, v211
    v_cvt_pk_bf16_f32 v248, v204, v205
    v_cvt_pk_bf16_f32 v249, v206, v207
    v_cvt_pk_bf16_f32 v250, v208, v209
    v_cvt_pk_bf16_f32 v251, v210, v211
    buffer_store_dwordx4 v[248:251], v6, s[36:39], s92 offen sc1
    s_setprio 0
    v_mfma_f32_16x16x32_bf16 v[188:191], v[96:99], v[16:19], v[188:191]
    v_mfma_f32_16x16x32_bf16 v[192:195], v[96:99], v[36:39], v[192:195]
    v_mfma_f32_16x16x32_bf16 v[196:199], v[96:99], v[56:59], v[196:199]
    v_mfma_f32_16x16x32_bf16 v[200:203], v[96:99], v[76:79], v[200:203]
    v_mfma_f32_16x16x32_bf16 v[188:191], v[100:103], v[20:23], v[188:191]
    v_mfma_f32_16x16x32_bf16 v[192:195], v[100:103], v[40:43], v[192:195]
    v_mfma_f32_16x16x32_bf16 v[196:199], v[100:103], v[60:63], v[196:199]
    v_mfma_f32_16x16x32_bf16 v[200:203], v[100:103], v[80:83], v[200:203]
    s_waitcnt lgkmcnt(0)
    v_min3_u32 v246, v252, v253, v254
    v_min_u32 v246, v246, v255
    s_nop 0
    v_readfirstlane_b32 s74, v246
    s_cmp_ge_u32 s74, 2
    s_cbranch_scc1 L44
    s_mov_b32 s75, 0x40000
L45:
    s_sub_u32 s75, s75, 1
    s_cbranch_scc1 L44
    ds_read_b128 v[252:255], v245
    s_waitcnt lgkmcnt(0)
    v_min3_u32 v246, v252, v253, v254
    v_min_u32 v246, v246, v255
    s_nop 0
    v_readfirstlane_b32 s74, v246
    s_cmp_ge_u32 s74, 2
    s_cbranch_scc0 L45
L44:
    v_cvt_pk_bf16_f32 v212, v212, v213
    v_cvt_pk_bf16_f32 v213, v214, v215
    ds_write_b64 v7, v[212:213] offset:0
    v_cvt_pk_bf16_f32 v216, v216, v217
    v_cvt_pk_bf16_f32 v217, v218, v219
    ds_write_b64 v7, v[216:217] offset:2560
    v_cvt_pk_bf16_f32 v220, v220, v221
    v_cvt_pk_bf16_f32 v221, v222, v223
    ds_write_b64 v7, v[220:221] offset:5120
    v_cvt_pk_bf16_f32 v224, v224, v225
    v_cvt_pk_bf16_f32 v225, v226, v227
    ds_write_b64 v7, v[224:225] offset:7680
    v_mfma_f32_16x16x32_bf16 v[188:191], v[104:107], v[24:27], v[188:191]
    v_mfma_f32_16x16x32_bf16 v[192:195], v[104:107], v[44:47], v[192:195]
    v_mfma_f32_16x16x32_bf16 v[196:199], v[104:107], v[64:67], v[196:199]
    v_mfma_f32_16x16x32_bf16 v[200:203], v[104:107], v[84:87], v[200:203]
    v_mfma_f32_16x16x32_bf16 v[212:215], v[108:111], v[8:11], 0
    v_mfma_f32_16x16x32_bf16 v[216:219], v[108:111], v[28:31], 0
    v_mfma_f32_16x16x32_bf16 v[220:223], v[108:111], v[48:51], 0
    v_mfma_f32_16x16x32_bf16 v[224:227], v[108:111], v[68:71], 0
    v_mfma_f32_16x16x32_bf16 v[212:215], v[112:115], v[12:15], v[212:215]
    v_mfma_f32_16x16x32_bf16 v[216:219], v[112:115], v[32:35], v[216:219]
    v_mfma_f32_16x16x32_bf16 v[220:223], v[112:115], v[52:55], v[220:223]
    v_mfma_f32_16x16x32_bf16 v[224:227], v[112:115], v[72:75], v[224:227]
    v_cvt_pk_bf16_f32 v188, v188, v189
    v_cvt_pk_bf16_f32 v189, v190, v191
    ds_write_b64 v7, v[188:189] offset:32
    v_cvt_pk_bf16_f32 v192, v192, v193
    v_cvt_pk_bf16_f32 v193, v194, v195
    ds_write_b64 v7, v[192:193] offset:2592
    v_cvt_pk_bf16_f32 v196, v196, v197
    v_cvt_pk_bf16_f32 v197, v198, v199
    ds_write_b64 v7, v[196:197] offset:5152
    v_cvt_pk_bf16_f32 v200, v200, v201
    v_cvt_pk_bf16_f32 v201, v202, v203
    ds_write_b64 v7, v[200:201] offset:7712
    s_waitcnt vmcnt(0)
    v_mov_b32 v244, s94
    v_mov_b32 v245, 1
    v_writelane_b32 v244, s95, 1
    s_mov_b32 exec_lo, s96
    s_mov_b32 exec_hi, 0
    buffer_atomic_add v245, v244, s[36:39], 0 offen sc1
    s_mov_b64 exec, -1
    v_mfma_f32_16x16x32_bf16 v[212:215], v[116:119], v[16:19], v[212:215]
    v_mfma_f32_16x16x32_bf16 v[216:219], v[116:119], v[36:39], v[216:219]
    v_mfma_f32_16x16x32_bf16 v[220:223], v[116:119], v[56:59], v[220:223]
    v_mfma_f32_16x16x32_bf16 v[224:227], v[116:119], v[76:79], v[224:227]
    v_mfma_f32_16x16x32_bf16 v[212:215], v[120:123], v[20:23], v[212:215]
    v_mfma_f32_16x16x32_bf16 v[216:219], v[120:123], v[40:43], v[216:219]
    v_mfma_f32_16x16x32_bf16 v[220:223], v[120:123], v[60:63], v[220:223]
    v_mfma_f32_16x16x32_bf16 v[224:227], v[120:123], v[80:83], v[224:227]
    v_and_b32 v244, 1, v0
    v_lshlrev_b32 v244, 4, v244
    v_mov_b32 v245, 0x3f80
    v_lshlrev_b32 v245, v244, v245
    v_mov_b32 v228, 0
    v_mov_b32 v229, 0
    v_mov_b32 v230, 0
    v_mov_b32 v231, 0
    v_mov_b32 v232, 0
    v_mov_b32 v233, 0
    v_mov_b32 v234, 0
    v_mov_b32 v235, 0
    v_mov_b32 v236, 0
    v_mov_b32 v237, 0
    v_mov_b32 v238, 0
    v_mov_b32 v239, 0
    v_mov_b32 v240, 0
    v_mov_b32 v241, 0
    v_mov_b32 v242, 0
    v_mov_b32 v243, 0
    s_mov_b32 exec_lo, 0x30003
    s_mov_b32 exec_hi, 0x30003
    v_mov_b32 v228, v245
    v_mov_b32 v230, v245
    s_mov_b32 exec_lo, 0xc000c
    s_mov_b32 exec_hi, 0xc000c
    v_mov_b32 v229, v245
    v_mov_b32 v231, v245
    s_mov_b32 exec_lo, 0x300030
    s_mov_b32 exec_hi, 0x300030
    v_mov_b32 v232, v245
    v_mov_b32 v234, v245
    s_mov_b32 exec_lo, 0xc000c0
    s_mov_b32 exec_hi, 0xc000c0
    v_mov_b32 v233, v245
    v_mov_b32 v235, v245
    s_mov_b32 exec_lo, 0x3000300
    s_mov_b32 exec_hi, 0x3000300
    v_mov_b32 v236, v245
    v_mov_b32 v238, v245
    s_mov_b32 exec_lo, 0xc000c00
    s_mov_b32 exec_hi, 0xc000c00
    v_mov_b32 v237, v245
    v_mov_b32 v239, v245
    s_mov_b32 exec_lo, 0x30003000
    s_mov_b32 exec_hi, 0x30003000
    v_mov_b32 v240, v245
    v_mov_b32 v242, v245
    s_mov_b32 exec_lo, 0xc000c000
    s_mov_b32 exec_hi, 0xc000c000
    v_mov_b32 v241, v245
    v_mov_b32 v243, v245
    s_mov_b64 exec, -1
    v_mfma_f32_16x16x32_bf16 v[212:215], v[124:127], v[24:27], v[212:215]
    v_mfma_f32_16x16x32_bf16 v[216:219], v[124:127], v[44:47], v[216:219]
    v_mfma_f32_16x16x32_bf16 v[220:223], v[124:127], v[64:67], v[220:223]
    v_mfma_f32_16x16x32_bf16 v[224:227], v[124:127], v[84:87], v[224:227]
    v_mfma_f32_16x16x32_bf16 v[188:191], v[148:151], v[8:11], 0
    v_mfma_f32_16x16x32_bf16 v[192:195], v[148:151], v[28:31], 0
    v_mfma_f32_16x16x32_bf16 v[196:199], v[148:151], v[48:51], 0
    v_mfma_f32_16x16x32_bf16 v[200:203], v[148:151], v[68:71], 0
    v_mfma_f32_16x16x32_bf16 v[188:191], v[152:155], v[12:15], v[188:191]
    v_mfma_f32_16x16x32_bf16 v[192:195], v[152:155], v[32:35], v[192:195]
    v_mfma_f32_16x16x32_bf16 v[196:199], v[152:155], v[52:55], v[196:199]
    v_mfma_f32_16x16x32_bf16 v[200:203], v[152:155], v[72:75], v[200:203]
    v_cvt_pk_bf16_f32 v212, v212, v213
    v_cvt_pk_bf16_f32 v213, v214, v215
    ds_write_b64 v7, v[212:213] offset:64
    v_cvt_pk_bf16_f32 v216, v216, v217
    v_cvt_pk_bf16_f32 v217, v218, v219
    ds_write_b64 v7, v[216:217] offset:2624
    v_cvt_pk_bf16_f32 v220, v220, v221
    v_cvt_pk_bf16_f32 v221, v222, v223
    ds_write_b64 v7, v[220:221] offset:5184
    v_cvt_pk_bf16_f32 v224, v224, v225
    v_cvt_pk_bf16_f32 v225, v226, v227
    ds_write_b64 v7, v[224:225] offset:7744
    v_mfma_f32_16x16x32_bf16 v[188:191], v[156:159], v[16:19], v[188:191]
    v_mfma_f32_16x16x32_bf16 v[192:195], v[156:159], v[36:39], v[192:195]
    v_mfma_f32_16x16x32_bf16 v[196:199], v[156:159], v[56:59], v[196:199]
    v_mfma_f32_16x16x32_bf16 v[200:203], v[156:159], v[76:79], v[200:203]
    v_mfma_f32_16x16x32_bf16 v[188:191], v[160:163], v[20:23], v[188:191]
    v_mfma_f32_16x16x32_bf16 v[192:195], v[160:163], v[40:43], v[192:195]
    v_mfma_f32_16x16x32_bf16 v[196:199], v[160:163], v[60:63], v[196:199]
    v_mfma_f32_16x16x32_bf16 v[200:203], v[160:163], v[80:83], v[200:203]
    v_mfma_f32_16x16x32_bf16 v[188:191], v[164:167], v[24:27], v[188:191]
    v_mfma_f32_16x16x32_bf16 v[192:195], v[164:167], v[44:47], v[192:195]
    v_mfma_f32_16x16x32_bf16 v[196:199], v[164:167], v[64:67], v[196:199]
    v_mfma_f32_16x16x32_bf16 v[200:203], v[164:167], v[84:87], v[200:203]
    v_mfma_f32_16x16x32_bf16 v[212:215], v[168:171], v[8:11], 0
    v_mfma_f32_16x16x32_bf16 v[216:219], v[168:171], v[28:31], 0
    v_mfma_f32_16x16x32_bf16 v[220:223], v[168:171], v[48:51], 0
    v_mfma_f32_16x16x32_bf16 v[224:227], v[168:171], v[68:71], 0
    v_mfma_f32_16x16x32_bf16 v[212:215], v[172:175], v[12:15], v[212:215]
    v_mfma_f32_16x16x32_bf16 v[216:219], v[172:175], v[32:35], v[216:219]
    v_mfma_f32_16x16x32_bf16 v[220:223], v[172:175], v[52:55], v[220:223]
    v_mfma_f32_16x16x32_bf16 v[224:227], v[172:175], v[72:75], v[224:227]
    v_cvt_pk_bf16_f32 v188, v188, v189
    v_cvt_pk_bf16_f32 v189, v190, v191
    ds_write_b64 v7, v[188:189] offset:96
    v_cvt_pk_bf16_f32 v192, v192, v193
    v_cvt_pk_bf16_f32 v193, v194, v195
    ds_write_b64 v7, v[192:193] offset:2656
    v_cvt_pk_bf16_f32 v196, v196, v197
    v_cvt_pk_bf16_f32 v197, v198, v199
    ds_write_b64 v7, v[196:197] offset:5216
    v_cvt_pk_bf16_f32 v200, v200, v201
    v_cvt_pk_bf16_f32 v201, v202, v203
    ds_write_b64 v7, v[200:201] offset:7776
    v_mfma_f32_16x16x32_bf16 v[212:215], v[176:179], v[16:19], v[212:215]
    v_mfma_f32_16x16x32_bf16 v[216:219], v[176:179], v[36:39], v[216:219]
    v_mfma_f32_16x16x32_bf16 v[220:223], v[176:179], v[56:59], v[220:223]
    v_mfma_f32_16x16x32_bf16 v[224:227], v[176:179], v[76:79], v[224:227]
    v_mfma_f32_16x16x32_bf16 v[212:215], v[180:183], v[20:23], v[212:215]
    v_mfma_f32_16x16x32_bf16 v[216:219], v[180:183], v[40:43], v[216:219]
    v_mfma_f32_16x16x32_bf16 v[220:223], v[180:183], v[60:63], v[220:223]
    v_mfma_f32_16x16x32_bf16 v[224:227], v[180:183], v[80:83], v[224:227]
    v_mfma_f32_16x16x32_bf16 v[212:215], v[184:187], v[24:27], v[212:215]
    v_mfma_f32_16x16x32_bf16 v[216:219], v[184:187], v[44:47], v[216:219]
    v_mfma_f32_16x16x32_bf16 v[220:223], v[184:187], v[64:67], v[220:223]
    v_mfma_f32_16x16x32_bf16 v[224:227], v[184:187], v[84:87], v[224:227]
    v_and_b32 v254, 15, v0
    v_lshrrev_b32 v253, 4, v0
    v_mul_u32_u24 v253, 0x5000, v253
    v_lshl_add_u32 v253, v254, 3, v253
    s_lshl_b32 s79, s6, 9
    s_add_u32 s79, s79, 0x600
    v_add_u32 v204, s79, v253
    v_add_u32 v205, 128, v204
    v_add_u32 v206, 256, v204
    v_add_u32 v207, 384, v204
    s_lshl_b32 s79, s6, 6
    v_add_u32 v247, s79, v0
    v_mul_u32_u24 v254, 0x667, v247
    v_lshrrev_b32 v248, 14, v254
    v_and_b32 v254, 1, v248
    v_mul_u32_u24 v254, 0x230, v254
    v_lshl_add_u32 v254, v247, 3, v254
    v_lshrrev_b32 v253, 6, v248
    v_mul_u32_u24 v253, 0x500, v253
    v_add_u32 v247, v254, v253
    v_lshrrev_b32 v248, 1, v248
    v_and_b32 v254, 31, v248
    v_mul_u32_u24 v254, 0x14000, v254
    v_add_u32 v254, v254, v247
    v_mul_u32_u24 v253, 0xa0, v248
    v_sub_u32 v248, v254, v253
    s_add_u32 s79, s6, 4
    s_lshl_b32 s79, s79, 6
    v_add_u32 v247, s79, v0
    v_mul_u32_u24 v254, 0x667, v247
    v_lshrrev_b32 v249, 14, v254
    v_and_b32 v254, 1, v249
    v_mul_u32_u24 v254, 0x230, v254
    v_lshl_add_u32 v254, v247, 3, v254
    v_lshrrev_b32 v253, 6, v249
    v_mul_u32_u24 v253, 0x500, v253
    v_add_u32 v247, v254, v253
    v_lshrrev_b32 v249, 1, v249
    v_and_b32 v254, 31, v249
    v_mul_u32_u24 v254, 0x14000, v254
    v_add_u32 v254, v254, v247
    v_mul_u32_u24 v253, 0xa0, v249
    v_sub_u32 v249, v254, v253
    s_mul_i32 s79, s4, 0xa00
    s_mul_i32 s78, s5, 0x50
    s_add_u32 s86, s79, s78
    v_cvt_pk_bf16_f32 v212, v212, v213
    v_cvt_pk_bf16_f32 v213, v214, v215
    ds_write_b64 v7, v[212:213] offset:128
    v_cvt_pk_bf16_f32 v216, v216, v217
    v_cvt_pk_bf16_f32 v217, v218, v219
    ds_write_b64 v7, v[216:217] offset:2688
    v_cvt_pk_bf16_f32 v220, v220, v221
    v_cvt_pk_bf16_f32 v221, v222, v223
    ds_write_b64 v7, v[220:221] offset:5248
    v_cvt_pk_bf16_f32 v224, v224, v225
    v_cvt_pk_bf16_f32 v225, v226, v227
    ds_write_b64 v7, v[224:225] offset:7808
    s_waitcnt lgkmcnt(0)
    s_barrier
    ds_read2st64_b64 v[8:11], v204 offset0:0 offset1:156
    ds_read2st64_b64 v[12:15], v205 offset0:0 offset1:156
    ds_read2st64_b64 v[16:19], v206 offset0:0 offset1:156
    ds_read2st64_b64 v[20:23], v207 offset0:0 offset1:156
    ds_read2st64_b64 v[24:27], v204 offset0:4 offset1:160
    ds_read2st64_b64 v[28:31], v205 offset0:4 offset1:160
    ds_read2st64_b64 v[32:35], v206 offset0:4 offset1:160
    ds_read2st64_b64 v[36:39], v207 offset0:4 offset1:160
    s_waitcnt lgkmcnt(7)
    v_mfma_f32_16x16x32_bf16 v[56:59], v[228:231], v[8:11], 0
    s_waitcnt lgkmcnt(6)
    v_mfma_f32_16x16x32_bf16 v[56:59], v[232:235], v[12:15], v[56:59]
    s_waitcnt lgkmcnt(5)
    v_mfma_f32_16x16x32_bf16 v[56:59], v[236:239], v[16:19], v[56:59]
    s_waitcnt lgkmcnt(4)
    v_mfma_f32_16x16x32_bf16 v[56:59], v[240:243], v[20:23], v[56:59]
    s_waitcnt lgkmcnt(3)
    v_mfma_f32_16x16x32_bf16 v[60:63], v[228:231], v[24:27], 0
    s_waitcnt lgkmcnt(2)
    v_mfma_f32_16x16x32_bf16 v[60:63], v[232:235], v[28:31], v[60:63]
    s_waitcnt lgkmcnt(1)
    v_mfma_f32_16x16x32_bf16 v[60:63], v[236:239], v[32:35], v[60:63]
    s_waitcnt lgkmcnt(0)
    v_mfma_f32_16x16x32_bf16 v[60:63], v[240:243], v[36:39], v[60:63]
    v_cvt_pk_bf16_f32 v56, v56, v57
    v_cvt_pk_bf16_f32 v57, v58, v59
    buffer_store_dwordx2 v[56:57], v248, s[60:63], s86 offen
    s_nop 4
    v_cvt_pk_bf16_f32 v60, v60, v61
    v_cvt_pk_bf16_f32 v61, v62, v63
    buffer_store_dwordx2 v[60:61], v249, s[60:63], s86 offen
    s_endpgm
FINAL_D:
    s_and_b32 s6, s3, 3
    s_cmp_lg_u32 s100, 0
    s_cbranch_scc1 L46
    s_setprio 2
L46:
    s_lshl_b32 s79, s4, 8
    s_add_u32 s84, s79, 0xb50000
    v_and_b32 v211, 15, v0
    v_lshlrev_b32 v242, 2, v211
    s_cmp_eq_u32 s101, 64
    s_cbranch_scc1 L47
    s_and_b32 s87, s2, 15
    s_lshl_b32 s87, s87, 9
    s_add_u32 s87, s87, 0xc34000
    v_and_b32 v241, 7, v0
    v_lshlrev_b32 v241, 6, v241
    s_waitcnt vmcnt(0)
    buffer_load_dword v240, v241, s[36:39], s87 offen offset:0 sc1
    s_waitcnt vmcnt(0)
    v_cmp_ne_u32 vcc, 8, v240
    s_cmp_eq_u64 vcc, 0
    s_cbranch_scc1 L48
    s_mov_b32 s90, 0x8000
L49:
    s_sub_u32 s90, s90, 1
    s_cbranch_scc1 L48
    s_sleep 1
    buffer_load_dword v240, v241, s[36:39], s87 offen offset:0 sc1
    s_waitcnt vmcnt(0)
    v_cmp_ne_u32 vcc, 8, v240
    s_cmp_eq_u64 vcc, 0
    s_cbranch_scc0 L49
L48:
    s_waitcnt vmcnt(0)
    s_nop 1
L47:
    buffer_load_dword v232, v242, s[36:39], s84 offen offset:0 sc1
    buffer_load_dword v233, v242, s[36:39], s84 offen offset:64 sc1
    buffer_load_dword v234, v242, s[36:39], s84 offen offset:128 sc1
    buffer_load_dword v235, v242, s[36:39], s84 offen offset:192 sc1
    v_mov_b32 v241, 0
    v_lshlrev_b32 v1, 4, v0
    s_and_b32 s79, s6, 1
    s_lshl_b32 s79, s79, 11
    s_mul_i32 s78, s4, 0x14100
    s_lshr_b32 s77, s6, 1
    s_mul_i32 s77, s77, 0x5000
    s_add_u32 s77, s78, s77
    s_add_u32 s77, s79, s77
    s_add_u32 s80, s77, 0x8b0000
    s_mul_i32 s79, s6, 0x5000
    s_add_u32 s81, s79, 0x13e00
    s_lshl_b32 s79, s4, 10
    s_add_u32 s85, s79, 0x560000
    s_mov_b32 s60, s22
    s_and_b32 s61, s23, 0xffff
    s_mov_b32 s62, 0x280000
    s_mov_b32 s63, 0x20000
    v_lshrrev_b32 v211, 4, v0
    v_lshrrev_b32 v210, 2, v0
    v_and_b32 v210, 3, v210
    v_lshl_add_u32 v210, v211, 2, v210
    v_and_b32 v211, 3, v0
    v_lshlrev_b32 v211, 4, v211
    v_lshl_add_u32 v211, v210, 6, v211
    v_add_u32 v2, s81, v211
    v_lshrrev_b32 v211, 4, v0
    v_lshrrev_b32 v210, 2, v0
    v_and_b32 v210, 3, v210
    v_lshl_add_u32 v210, v211, 2, v210
    v_lshlrev_b32 v210, 4, v210
    v_add_u32 v237, 0x200, v210
    v_lshrrev_b32 v211, 4, v0
    v_and_b32 v210, 15, v0
    v_mul_u32_u24 v210, 0xa0, v210
    v_lshl_add_u32 v210, v211, 3, v210
    v_add_u32 v3, s81, v210
    s_bitcmp1_b32 s6, 0
    s_cselect_b32 s96, 0x80008000, 0
    s_mul_i32 s79, s6, 0x5000
    s_add_u32 s79, s79, 0x2e00
    v_lshl_add_u32 v238, v0, 4, s79
    v_and_b32 v211, 15, v0
    s_mul_i32 s79, s5, 40
    v_add_u32 v212, s79, v211
    v_cvt_f32_u32 v212, v212
    v_lshrrev_b32 v211, 4, v0
    s_lshr_b32 s79, s6, 1
    s_mul_i32 s79, s79, 0xa0
    s_and_b32 s78, s6, 1
    s_add_u32 s78, s79, s78
    v_lshl_add_u32 v213, v211, 3, s78
    v_cvt_f32_u32 v213, v213
    v_add_f32 v215, 0x00000000, v213
    v_mul_f32 v214, v215, v212
    v_mul_f32 v28, 0x3acccccd, v214
    v_floor_f32 v28, v28
    v_mul_f32 v28, 0x44200000, v28
    v_sub_f32 v214, v28, v214
    v_mul_f32 v214, 0x3acccccd, v214
    v_cos_f32 v4, v214
    v_sin_f32 v5, v214
    v_mul_f32 v215, 0xbccccccd, v215
    v_cos_f32 v20, v215
    v_sin_f32 v21, v215
    v_add_f32 v215, 0x40000000, v213
    v_mul_f32 v214, v215, v212
    v_mul_f32 v28, 0x3acccccd, v214
    v_floor_f32 v28, v28
    v_mul_f32 v28, 0x44200000, v28
    v_sub_f32 v214, v28, v214
    v_mul_f32 v214, 0x3acccccd, v214
    v_cos_f32 v6, v214
    v_sin_f32 v7, v214
    v_mul_f32 v215, 0xbccccccd, v215
    v_cos_f32 v22, v215
    v_sin_f32 v23, v215
    v_add_f32 v215, 0x40800000, v213
    v_mul_f32 v214, v215, v212
    v_mul_f32 v28, 0x3acccccd, v214
    v_floor_f32 v28, v28
    v_mul_f32 v28, 0x44200000, v28
    v_sub_f32 v214, v28, v214
    v_mul_f32 v214, 0x3acccccd, v214
    v_cos_f32 v8, v214
    v_sin_f32 v9, v214
    v_mul_f32 v215, 0xbccccccd, v215
    v_cos_f32 v24, v215
    v_sin_f32 v25, v215
    v_add_f32 v215, 0x40c00000, v213
    v_mul_f32 v214, v215, v212
    v_mul_f32 v28, 0x3acccccd, v214
    v_floor_f32 v28, v28
    v_mul_f32 v28, 0x44200000, v28
    v_sub_f32 v214, v28, v214
    v_mul_f32 v214, 0x3acccccd, v214
    v_cos_f32 v10, v214
    v_sin_f32 v11, v214
    v_mul_f32 v215, 0xbccccccd, v215
    v_cos_f32 v26, v215
    v_sin_f32 v27, v215
    v_mul_f32 v214, 0xbd4ccccd, v212
    v_cos_f32 v36, v214
    v_sin_f32 v37, v214
    s_mov_b32 s82, 0x3e9e377a
    s_mov_b32 s83, 0x3f737871
    v_and_b32 v211, 1, v0
    v_lshlrev_b32 v211, 31, v211
    v_add_u32 v236, 0x3f003f00, v211
    s_cmp_eq_u32 s6, 0
    s_cselect_b32 s88, 0xffff, 0
    s_mov_b32 s89, 0
    s_cselect_b32 s92, 0x00010001, 0
    s_mov_b32 s93, s92
    s_cselect_b64 s[94:95], -1, 0
    v_cvt_pk_bf16_f32 v116, v4, v5
    v_cvt_pk_bf16_f32 v117, v6, v7
    v_cvt_pk_bf16_f32 v118, v8, v9
    v_cvt_pk_bf16_f32 v119, v10, v11
    v_cndmask_b32 v116, v116, v236, s[88:89]
    v_pk_mul_f32 v[32:33], v[4:5], v[36:37] op_sel:[0,0] op_sel_hi:[0,1]
    v_pk_fma_f32 v[12:13], v[4:5], v[36:37], v[32:33] op_sel:[1,1,0] op_sel_hi:[1,0,1] neg_lo:[1,0,0]
    v_pk_mul_f32 v[34:35], v[6:7], v[36:37] op_sel:[0,0] op_sel_hi:[0,1]
    v_pk_fma_f32 v[14:15], v[6:7], v[36:37], v[34:35] op_sel:[1,1,0] op_sel_hi:[1,0,1] neg_lo:[1,0,0]
    v_pk_mul_f32 v[28:29], v[8:9], v[36:37] op_sel:[0,0] op_sel_hi:[0,1]
    v_pk_fma_f32 v[16:17], v[8:9], v[36:37], v[28:29] op_sel:[1,1,0] op_sel_hi:[1,0,1] neg_lo:[1,0,0]
    v_pk_mul_f32 v[30:31], v[10:11], v[36:37] op_sel:[0,0] op_sel_hi:[0,1]
    v_pk_fma_f32 v[18:19], v[10:11], v[36:37], v[30:31] op_sel:[1,1,0] op_sel_hi:[1,0,1] neg_lo:[1,0,0]
    v_cvt_pk_bf16_f32 v120, v12, v13
    v_cvt_pk_bf16_f32 v121, v14, v15
    v_cvt_pk_bf16_f32 v122, v16, v17
    v_cvt_pk_bf16_f32 v123, v18, v19
    v_pk_mul_f32 v[32:33], v[12:13], v[36:37] op_sel:[0,0] op_sel_hi:[0,1]
    v_pk_fma_f32 v[12:13], v[12:13], v[36:37], v[32:33] op_sel:[1,1,0] op_sel_hi:[1,0,1] neg_lo:[1,0,0]
    v_pk_mul_f32 v[34:35], v[14:15], v[36:37] op_sel:[0,0] op_sel_hi:[0,1]
    v_pk_fma_f32 v[14:15], v[14:15], v[36:37], v[34:35] op_sel:[1,1,0] op_sel_hi:[1,0,1] neg_lo:[1,0,0]
    v_pk_mul_f32 v[28:29], v[16:17], v[36:37] op_sel:[0,0] op_sel_hi:[0,1]
    v_pk_fma_f32 v[16:17], v[16:17], v[36:37], v[28:29] op_sel:[1,1,0] op_sel_hi:[1,0,1] neg_lo:[1,0,0]
    v_pk_mul_f32 v[30:31], v[18:19], v[36:37] op_sel:[0,0] op_sel_hi:[0,1]
    v_pk_fma_f32 v[18:19], v[18:19], v[36:37], v[30:31] op_sel:[1,1,0] op_sel_hi:[1,0,1] neg_lo:[1,0,0]
    v_cvt_pk_bf16_f32 v124, v12, v13
    v_cvt_pk_bf16_f32 v125, v14, v15
    v_cvt_pk_bf16_f32 v126, v16, v17
    v_cvt_pk_bf16_f32 v127, v18, v19
    v_pk_mul_f32 v[32:33], v[12:13], v[36:37] op_sel:[0,0] op_sel_hi:[0,1]
    v_pk_fma_f32 v[12:13], v[12:13], v[36:37], v[32:33] op_sel:[1,1,0] op_sel_hi:[1,0,1] neg_lo:[1,0,0]
    v_pk_mul_f32 v[34:35], v[14:15], v[36:37] op_sel:[0,0] op_sel_hi:[0,1]
    v_pk_fma_f32 v[14:15], v[14:15], v[36:37], v[34:35] op_sel:[1,1,0] op_sel_hi:[1,0,1] neg_lo:[1,0,0]
    v_pk_mul_f32 v[28:29], v[16:17], v[36:37] op_sel:[0,0] op_sel_hi:[0,1]
    v_pk_fma_f32 v[16:17], v[16:17], v[36:37], v[28:29] op_sel:[1,1,0] op_sel_hi:[1,0,1] neg_lo:[1,0,0]
    v_pk_mul_f32 v[30:31], v[18:19], v[36:37] op_sel:[0,0] op_sel_hi:[0,1]
    v_pk_fma_f32 v[18:19], v[18:19], v[36:37], v[30:31] op_sel:[1,1,0] op_sel_hi:[1,0,1] neg_lo:[1,0,0]
    v_cvt_pk_bf16_f32 v128, v12, v13
    v_cvt_pk_bf16_f32 v129, v14, v15
    v_cvt_pk_bf16_f32 v130, v16, v17
    v_cvt_pk_bf16_f32 v131, v18, v19
    v_pk_mul_f32 v[32:33], v[12:13], v[36:37] op_sel:[0,0] op_sel_hi:[0,1]
    v_pk_fma_f32 v[12:13], v[12:13], v[36:37], v[32:33] op_sel:[1,1,0] op_sel_hi:[1,0,1] neg_lo:[1,0,0]
    v_pk_mul_f32 v[34:35], v[14:15], v[36:37] op_sel:[0,0] op_sel_hi:[0,1]
    v_pk_fma_f32 v[14:15], v[14:15], v[36:37], v[34:35] op_sel:[1,1,0] op_sel_hi:[1,0,1] neg_lo:[1,0,0]
    v_pk_mul_f32 v[28:29], v[16:17], v[36:37] op_sel:[0,0] op_sel_hi:[0,1]
    v_pk_fma_f32 v[16:17], v[16:17], v[36:37], v[28:29] op_sel:[1,1,0] op_sel_hi:[1,0,1] neg_lo:[1,0,0]
    v_pk_mul_f32 v[30:31], v[18:19], v[36:37] op_sel:[0,0] op_sel_hi:[0,1]
    v_pk_fma_f32 v[18:19], v[18:19], v[36:37], v[30:31] op_sel:[1,1,0] op_sel_hi:[1,0,1] neg_lo:[1,0,0]
    v_cvt_pk_bf16_f32 v132, v12, v13
    v_cvt_pk_bf16_f32 v133, v14, v15
    v_cvt_pk_bf16_f32 v134, v16, v17
    v_cvt_pk_bf16_f32 v135, v18, v19
    v_pk_mul_f32 v[32:33], v[4:5], v[20:21] op_sel:[0,0] op_sel_hi:[0,1]
    v_pk_fma_f32 v[4:5], v[4:5], v[20:21], v[32:33] op_sel:[1,1,0] op_sel_hi:[1,0,1] neg_lo:[1,0,0]
    v_pk_mul_f32 v[34:35], v[6:7], v[22:23] op_sel:[0,0] op_sel_hi:[0,1]
    v_pk_fma_f32 v[6:7], v[6:7], v[22:23], v[34:35] op_sel:[1,1,0] op_sel_hi:[1,0,1] neg_lo:[1,0,0]
    v_pk_mul_f32 v[28:29], v[8:9], v[24:25] op_sel:[0,0] op_sel_hi:[0,1]
    v_pk_fma_f32 v[8:9], v[8:9], v[24:25], v[28:29] op_sel:[1,1,0] op_sel_hi:[1,0,1] neg_lo:[1,0,0]
    v_pk_mul_f32 v[30:31], v[10:11], v[26:27] op_sel:[0,0] op_sel_hi:[0,1]
    v_pk_fma_f32 v[10:11], v[10:11], v[26:27], v[30:31] op_sel:[1,1,0] op_sel_hi:[1,0,1] neg_lo:[1,0,0]
    v_pk_mul_f32 v[32:33], v[36:37], s[82:83] op_sel:[0,0] op_sel_hi:[0,1]
    v_pk_fma_f32 v[36:37], v[36:37], s[82:83], v[32:33] op_sel:[1,1,0] op_sel_hi:[1,0,1] neg_lo:[1,0,0]
    v_cvt_pk_bf16_f32 v136, v4, v5
    v_cvt_pk_bf16_f32 v137, v6, v7
    v_cvt_pk_bf16_f32 v138, v8, v9
    v_cvt_pk_bf16_f32 v139, v10, v11
    v_cndmask_b32 v136, v136, v236, s[88:89]
    v_pk_mul_f32 v[32:33], v[4:5], v[36:37] op_sel:[0,0] op_sel_hi:[0,1]
    v_pk_fma_f32 v[12:13], v[4:5], v[36:37], v[32:33] op_sel:[1,1,0] op_sel_hi:[1,0,1] neg_lo:[1,0,0]
    v_pk_mul_f32 v[34:35], v[6:7], v[36:37] op_sel:[0,0] op_sel_hi:[0,1]
    v_pk_fma_f32 v[14:15], v[6:7], v[36:37], v[34:35] op_sel:[1,1,0] op_sel_hi:[1,0,1] neg_lo:[1,0,0]
    v_pk_mul_f32 v[28:29], v[8:9], v[36:37] op_sel:[0,0] op_sel_hi:[0,1]
    v_pk_fma_f32 v[16:17], v[8:9], v[36:37], v[28:29] op_sel:[1,1,0] op_sel_hi:[1,0,1] neg_lo:[1,0,0]
    v_pk_mul_f32 v[30:31], v[10:11], v[36:37] op_sel:[0,0] op_sel_hi:[0,1]
    v_pk_fma_f32 v[18:19], v[10:11], v[36:37], v[30:31] op_sel:[1,1,0] op_sel_hi:[1,0,1] neg_lo:[1,0,0]
    v_cvt_pk_bf16_f32 v140, v12, v13
    v_cvt_pk_bf16_f32 v141, v14, v15
    v_cvt_pk_bf16_f32 v142, v16, v17
    v_cvt_pk_bf16_f32 v143, v18, v19
    v_pk_mul_f32 v[32:33], v[12:13], v[36:37] op_sel:[0,0] op_sel_hi:[0,1]
    v_pk_fma_f32 v[12:13], v[12:13], v[36:37], v[32:33] op_sel:[1,1,0] op_sel_hi:[1,0,1] neg_lo:[1,0,0]
    v_pk_mul_f32 v[34:35], v[14:15], v[36:37] op_sel:[0,0] op_sel_hi:[0,1]
    v_pk_fma_f32 v[14:15], v[14:15], v[36:37], v[34:35] op_sel:[1,1,0] op_sel_hi:[1,0,1] neg_lo:[1,0,0]
    v_pk_mul_f32 v[28:29], v[16:17], v[36:37] op_sel:[0,0] op_sel_hi:[0,1]
    v_pk_fma_f32 v[16:17], v[16:17], v[36:37], v[28:29] op_sel:[1,1,0] op_sel_hi:[1,0,1] neg_lo:[1,0,0]
    v_pk_mul_f32 v[30:31], v[18:19], v[36:37] op_sel:[0,0] op_sel_hi:[0,1]
    v_pk_fma_f32 v[18:19], v[18:19], v[36:37], v[30:31] op_sel:[1,1,0] op_sel_hi:[1,0,1] neg_lo:[1,0,0]
    v_cvt_pk_bf16_f32 v144, v12, v13
    v_cvt_pk_bf16_f32 v145, v14, v15
    v_cvt_pk_bf16_f32 v146, v16, v17
    v_cvt_pk_bf16_f32 v147, v18, v19
    v_pk_mul_f32 v[32:33], v[12:13], v[36:37] op_sel:[0,0] op_sel_hi:[0,1]
    v_pk_fma_f32 v[12:13], v[12:13], v[36:37], v[32:33] op_sel:[1,1,0] op_sel_hi:[1,0,1] neg_lo:[1,0,0]
    v_pk_mul_f32 v[34:35], v[14:15], v[36:37] op_sel:[0,0] op_sel_hi:[0,1]
    v_pk_fma_f32 v[14:15], v[14:15], v[36:37], v[34:35] op_sel:[1,1,0] op_sel_hi:[1,0,1] neg_lo:[1,0,0]
    v_pk_mul_f32 v[28:29], v[16:17], v[36:37] op_sel:[0,0] op_sel_hi:[0,1]
    v_pk_fma_f32 v[16:17], v[16:17], v[36:37], v[28:29] op_sel:[1,1,0] op_sel_hi:[1,0,1] neg_lo:[1,0,0]
    v_pk_mul_f32 v[30:31], v[18:19], v[36:37] op_sel:[0,0] op_sel_hi:[0,1]
    v_pk_fma_f32 v[18:19], v[18:19], v[36:37], v[30:31] op_sel:[1,1,0] op_sel_hi:[1,0,1] neg_lo:[1,0,0]
    v_cvt_pk_bf16_f32 v148, v12, v13
    v_cvt_pk_bf16_f32 v149, v14, v15
    v_cvt_pk_bf16_f32 v150, v16, v17
    v_cvt_pk_bf16_f32 v151, v18, v19
    v_pk_mul_f32 v[32:33], v[12:13], v[36:37] op_sel:[0,0] op_sel_hi:[0,1]
    v_pk_fma_f32 v[12:13], v[12:13], v[36:37], v[32:33] op_sel:[1,1,0] op_sel_hi:[1,0,1] neg_lo:[1,0,0]
    v_pk_mul_f32 v[34:35], v[14:15], v[36:37] op_sel:[0,0] op_sel_hi:[0,1]
    v_pk_fma_f32 v[14:15], v[14:15], v[36:37], v[34:35] op_sel:[1,1,0] op_sel_hi:[1,0,1] neg_lo:[1,0,0]
    v_pk_mul_f32 v[28:29], v[16:17], v[36:37] op_sel:[0,0] op_sel_hi:[0,1]
    v_pk_fma_f32 v[16:17], v[16:17], v[36:37], v[28:29] op_sel:[1,1,0] op_sel_hi:[1,0,1] neg_lo:[1,0,0]
    v_pk_mul_f32 v[30:31], v[18:19], v[36:37] op_sel:[0,0] op_sel_hi:[0,1]
    v_pk_fma_f32 v[18:19], v[18:19], v[36:37], v[30:31] op_sel:[1,1,0] op_sel_hi:[1,0,1] neg_lo:[1,0,0]
    s_and_b32 s79, s2, 63
    s_lshl_b32 s79, s79, 9
    s_add_u32 s87, s79, 0xc28000
    v_cvt_pk_bf16_f32 v152, v12, v13
    v_cvt_pk_bf16_f32 v153, v14, v15
    v_cvt_pk_bf16_f32 v154, v16, v17
    v_cvt_pk_bf16_f32 v155, v18, v19
    v_pk_mul_f32 v[32:33], v[4:5], v[20:21] op_sel:[0,0] op_sel_hi:[0,1]
    v_pk_fma_f32 v[4:5], v[4:5], v[20:21], v[32:33] op_sel:[1,1,0] op_sel_hi:[1,0,1] neg_lo:[1,0,0]
    v_pk_mul_f32 v[34:35], v[6:7], v[22:23] op_sel:[0,0] op_sel_hi:[0,1]
    v_pk_fma_f32 v[6:7], v[6:7], v[22:23], v[34:35] op_sel:[1,1,0] op_sel_hi:[1,0,1] neg_lo:[1,0,0]
    v_pk_mul_f32 v[28:29], v[8:9], v[24:25] op_sel:[0,0] op_sel_hi:[0,1]
    v_pk_fma_f32 v[8:9], v[8:9], v[24:25], v[28:29] op_sel:[1,1,0] op_sel_hi:[1,0,1] neg_lo:[1,0,0]
    v_pk_mul_f32 v[30:31], v[10:11], v[26:27] op_sel:[0,0] op_sel_hi:[0,1]
    v_pk_fma_f32 v[10:11], v[10:11], v[26:27], v[30:31] op_sel:[1,1,0] op_sel_hi:[1,0,1] neg_lo:[1,0,0]
    v_pk_mul_f32 v[32:33], v[36:37], s[82:83] op_sel:[0,0] op_sel_hi:[0,1]
    v_pk_fma_f32 v[36:37], v[36:37], s[82:83], v[32:33] op_sel:[1,1,0] op_sel_hi:[1,0,1] neg_lo:[1,0,0]
    v_cvt_pk_bf16_f32 v156, v4, v5
    v_cvt_pk_bf16_f32 v157, v6, v7
    v_cvt_pk_bf16_f32 v158, v8, v9
    v_cvt_pk_bf16_f32 v159, v10, v11
    v_cndmask_b32 v156, v156, v236, s[88:89]
    v_pk_mul_f32 v[32:33], v[4:5], v[36:37] op_sel:[0,0] op_sel_hi:[0,1]
    v_pk_fma_f32 v[12:13], v[4:5], v[36:37], v[32:33] op_sel:[1,1,0] op_sel_hi:[1,0,1] neg_lo:[1,0,0]
    v_pk_mul_f32 v[34:35], v[6:7], v[36:37] op_sel:[0,0] op_sel_hi:[0,1]
    v_pk_fma_f32 v[14:15], v[6:7], v[36:37], v[34:35] op_sel:[1,1,0] op_sel_hi:[1,0,1] neg_lo:[1,0,0]
    v_pk_mul_f32 v[28:29], v[8:9], v[36:37] op_sel:[0,0] op_sel_hi:[0,1]
    v_pk_fma_f32 v[16:17], v[8:9], v[36:37], v[28:29] op_sel:[1,1,0] op_sel_hi:[1,0,1] neg_lo:[1,0,0]
    v_pk_mul_f32 v[30:31], v[10:11], v[36:37] op_sel:[0,0] op_sel_hi:[0,1]
    v_pk_fma_f32 v[18:19], v[10:11], v[36:37], v[30:31] op_sel:[1,1,0] op_sel_hi:[1,0,1] neg_lo:[1,0,0]
    v_cvt_pk_bf16_f32 v160, v12, v13
    v_cvt_pk_bf16_f32 v161, v14, v15
    v_cvt_pk_bf16_f32 v162, v16, v17
    v_cvt_pk_bf16_f32 v163, v18, v19
    v_pk_mul_f32 v[32:33], v[12:13], v[36:37] op_sel:[0,0] op_sel_hi:[0,1]
    v_pk_fma_f32 v[12:13], v[12:13], v[36:37], v[32:33] op_sel:[1,1,0] op_sel_hi:[1,0,1] neg_lo:[1,0,0]
    v_pk_mul_f32 v[34:35], v[14:15], v[36:37] op_sel:[0,0] op_sel_hi:[0,1]
    v_pk_fma_f32 v[14:15], v[14:15], v[36:37], v[34:35] op_sel:[1,1,0] op_sel_hi:[1,0,1] neg_lo:[1,0,0]
    v_pk_mul_f32 v[28:29], v[16:17], v[36:37] op_sel:[0,0] op_sel_hi:[0,1]
    v_pk_fma_f32 v[16:17], v[16:17], v[36:37], v[28:29] op_sel:[1,1,0] op_sel_hi:[1,0,1] neg_lo:[1,0,0]
    v_pk_mul_f32 v[30:31], v[18:19], v[36:37] op_sel:[0,0] op_sel_hi:[0,1]
    v_pk_fma_f32 v[18:19], v[18:19], v[36:37], v[30:31] op_sel:[1,1,0] op_sel_hi:[1,0,1] neg_lo:[1,0,0]
    v_cvt_pk_bf16_f32 v164, v12, v13
    v_cvt_pk_bf16_f32 v165, v14, v15
    v_cvt_pk_bf16_f32 v166, v16, v17
    v_cvt_pk_bf16_f32 v167, v18, v19
    v_pk_mul_f32 v[32:33], v[12:13], v[36:37] op_sel:[0,0] op_sel_hi:[0,1]
    v_pk_fma_f32 v[12:13], v[12:13], v[36:37], v[32:33] op_sel:[1,1,0] op_sel_hi:[1,0,1] neg_lo:[1,0,0]
    v_pk_mul_f32 v[34:35], v[14:15], v[36:37] op_sel:[0,0] op_sel_hi:[0,1]
    v_pk_fma_f32 v[14:15], v[14:15], v[36:37], v[34:35] op_sel:[1,1,0] op_sel_hi:[1,0,1] neg_lo:[1,0,0]
    v_pk_mul_f32 v[28:29], v[16:17], v[36:37] op_sel:[0,0] op_sel_hi:[0,1]
    v_pk_fma_f32 v[16:17], v[16:17], v[36:37], v[28:29] op_sel:[1,1,0] op_sel_hi:[1,0,1] neg_lo:[1,0,0]
    v_pk_mul_f32 v[30:31], v[18:19], v[36:37] op_sel:[0,0] op_sel_hi:[0,1]
    v_pk_fma_f32 v[18:19], v[18:19], v[36:37], v[30:31] op_sel:[1,1,0] op_sel_hi:[1,0,1] neg_lo:[1,0,0]
    v_cvt_pk_bf16_f32 v168, v12, v13
    v_cvt_pk_bf16_f32 v169, v14, v15
    v_cvt_pk_bf16_f32 v170, v16, v17
    v_cvt_pk_bf16_f32 v171, v18, v19
    v_pk_mul_f32 v[32:33], v[12:13], v[36:37] op_sel:[0,0] op_sel_hi:[0,1]
    v_pk_fma_f32 v[12:13], v[12:13], v[36:37], v[32:33] op_sel:[1,1,0] op_sel_hi:[1,0,1] neg_lo:[1,0,0]
    v_pk_mul_f32 v[34:35], v[14:15], v[36:37] op_sel:[0,0] op_sel_hi:[0,1]
    v_pk_fma_f32 v[14:15], v[14:15], v[36:37], v[34:35] op_sel:[1,1,0] op_sel_hi:[1,0,1] neg_lo:[1,0,0]
    v_pk_mul_f32 v[28:29], v[16:17], v[36:37] op_sel:[0,0] op_sel_hi:[0,1]
    v_pk_fma_f32 v[16:17], v[16:17], v[36:37], v[28:29] op_sel:[1,1,0] op_sel_hi:[1,0,1] neg_lo:[1,0,0]
    v_pk_mul_f32 v[30:31], v[18:19], v[36:37] op_sel:[0,0] op_sel_hi:[0,1]
    v_pk_fma_f32 v[18:19], v[18:19], v[36:37], v[30:31] op_sel:[1,1,0] op_sel_hi:[1,0,1] neg_lo:[1,0,0]
    v_cvt_pk_bf16_f32 v172, v12, v13
    v_cvt_pk_bf16_f32 v173, v14, v15
    v_cvt_pk_bf16_f32 v174, v16, v17
    v_cvt_pk_bf16_f32 v175, v18, v19
    v_and_b32 v211, 15, v0
    s_lshl_b32 s79, s4, 1
    v_lshl_add_u32 v212, v211, 6, s79
    v_cvt_f32_u32 v212, v212
    v_mul_f32 v212, 0x3a000000, v212
    v_add_f32 v215, v212, v212
    v_lshrrev_b32 v211, 4, v0
    v_lshl_add_u32 v213, v211, 3, 0
    v_cvt_f32_u32 v213, v213
    v_mul_f32 v214, v212, v213
    v_cos_f32 v44, v214
    v_sin_f32 v48, v214
    v_add_f32 v214, v214, v215
    v_cos_f32 v45, v214
    v_sin_f32 v49, v214
    v_add_f32 v214, v214, v215
    v_cos_f32 v46, v214
    v_sin_f32 v50, v214
    v_add_f32 v214, v214, v215
    v_cos_f32 v47, v214
    v_sin_f32 v51, v214
    v_cvt_pk_bf16_f32 v176, v48, v49
    v_cvt_pk_bf16_f32 v178, v44, v45
    v_xor_b32 v180, 0x80008000, v176
    v_cvt_pk_bf16_f32 v177, v50, v51
    v_cvt_pk_bf16_f32 v179, v46, v47
    v_xor_b32 v181, 0x80008000, v177
    v_lshrrev_b32 v211, 4, v0
    v_lshl_add_u32 v213, v211, 3, 1
    v_cvt_f32_u32 v213, v213
    v_mul_f32 v214, v212, v213
    v_cos_f32 v44, v214
    v_sin_f32 v48, v214
    v_add_f32 v214, v214, v215
    v_cos_f32 v45, v214
    v_sin_f32 v49, v214
    v_add_f32 v214, v214, v215
    v_cos_f32 v46, v214
    v_sin_f32 v50, v214
    v_add_f32 v214, v214, v215
    v_cos_f32 v47, v214
    v_sin_f32 v51, v214
    v_cvt_pk_bf16_f32 v182, v48, v49
    v_cvt_pk_bf16_f32 v184, v44, v45
    v_xor_b32 v186, 0x80008000, v182
    v_cvt_pk_bf16_f32 v183, v50, v51
    v_cvt_pk_bf16_f32 v185, v46, v47
    v_xor_b32 v187, 0x80008000, v183
    v_and_b32 v211, 15, v0
    s_lshl_b32 s79, s4, 1
    s_add_u32 s79, s79, 1
    v_lshl_add_u32 v212, v211, 6, s79
    v_cvt_f32_u32 v212, v212
    v_mul_f32 v212, 0x3a000000, v212
    v_add_f32 v215, v212, v212
    v_lshrrev_b32 v211, 4, v0
    v_lshl_add_u32 v213, v211, 3, 0
    v_cvt_f32_u32 v213, v213
    v_mul_f32 v214, v212, v213
    v_cos_f32 v44, v214
    v_sin_f32 v48, v214
    v_add_f32 v214, v214, v215
    v_cos_f32 v45, v214
    v_sin_f32 v49, v214
    v_add_f32 v214, v214, v215
    v_cos_f32 v46, v214
    v_sin_f32 v50, v214
    v_add_f32 v214, v214, v215
    v_cos_f32 v47, v214
    v_sin_f32 v51, v214
    v_cvt_pk_bf16_f32 v188, v48, v49
    v_cvt_pk_bf16_f32 v190, v44, v45
    v_xor_b32 v192, 0x80008000, v188
    v_cvt_pk_bf16_f32 v189, v50, v51
    v_cvt_pk_bf16_f32 v191, v46, v47
    v_xor_b32 v193, 0x80008000, v189
    v_lshrrev_b32 v211, 4, v0
    v_lshl_add_u32 v213, v211, 3, 1
    v_cvt_f32_u32 v213, v213
    v_mul_f32 v214, v212, v213
    v_cos_f32 v44, v214
    v_sin_f32 v48, v214
    v_add_f32 v214, v214, v215
    v_cos_f32 v45, v214
    v_sin_f32 v49, v214
    v_add_f32 v214, v214, v215
    v_cos_f32 v46, v214
    v_sin_f32 v50, v214
    v_add_f32 v214, v214, v215
    v_cos_f32 v47, v214
    v_sin_f32 v51, v214
    v_cvt_pk_bf16_f32 v194, v48, v49
    v_cvt_pk_bf16_f32 v196, v44, v45
    v_xor_b32 v198, 0x80008000, v194
    v_cvt_pk_bf16_f32 v195, v50, v51
    v_cvt_pk_bf16_f32 v197, v46, v47
    v_xor_b32 v199, 0x80008000, v195
    s_waitcnt vmcnt(3)
    v_sub_f32 v232, 1.0, v232
    v_mul_f32 v232, 0x35cccccd, v232
    s_waitcnt vmcnt(2)
    v_sub_f32 v233, 1.0, v233
    v_mul_f32 v233, 0x35cccccd, v233
    s_waitcnt vmcnt(1)
    v_sub_f32 v234, 1.0, v234
    v_mul_f32 v234, 0x35cccccd, v234
    s_waitcnt vmcnt(0)
    v_sub_f32 v235, 1.0, v235
    v_mul_f32 v235, 0x35cccccd, v235
    v_and_b32 v212, 1, v0
    v_lshlrev_b32 v212, 4, v212
    v_mov_b32 v213, 0x3f80
    v_lshlrev_b32 v213, v212, v213
    v_mov_b32 v44, 0
    v_mov_b32 v45, 0
    v_mov_b32 v46, 0
    v_mov_b32 v47, 0
    v_mov_b32 v48, 0
    v_mov_b32 v49, 0
    v_mov_b32 v50, 0
    v_mov_b32 v51, 0
    v_mov_b32 v52, 0
    v_mov_b32 v53, 0
    v_mov_b32 v54, 0
    v_mov_b32 v55, 0
    v_mov_b32 v56, 0
    v_mov_b32 v57, 0
    v_mov_b32 v58, 0
    v_mov_b32 v59, 0
    s_mov_b32 exec_lo, 0x30003
    s_mov_b32 exec_hi, 0x30003
    v_mov_b32 v44, v213
    v_mov_b32 v46, v213
    s_mov_b32 exec_lo, 0xc000c
    s_mov_b32 exec_hi, 0xc000c
    v_mov_b32 v45, v213
    v_mov_b32 v47, v213
    s_mov_b32 exec_lo, 0x300030
    s_mov_b32 exec_hi, 0x300030
    v_mov_b32 v48, v213
    v_mov_b32 v50, v213
    s_mov_b32 exec_lo, 0xc000c0
    s_mov_b32 exec_hi, 0xc000c0
    v_mov_b32 v49, v213
    v_mov_b32 v51, v213
    s_mov_b32 exec_lo, 0x3000300
    s_mov_b32 exec_hi, 0x3000300
    v_mov_b32 v52, v213
    v_mov_b32 v54, v213
    s_mov_b32 exec_lo, 0xc000c00
    s_mov_b32 exec_hi, 0xc000c00
    v_mov_b32 v53, v213
    v_mov_b32 v55, v213
    s_mov_b32 exec_lo, 0x30003000
    s_mov_b32 exec_hi, 0x30003000
    v_mov_b32 v56, v213
    v_mov_b32 v58, v213
    s_mov_b32 exec_lo, 0xc000c000
    s_mov_b32 exec_hi, 0xc000c000
    v_mov_b32 v57, v213
    v_mov_b32 v59, v213
    s_mov_b64 exec, -1
    v_and_b32 v211, 15, v0
    v_lshrrev_b32 v210, 4, v0
    v_mul_u32_u24 v210, 0x5000, v210
    v_lshl_add_u32 v210, v211, 3, v210
    s_add_u32 s79, s6, 8
    s_lshl_b32 s79, s79, 9
    s_add_u32 s79, s79, 0x600
    v_add_u32 v200, s79, v210
    v_add_u32 v201, 128, v200
    v_add_u32 v202, 256, v200
    v_add_u32 v203, 384, v200
    s_add_u32 s79, s6, 8
    s_lshl_b32 s79, s79, 6
    v_add_u32 v212, s79, v0
    v_mul_u32_u24 v211, 0x667, v212
    v_lshrrev_b32 v204, 14, v211
    v_and_b32 v211, 1, v204
    v_mul_u32_u24 v211, 0x230, v211
    v_lshl_add_u32 v211, v212, 3, v211
    v_lshrrev_b32 v210, 6, v204
    v_mul_u32_u24 v210, 0x500, v210
    v_add_u32 v212, v211, v210
    v_lshrrev_b32 v204, 1, v204
    v_and_b32 v211, 31, v204
    v_mul_u32_u24 v211, 0x14000, v211
    v_add_u32 v211, v211, v212
    v_mul_u32_u24 v210, 0xa0, v204
    v_sub_u32 v204, v211, v210
    s_add_u32 s79, s6, 12
    s_lshl_b32 s79, s79, 6
    v_add_u32 v212, s79, v0
    v_mul_u32_u24 v211, 0x667, v212
    v_lshrrev_b32 v205, 14, v211
    v_and_b32 v211, 1, v205
    v_mul_u32_u24 v211, 0x230, v211
    v_lshl_add_u32 v211, v212, 3, v211
    v_lshrrev_b32 v210, 6, v205
    v_mul_u32_u24 v210, 0x500, v210
    v_add_u32 v212, v211, v210
    v_lshrrev_b32 v205, 1, v205
    v_and_b32 v211, 31, v205
    v_mul_u32_u24 v211, 0x14000, v211
    v_add_u32 v211, v211, v212
    v_mul_u32_u24 v210, 0xa0, v205
    v_sub_u32 v205, v211, v210
    s_add_u32 s79, s6, 16
    s_lshl_b32 s79, s79, 6
    v_add_u32 v212, s79, v0
    v_mul_u32_u24 v211, 0x667, v212
    v_lshrrev_b32 v206, 14, v211
    v_and_b32 v211, 1, v206
    v_mul_u32_u24 v211, 0x230, v211
    v_lshl_add_u32 v211, v212, 3, v211
    v_lshrrev_b32 v210, 6, v206
    v_mul_u32_u24 v210, 0x500, v210
    v_add_u32 v212, v211, v210
    v_lshrrev_b32 v206, 1, v206
    v_and_b32 v211, 31, v206
    v_mul_u32_u24 v211, 0x14000, v211
    v_add_u32 v211, v211, v212
    v_mul_u32_u24 v210, 0xa0, v206
    v_sub_u32 v206, v211, v210
    s_mul_i32 s79, s4, 0xa00
    s_mul_i32 s78, s5, 0x50
    s_add_u32 s86, s79, s78
    s_cmp_eq_u32 s100, 0
    s_cbranch_scc1 L50
    s_mov_b32 s91, 0x40000
    v_mov_b32 v214, 0
L51:
    s_sub_u32 s91, s91, 1
    s_cbranch_scc1 L50
    s_sleep 1
    ds_read_b32 v215, v214 offset:52
    s_waitcnt lgkmcnt(0)
    s_waitcnt lgkmcnt(0)
    v_readfirstlane_b32 s90, v215
    s_cmp_ge_u32 s90, s100
    s_cbranch_scc0 L51
    s_nop 2
L50:
    ds_write_b128 v238, v[44:47] offset:0
    ds_write_b128 v238, v[48:51] offset:1024
    ds_write_b128 v238, v[52:55] offset:2048
    ds_write_b128 v238, v[56:59] offset:3072
    s_mov_b32 s91, 2000
    s_waitcnt lgkmcnt(0)
    s_cmp_lg_u32 s6, 0
    s_cbranch_scc1 L52
    v_and_b32 v214, 7, v0
    v_lshlrev_b32 v214, 6, v214
    buffer_load_dword v240, v214, s[36:39], s87 offen offset:0 sc1
    s_waitcnt vmcnt(0)
    v_cmp_ne_u32 vcc, 8, v240
    s_cmp_eq_u64 vcc, 0
    s_cbranch_scc1 L54
    s_mov_b32 s90, 0x8000
L55:
    s_sub_u32 s90, s90, 1
    s_cbranch_scc1 L54
    s_sleep 4
    buffer_load_dword v240, v214, s[36:39], s87 offen offset:0 sc1
    s_waitcnt vmcnt(0)
    v_cmp_ne_u32 vcc, 8, v240
    s_cmp_eq_u64 vcc, 0
    s_cbranch_scc0 L55
L54:
    ds_write_b32 v241, v240 offset:16
    s_nop 1
    s_branch L53
L52:
    s_mov_b32 s90, 0x100000
L56:
    s_sub_u32 s90, s90, 1
    s_cbranch_scc1 L53
    s_sleep 1
    ds_read_b32 v240, v241 offset:16
    s_waitcnt lgkmcnt(0)
    v_readfirstlane_b32 s74, v240
    s_cmp_eq_u32 s74, 0
    s_cbranch_scc1 L56
    s_nop 2
L53:
    s_setprio 2
    s_mov_b32 m0, 512
    s_mov_b64 exec, s[94:95]
    buffer_load_dwordx4 v1, s[36:39], s85 offen sc1 lds
    s_mov_b64 exec, -1
    s_add_u32 m0, s81, 0
    s_add_u32 s74, s80, 0
    buffer_load_dwordx4 v1, s[36:39], s74 offen offset:0 sc1 lds
    buffer_load_dwordx4 v1, s[36:39], s74 offen offset:1024 sc1 lds
    s_add_u32 m0, s81, 10240
    s_add_u32 s74, s80, 41088
    buffer_load_dwordx4 v1, s[36:39], s74 offen offset:0 sc1 lds
    buffer_load_dwordx4 v1, s[36:39], s74 offen offset:1024 sc1 lds
    s_add_u32 m0, s81, 2048
    s_add_u32 s74, s80, 4096
    buffer_load_dwordx4 v1, s[36:39], s74 offen offset:0 sc1 lds
    buffer_load_dwordx4 v1, s[36:39], s74 offen offset:1024 sc1 lds
    s_add_u32 m0, s81, 12288
    s_add_u32 s74, s80, 45184
    buffer_load_dwordx4 v1, s[36:39], s74 offen offset:0 sc1 lds
    buffer_load_dwordx4 v1, s[36:39], s74 offen offset:1024 sc1 lds
    s_add_u32 m0, s81, 4096
    s_add_u32 s74, s80, 8192
    buffer_load_dwordx4 v1, s[36:39], s74 offen offset:0 sc1 lds
    buffer_load_dwordx4 v1, s[36:39], s74 offen offset:1024 sc1 lds
    s_add_u32 m0, s81, 14336
    s_add_u32 s74, s80, 49280
    buffer_load_dwordx4 v1, s[36:39], s74 offen offset:0 sc1 lds
    buffer_load_dwordx4 v1, s[36:39], s74 offen offset:1024 sc1 lds
    s_add_u32 m0, s81, 6144
    s_add_u32 s74, s80, 12288
    buffer_load_dwordx4 v1, s[36:39], s74 offen offset:0 sc1 lds
    buffer_load_dwordx4 v1, s[36:39], s74 offen offset:1024 sc1 lds
    s_add_u32 m0, s81, 16384
    s_add_u32 s74, s80, 53376
    buffer_load_dwordx4 v1, s[36:39], s74 offen offset:0 sc1 lds
    buffer_load_dwordx4 v1, s[36:39], s74 offen offset:1024 sc1 lds
    s_add_u32 m0, s81, 8192
    s_add_u32 s74, s80, 16384
    buffer_load_dwordx4 v1, s[36:39], s74 offen offset:0 sc1 lds
    buffer_load_dwordx4 v1, s[36:39], s74 offen offset:1024 sc1 lds
    s_add_u32 m0, s81, 18432
    s_add_u32 s74, s80, 57472
    buffer_load_dwordx4 v1, s[36:39], s74 offen offset:0 sc1 lds
    buffer_load_dwordx4 v1, s[36:39], s74 offen offset:1024 sc1 lds
L57:
    s_waitcnt vmcnt(18)
    ds_read_b64_tr_b16 v[208:209], v2 offset:0
    ds_read_b64_tr_b16 v[210:211], v2 offset:8
    ds_read_b64_tr_b16 v[212:213], v2 offset:1024
    ds_read_b64_tr_b16 v[214:215], v2 offset:1032
    ds_read_b64_tr_b16 v[68:69], v237 offset:0
    ds_read_b64_tr_b16 v[70:71], v237 offset:8
    ds_read_b64_tr_b16 v[72:73], v237 offset:256
    ds_read_b64_tr_b16 v[74:75], v237 offset:264
    s_waitcnt vmcnt(16)
    ds_read_b64_tr_b16 v[216:217], v2 offset:10240
    ds_read_b64_tr_b16 v[218:219], v2 offset:10248
    ds_read_b64_tr_b16 v[220:221], v2 offset:11264
    ds_read_b64_tr_b16 v[222:223], v2 offset:11272
    ds_read_b64_tr_b16 v[76:77], v237 offset:512
    ds_read_b64_tr_b16 v[78:79], v237 offset:520
    ds_read_b64_tr_b16 v[80:81], v237 offset:768
    ds_read_b64_tr_b16 v[82:83], v237 offset:776
    s_waitcnt lgkmcnt(14)
    v_mfma_f32_16x16x32_bf16 v[84:87], v[208:211], v[178:181], 0
    s_waitcnt lgkmcnt(12)
    v_mfma_f32_16x16x32_bf16 v[92:95], v[212:215], v[184:187], 0
    s_waitcnt lgkmcnt(10)
    v_xor_b32 v70, 0x80008000, v70
    v_cndmask_b32 v52, v208, v70, s[92:93]
    v_cndmask_b32 v54, v210, v68, s[92:93]
    v_xor_b32 v71, 0x80008000, v71
    v_cndmask_b32 v53, v209, v71, s[92:93]
    v_cndmask_b32 v55, v211, v69, s[92:93]
    s_waitcnt lgkmcnt(8)
    v_xor_b32 v74, 0x80008000, v74
    v_cndmask_b32 v56, v212, v74, s[92:93]
    v_cndmask_b32 v58, v214, v72, s[92:93]
    v_xor_b32 v75, 0x80008000, v75
    v_cndmask_b32 v57, v213, v75, s[92:93]
    v_cndmask_b32 v59, v215, v73, s[92:93]
    v_mfma_f32_16x16x32_bf16 v[88:91], v[52:55], v[176:179], 0
    s_nop 0
    v_mfma_f32_16x16x32_bf16 v[96:99], v[56:59], v[182:185], 0
    s_waitcnt vmcnt(14)
    ds_read_b64_tr_b16 v[208:209], v2 offset:2048
    ds_read_b64_tr_b16 v[210:211], v2 offset:2056
    ds_read_b64_tr_b16 v[212:213], v2 offset:3072
    ds_read_b64_tr_b16 v[214:215], v2 offset:3080
    s_waitcnt lgkmcnt(10)
    v_mfma_f32_16x16x32_bf16 v[100:103], v[216:219], v[190:193], 0
    s_waitcnt lgkmcnt(8)
    v_mfma_f32_16x16x32_bf16 v[108:111], v[220:223], v[196:199], 0
    s_waitcnt lgkmcnt(6)
    v_xor_b32 v78, 0x80008000, v78
    v_cndmask_b32 v60, v216, v78, s[92:93]
    v_cndmask_b32 v62, v218, v76, s[92:93]
    v_xor_b32 v79, 0x80008000, v79
    v_cndmask_b32 v61, v217, v79, s[92:93]
    v_cndmask_b32 v63, v219, v77, s[92:93]
    s_waitcnt lgkmcnt(4)
    v_xor_b32 v82, 0x80008000, v82
    v_cndmask_b32 v64, v220, v82, s[92:93]
    v_cndmask_b32 v66, v222, v80, s[92:93]
    v_xor_b32 v83, 0x80008000, v83
    v_cndmask_b32 v65, v221, v83, s[92:93]
    v_cndmask_b32 v67, v223, v81, s[92:93]
    v_mfma_f32_16x16x32_bf16 v[104:107], v[60:63], v[188:191], 0
    s_nop 0
    v_mfma_f32_16x16x32_bf16 v[112:115], v[64:67], v[194:197], 0
    s_waitcnt vmcnt(12)
    ds_read_b64_tr_b16 v[216:217], v2 offset:12288
    ds_read_b64_tr_b16 v[218:219], v2 offset:12296
    ds_read_b64_tr_b16 v[220:221], v2 offset:13312
    ds_read_b64_tr_b16 v[222:223], v2 offset:13320
    v_pk_add_f32 v[224:225], v[84:85], v[92:93]
    v_pk_add_f32 v[92:93], v[84:85], v[92:93] neg_lo:[0,1] neg_hi:[0,1]
    v_pk_add_f32 v[226:227], v[88:89], v[96:97]
    v_pk_add_f32 v[96:97], v[88:89], v[96:97] neg_lo:[0,1] neg_hi:[0,1]
    v_pk_add_f32 v[228:229], v[86:87], v[94:95]
    v_pk_add_f32 v[94:95], v[86:87], v[94:95] neg_lo:[0,1] neg_hi:[0,1]
    v_pk_add_f32 v[230:231], v[90:91], v[98:99]
    v_pk_add_f32 v[98:99], v[90:91], v[98:99] neg_lo:[0,1] neg_hi:[0,1]
    v_cvt_pk_bf16_f32 v4, v224, v226
    v_cvt_pk_bf16_f32 v8, v92, v96
    v_cvt_pk_bf16_f32 v5, v225, v227
    v_cvt_pk_bf16_f32 v9, v93, v97
    v_cvt_pk_bf16_f32 v6, v228, v230
    v_cvt_pk_bf16_f32 v10, v94, v98
    v_cvt_pk_bf16_f32 v7, v229, v231
    v_cvt_pk_bf16_f32 v11, v95, v99
    s_waitcnt lgkmcnt(6)
    v_mfma_f32_16x16x32_bf16 v[84:87], v[208:211], v[178:181], 0
    s_waitcnt lgkmcnt(4)
    v_mfma_f32_16x16x32_bf16 v[92:95], v[212:215], v[184:187], 0
    v_mfma_f32_16x16x32_bf16 v[88:91], v[208:211], v[176:179], 0
    v_mfma_f32_16x16x32_bf16 v[96:99], v[212:215], v[182:185], 0
    s_waitcnt vmcnt(10)
    ds_read_b64_tr_b16 v[208:209], v2 offset:4096
    ds_read_b64_tr_b16 v[210:211], v2 offset:4104
    ds_read_b64_tr_b16 v[212:213], v2 offset:5120
    ds_read_b64_tr_b16 v[214:215], v2 offset:5128
    v_pk_add_f32 v[224:225], v[100:101], v[108:109]
    v_pk_add_f32 v[108:109], v[100:101], v[108:109] neg_lo:[0,1] neg_hi:[0,1]
    v_pk_add_f32 v[226:227], v[104:105], v[112:113]
    v_pk_add_f32 v[112:113], v[104:105], v[112:113] neg_lo:[0,1] neg_hi:[0,1]
    v_pk_add_f32 v[228:229], v[102:103], v[110:111]
    v_pk_add_f32 v[110:111], v[102:103], v[110:111] neg_lo:[0,1] neg_hi:[0,1]
    v_pk_add_f32 v[230:231], v[106:107], v[114:115]
    v_pk_add_f32 v[114:115], v[106:107], v[114:115] neg_lo:[0,1] neg_hi:[0,1]
    v_cvt_pk_bf16_f32 v12, v224, v226
    v_cvt_pk_bf16_f32 v16, v108, v112
    v_cvt_pk_bf16_f32 v13, v225, v227
    v_cvt_pk_bf16_f32 v17, v109, v113
    v_cvt_pk_bf16_f32 v14, v228, v230
    v_cvt_pk_bf16_f32 v18, v110, v114
    v_cvt_pk_bf16_f32 v15, v229, v231
    v_cvt_pk_bf16_f32 v19, v111, v115
    s_waitcnt lgkmcnt(6)
    v_mfma_f32_16x16x32_bf16 v[100:103], v[216:219], v[190:193], 0
    s_waitcnt lgkmcnt(4)
    v_mfma_f32_16x16x32_bf16 v[108:111], v[220:223], v[196:199], 0
    v_mfma_f32_16x16x32_bf16 v[104:107], v[216:219], v[188:191], 0
    v_mfma_f32_16x16x32_bf16 v[112:115], v[220:223], v[194:197], 0
    s_waitcnt vmcnt(8)
    ds_read_b64_tr_b16 v[216:217], v2 offset:14336
    ds_read_b64_tr_b16 v[218:219], v2 offset:14344
    ds_read_b64_tr_b16 v[220:221], v2 offset:15360
    ds_read_b64_tr_b16 v[222:223], v2 offset:15368
    v_pk_add_f32 v[224:225], v[84:85], v[92:93]
    v_pk_add_f32 v[92:93], v[84:85], v[92:93] neg_lo:[0,1] neg_hi:[0,1]
    v_pk_add_f32 v[226:227], v[88:89], v[96:97]
    v_pk_add_f32 v[96:97], v[88:89], v[96:97] neg_lo:[0,1] neg_hi:[0,1]
    v_pk_add_f32 v[228:229], v[86:87], v[94:95]
    v_pk_add_f32 v[94:95], v[86:87], v[94:95] neg_lo:[0,1] neg_hi:[0,1]
    v_pk_add_f32 v[230:231], v[90:91], v[98:99]
    v_pk_add_f32 v[98:99], v[90:91], v[98:99] neg_lo:[0,1] neg_hi:[0,1]
    v_cvt_pk_bf16_f32 v20, v224, v226
    v_cvt_pk_bf16_f32 v24, v92, v96
    v_cvt_pk_bf16_f32 v21, v225, v227
    v_cvt_pk_bf16_f32 v25, v93, v97
    v_cvt_pk_bf16_f32 v22, v228, v230
    v_cvt_pk_bf16_f32 v26, v94, v98
    v_cvt_pk_bf16_f32 v23, v229, v231
    v_cvt_pk_bf16_f32 v27, v95, v99
    s_waitcnt lgkmcnt(6)
    v_mfma_f32_16x16x32_bf16 v[84:87], v[208:211], v[178:181], 0
    s_waitcnt lgkmcnt(4)
    v_mfma_f32_16x16x32_bf16 v[92:95], v[212:215], v[184:187], 0
    v_mfma_f32_16x16x32_bf16 v[88:91], v[208:211], v[176:179], 0
    v_mfma_f32_16x16x32_bf16 v[96:99], v[212:215], v[182:185], 0
    s_waitcnt vmcnt(6)
    ds_read_b64_tr_b16 v[208:209], v2 offset:6144
    ds_read_b64_tr_b16 v[210:211], v2 offset:6152
    ds_read_b64_tr_b16 v[212:213], v2 offset:7168
    ds_read_b64_tr_b16 v[214:215], v2 offset:7176
    v_pk_add_f32 v[224:225], v[100:101], v[108:109]
    v_pk_add_f32 v[108:109], v[100:101], v[108:109] neg_lo:[0,1] neg_hi:[0,1]
    v_pk_add_f32 v[226:227], v[104:105], v[112:113]
    v_pk_add_f32 v[112:113], v[104:105], v[112:113] neg_lo:[0,1] neg_hi:[0,1]
    v_pk_add_f32 v[228:229], v[102:103], v[110:111]
    v_pk_add_f32 v[110:111], v[102:103], v[110:111] neg_lo:[0,1] neg_hi:[0,1]
    v_pk_add_f32 v[230:231], v[106:107], v[114:115]
    v_pk_add_f32 v[114:115], v[106:107], v[114:115] neg_lo:[0,1] neg_hi:[0,1]
    v_cvt_pk_bf16_f32 v28, v224, v226
    v_cvt_pk_bf16_f32 v32, v108, v112
    v_cvt_pk_bf16_f32 v29, v225, v227
    v_cvt_pk_bf16_f32 v33, v109, v113
    v_cvt_pk_bf16_f32 v30, v228, v230
    v_cvt_pk_bf16_f32 v34, v110, v114
    v_cvt_pk_bf16_f32 v31, v229, v231
    v_cvt_pk_bf16_f32 v35, v111, v115
    s_waitcnt lgkmcnt(6)
    v_mfma_f32_16x16x32_bf16 v[100:103], v[216:219], v[190:193], 0
    s_waitcnt lgkmcnt(4)
    v_mfma_f32_16x16x32_bf16 v[108:111], v[220:223], v[196:199], 0
    v_mfma_f32_16x16x32_bf16 v[104:107], v[216:219], v[188:191], 0
    v_mfma_f32_16x16x32_bf16 v[112:115], v[220:223], v[194:197], 0
    s_waitcnt vmcnt(4)
    ds_read_b64_tr_b16 v[216:217], v2 offset:16384
    ds_read_b64_tr_b16 v[218:219], v2 offset:16392
    ds_read_b64_tr_b16 v[220:221], v2 offset:17408
    ds_read_b64_tr_b16 v[222:223], v2 offset:17416
    v_pk_add_f32 v[224:225], v[84:85], v[92:93]
    v_pk_add_f32 v[92:93], v[84:85], v[92:93] neg_lo:[0,1] neg_hi:[0,1]
    v_pk_add_f32 v[226:227], v[88:89], v[96:97]
    v_pk_add_f32 v[96:97], v[88:89], v[96:97] neg_lo:[0,1] neg_hi:[0,1]
    v_pk_add_f32 v[228:229], v[86:87], v[94:95]
    v_pk_add_f32 v[94:95], v[86:87], v[94:95] neg_lo:[0,1] neg_hi:[0,1]
    v_pk_add_f32 v[230:231], v[90:91], v[98:99]
    v_pk_add_f32 v[98:99], v[90:91], v[98:99] neg_lo:[0,1] neg_hi:[0,1]
    v_cvt_pk_bf16_f32 v36, v224, v226
    v_cvt_pk_bf16_f32 v40, v92, v96
    v_cvt_pk_bf16_f32 v37, v225, v227
    v_cvt_pk_bf16_f32 v41, v93, v97
    v_cvt_pk_bf16_f32 v38, v228, v230
    v_cvt_pk_bf16_f32 v42, v94, v98
    v_cvt_pk_bf16_f32 v39, v229, v231
    v_cvt_pk_bf16_f32 v43, v95, v99
    s_waitcnt lgkmcnt(6)
    v_mfma_f32_16x16x32_bf16 v[84:87], v[208:211], v[178:181], 0
    s_waitcnt lgkmcnt(4)
    v_mfma_f32_16x16x32_bf16 v[92:95], v[212:215], v[184:187], 0
    v_mfma_f32_16x16x32_bf16 v[88:91], v[208:211], v[176:179], 0
    v_mfma_f32_16x16x32_bf16 v[96:99], v[212:215], v[182:185], 0
    s_waitcnt vmcnt(2)
    ds_read_b64_tr_b16 v[208:209], v2 offset:8192
    ds_read_b64_tr_b16 v[210:211], v2 offset:8200
    ds_read_b64_tr_b16 v[212:213], v2 offset:9216
    ds_read_b64_tr_b16 v[214:215], v2 offset:9224
    v_pk_add_f32 v[224:225], v[100:101], v[108:109]
    v_pk_add_f32 v[108:109], v[100:101], v[108:109] neg_lo:[0,1] neg_hi:[0,1]
    v_pk_add_f32 v[226:227], v[104:105], v[112:113]
    v_pk_add_f32 v[112:113], v[104:105], v[112:113] neg_lo:[0,1] neg_hi:[0,1]
    v_pk_add_f32 v[228:229], v[102:103], v[110:111]
    v_pk_add_f32 v[110:111], v[102:103], v[110:111] neg_lo:[0,1] neg_hi:[0,1]
    v_pk_add_f32 v[230:231], v[106:107], v[114:115]
    v_pk_add_f32 v[114:115], v[106:107], v[114:115] neg_lo:[0,1] neg_hi:[0,1]
    v_cvt_pk_bf16_f32 v44, v224, v226
    v_cvt_pk_bf16_f32 v48, v108, v112
    v_cvt_pk_bf16_f32 v45, v225, v227
    v_cvt_pk_bf16_f32 v49, v109, v113
    v_cvt_pk_bf16_f32 v46, v228, v230
    v_cvt_pk_bf16_f32 v50, v110, v114
    v_cvt_pk_bf16_f32 v47, v229, v231
    v_cvt_pk_bf16_f32 v51, v111, v115
    s_waitcnt lgkmcnt(6)
    v_mfma_f32_16x16x32_bf16 v[100:103], v[216:219], v[190:193], 0
    s_waitcnt lgkmcnt(4)
    v_mfma_f32_16x16x32_bf16 v[108:111], v[220:223], v[196:199], 0
    v_mfma_f32_16x16x32_bf16 v[104:107], v[216:219], v[188:191], 0
    v_mfma_f32_16x16x32_bf16 v[112:115], v[220:223], v[194:197], 0
    s_waitcnt vmcnt(0)
    ds_read_b64_tr_b16 v[216:217], v2 offset:18432
    ds_read_b64_tr_b16 v[218:219], v2 offset:18440
    ds_read_b64_tr_b16 v[220:221], v2 offset:19456
    ds_read_b64_tr_b16 v[222:223], v2 offset:19464
    v_pk_add_f32 v[224:225], v[84:85], v[92:93]
    v_pk_add_f32 v[92:93], v[84:85], v[92:93] neg_lo:[0,1] neg_hi:[0,1]
    v_pk_add_f32 v[226:227], v[88:89], v[96:97]
    v_pk_add_f32 v[96:97], v[88:89], v[96:97] neg_lo:[0,1] neg_hi:[0,1]
    v_pk_add_f32 v[228:229], v[86:87], v[94:95]
    v_pk_add_f32 v[94:95], v[86:87], v[94:95] neg_lo:[0,1] neg_hi:[0,1]
    v_pk_add_f32 v[230:231], v[90:91], v[98:99]
    v_pk_add_f32 v[98:99], v[90:91], v[98:99] neg_lo:[0,1] neg_hi:[0,1]
    v_cvt_pk_bf16_f32 v52, v224, v226
    v_cvt_pk_bf16_f32 v56, v92, v96
    v_cvt_pk_bf16_f32 v53, v225, v227
    v_cvt_pk_bf16_f32 v57, v93, v97
    v_cvt_pk_bf16_f32 v54, v228, v230
    v_cvt_pk_bf16_f32 v58, v94, v98
    v_cvt_pk_bf16_f32 v55, v229, v231
    v_cvt_pk_bf16_f32 v59, v95, v99
    s_waitcnt lgkmcnt(6)
    v_mfma_f32_16x16x32_bf16 v[84:87], v[208:211], v[178:181], 0
    s_waitcnt lgkmcnt(4)
    v_mfma_f32_16x16x32_bf16 v[92:95], v[212:215], v[184:187], 0
    v_mfma_f32_16x16x32_bf16 v[88:91], v[208:211], v[176:179], 0
    v_mfma_f32_16x16x32_bf16 v[96:99], v[212:215], v[182:185], 0
    v_pk_add_f32 v[224:225], v[100:101], v[108:109]
    v_pk_add_f32 v[108:109], v[100:101], v[108:109] neg_lo:[0,1] neg_hi:[0,1]
    v_pk_add_f32 v[226:227], v[104:105], v[112:113]
    v_pk_add_f32 v[112:113], v[104:105], v[112:113] neg_lo:[0,1] neg_hi:[0,1]
    v_pk_add_f32 v[228:229], v[102:103], v[110:111]
    v_pk_add_f32 v[110:111], v[102:103], v[110:111] neg_lo:[0,1] neg_hi:[0,1]
    v_pk_add_f32 v[230:231], v[106:107], v[114:115]
    v_pk_add_f32 v[114:115], v[106:107], v[114:115] neg_lo:[0,1] neg_hi:[0,1]
    v_cvt_pk_bf16_f32 v60, v224, v226
    v_cvt_pk_bf16_f32 v64, v108, v112
    v_cvt_pk_bf16_f32 v61, v225, v227
    v_cvt_pk_bf16_f32 v65, v109, v113
    v_cvt_pk_bf16_f32 v62, v228, v230
    v_cvt_pk_bf16_f32 v66, v110, v114
    v_cvt_pk_bf16_f32 v63, v229, v231
    v_cvt_pk_bf16_f32 v67, v111, v115
    s_waitcnt lgkmcnt(2)
    v_mfma_f32_16x16x32_bf16 v[100:103], v[216:219], v[190:193], 0
    s_waitcnt lgkmcnt(0)
    v_mfma_f32_16x16x32_bf16 v[108:111], v[220:223], v[196:199], 0
    v_mfma_f32_16x16x32_bf16 v[104:107], v[216:219], v[188:191], 0
    v_mfma_f32_16x16x32_bf16 v[112:115], v[220:223], v[194:197], 0
    v_pk_add_f32 v[224:225], v[84:85], v[92:93]
    v_pk_add_f32 v[92:93], v[84:85], v[92:93] neg_lo:[0,1] neg_hi:[0,1]
    v_pk_add_f32 v[226:227], v[88:89], v[96:97]
    v_pk_add_f32 v[96:97], v[88:89], v[96:97] neg_lo:[0,1] neg_hi:[0,1]
    v_pk_add_f32 v[228:229], v[86:87], v[94:95]
    v_pk_add_f32 v[94:95], v[86:87], v[94:95] neg_lo:[0,1] neg_hi:[0,1]
    v_pk_add_f32 v[230:231], v[90:91], v[98:99]
    v_pk_add_f32 v[98:99], v[90:91], v[98:99] neg_lo:[0,1] neg_hi:[0,1]
    v_cvt_pk_bf16_f32 v68, v224, v226
    v_cvt_pk_bf16_f32 v72, v92, v96
    v_cvt_pk_bf16_f32 v69, v225, v227
    v_cvt_pk_bf16_f32 v73, v93, v97
    v_cvt_pk_bf16_f32 v70, v228, v230
    v_cvt_pk_bf16_f32 v74, v94, v98
    v_cvt_pk_bf16_f32 v71, v229, v231
    v_cvt_pk_bf16_f32 v75, v95, v99
    v_pk_add_f32 v[224:225], v[100:101], v[108:109]
    v_pk_add_f32 v[108:109], v[100:101], v[108:109] neg_lo:[0,1] neg_hi:[0,1]
    v_pk_add_f32 v[226:227], v[104:105], v[112:113]
    v_pk_add_f32 v[112:113], v[104:105], v[112:113] neg_lo:[0,1] neg_hi:[0,1]
    v_pk_add_f32 v[228:229], v[102:103], v[110:111]
    v_pk_add_f32 v[110:111], v[102:103], v[110:111] neg_lo:[0,1] neg_hi:[0,1]
    v_pk_add_f32 v[230:231], v[106:107], v[114:115]
    v_pk_add_f32 v[114:115], v[106:107], v[114:115] neg_lo:[0,1] neg_hi:[0,1]
    v_cvt_pk_bf16_f32 v76, v224, v226
    v_cvt_pk_bf16_f32 v80, v108, v112
    v_cvt_pk_bf16_f32 v77, v225, v227
    v_cvt_pk_bf16_f32 v81, v109, v113
    v_cvt_pk_bf16_f32 v78, v228, v230
    v_cvt_pk_bf16_f32 v82, v110, v114
    v_cvt_pk_bf16_f32 v79, v229, v231
    v_cvt_pk_bf16_f32 v83, v111, v115
    v_mfma_f32_16x16x32_bf16 v[84:87], v[116:119], v[4:7], 0
    v_mfma_f32_16x16x32_bf16 v[88:91], v[116:119], v[8:11], 0
    v_mfma_f32_16x16x32_bf16 v[92:95], v[116:119], v[12:15], 0
    v_mfma_f32_16x16x32_bf16 v[96:99], v[116:119], v[16:19], 0
    v_mfma_f32_16x16x32_bf16 v[84:87], v[120:123], v[20:23], v[84:87]
    v_mfma_f32_16x16x32_bf16 v[88:91], v[120:123], v[24:27], v[88:91]
    v_mfma_f32_16x16x32_bf16 v[92:95], v[120:123], v[28:31], v[92:95]
    v_mfma_f32_16x16x32_bf16 v[96:99], v[120:123], v[32:35], v[96:99]
    ds_read_b128 v[176:179], v238 offset:0
    ds_read_b128 v[180:183], v238 offset:1024
    ds_read_b128 v[184:187], v238 offset:2048
    ds_read_b128 v[188:191], v238 offset:3072
    v_mfma_f32_16x16x32_bf16 v[84:87], v[124:127], v[36:39], v[84:87]
    v_mfma_f32_16x16x32_bf16 v[88:91], v[124:127], v[40:43], v[88:91]
    v_mfma_f32_16x16x32_bf16 v[92:95], v[124:127], v[44:47], v[92:95]
    v_mfma_f32_16x16x32_bf16 v[96:99], v[124:127], v[48:51], v[96:99]
    v_mfma_f32_16x16x32_bf16 v[84:87], v[128:131], v[52:55], v[84:87]
    v_mfma_f32_16x16x32_bf16 v[88:91], v[128:131], v[56:59], v[88:91]
    v_mfma_f32_16x16x32_bf16 v[92:95], v[128:131], v[60:63], v[92:95]
    v_mfma_f32_16x16x32_bf16 v[96:99], v[128:131], v[64:67], v[96:99]
    v_mfma_f32_16x16x32_bf16 v[84:87], v[132:135], v[68:71], v[84:87]
    v_mfma_f32_16x16x32_bf16 v[88:91], v[132:135], v[72:75], v[88:91]
    v_mfma_f32_16x16x32_bf16 v[92:95], v[132:135], v[76:79], v[92:95]
    v_mfma_f32_16x16x32_bf16 v[96:99], v[132:135], v[80:83], v[96:99]
    v_mfma_f32_16x16x32_bf16 v[100:103], v[136:139], v[4:7], 0
    v_mfma_f32_16x16x32_bf16 v[104:107], v[136:139], v[8:11], 0
    v_mfma_f32_16x16x32_bf16 v[108:111], v[136:139], v[12:15], 0
    v_mfma_f32_16x16x32_bf16 v[112:115], v[136:139], v[16:19], 0
    v_mfma_f32_16x16x32_bf16 v[100:103], v[140:143], v[20:23], v[100:103]
    v_mfma_f32_16x16x32_bf16 v[104:107], v[140:143], v[24:27], v[104:107]
    v_mfma_f32_16x16x32_bf16 v[108:111], v[140:143], v[28:31], v[108:111]
    v_mfma_f32_16x16x32_bf16 v[112:115], v[140:143], v[32:35], v[112:115]
    v_pk_mul_f32 v[84:85], v[84:85], v[232:233] op_sel:[0,0] op_sel_hi:[1,0]
    v_pk_mul_f32 v[86:87], v[86:87], v[232:233] op_sel:[0,0] op_sel_hi:[1,0]
    v_pk_mul_f32 v[88:89], v[88:89], v[232:233] op_sel:[0,1] op_sel_hi:[1,1]
    v_pk_mul_f32 v[90:91], v[90:91], v[232:233] op_sel:[0,1] op_sel_hi:[1,1]
    v_pk_mul_f32 v[92:93], v[92:93], v[234:235] op_sel:[0,0] op_sel_hi:[1,0]
    v_pk_mul_f32 v[94:95], v[94:95], v[234:235] op_sel:[0,0] op_sel_hi:[1,0]
    v_pk_mul_f32 v[96:97], v[96:97], v[234:235] op_sel:[0,1] op_sel_hi:[1,1]
    v_pk_mul_f32 v[98:99], v[98:99], v[234:235] op_sel:[0,1] op_sel_hi:[1,1]
    v_cvt_pk_bf16_f32 v84, v84, v85
    v_cvt_pk_bf16_f32 v85, v86, v87
    ds_write_b64 v3, v[84:85] offset:0
    v_xor_b32 v86, s96, v84
    v_xor_b32 v87, s96, v85
    ds_write_b64 v3, v[86:87] offset:80
    v_cvt_pk_bf16_f32 v88, v88, v89
    v_cvt_pk_bf16_f32 v89, v90, v91
    ds_write_b64 v3, v[88:89] offset:2560
    v_xor_b32 v90, s96, v88
    v_xor_b32 v91, s96, v89
    ds_write_b64 v3, v[90:91] offset:2640
    v_cvt_pk_bf16_f32 v92, v92, v93
    v_cvt_pk_bf16_f32 v93, v94, v95
    ds_write_b64 v3, v[92:93] offset:5120
    v_xor_b32 v94, s96, v92
    v_xor_b32 v95, s96, v93
    ds_write_b64 v3, v[94:95] offset:5200
    v_cvt_pk_bf16_f32 v96, v96, v97
    v_cvt_pk_bf16_f32 v97, v98, v99
    ds_write_b64 v3, v[96:97] offset:7680
    v_xor_b32 v98, s96, v96
    v_xor_b32 v99, s96, v97
    ds_write_b64 v3, v[98:99] offset:7760
    v_mfma_f32_16x16x32_bf16 v[100:103], v[144:147], v[36:39], v[100:103]
    v_mfma_f32_16x16x32_bf16 v[104:107], v[144:147], v[40:43], v[104:107]
    v_mfma_f32_16x16x32_bf16 v[108:111], v[144:147], v[44:47], v[108:111]
    v_mfma_f32_16x16x32_bf16 v[112:115], v[144:147], v[48:51], v[112:115]
    v_mfma_f32_16x16x32_bf16 v[100:103], v[148:151], v[52:55], v[100:103]
    v_mfma_f32_16x16x32_bf16 v[104:107], v[148:151], v[56:59], v[104:107]
    v_mfma_f32_16x16x32_bf16 v[108:111], v[148:151], v[60:63], v[108:111]
    v_mfma_f32_16x16x32_bf16 v[112:115], v[148:151], v[64:67], v[112:115]
    v_mfma_f32_16x16x32_bf16 v[100:103], v[152:155], v[68:71], v[100:103]
    v_mfma_f32_16x16x32_bf16 v[104:107], v[152:155], v[72:75], v[104:107]
    v_mfma_f32_16x16x32_bf16 v[108:111], v[152:155], v[76:79], v[108:111]
    v_mfma_f32_16x16x32_bf16 v[112:115], v[152:155], v[80:83], v[112:115]
    v_mfma_f32_16x16x32_bf16 v[84:87], v[156:159], v[4:7], 0
    v_mfma_f32_16x16x32_bf16 v[88:91], v[156:159], v[8:11], 0
    v_mfma_f32_16x16x32_bf16 v[92:95], v[156:159], v[12:15], 0
    v_mfma_f32_16x16x32_bf16 v[96:99], v[156:159], v[16:19], 0
    v_mfma_f32_16x16x32_bf16 v[84:87], v[160:163], v[20:23], v[84:87]
    v_mfma_f32_16x16x32_bf16 v[88:91], v[160:163], v[24:27], v[88:91]
    v_mfma_f32_16x16x32_bf16 v[92:95], v[160:163], v[28:31], v[92:95]
    v_mfma_f32_16x16x32_bf16 v[96:99], v[160:163], v[32:35], v[96:99]
    v_pk_mul_f32 v[100:101], v[100:101], v[232:233] op_sel:[0,0] op_sel_hi:[1,0]
    v_pk_mul_f32 v[102:103], v[102:103], v[232:233] op_sel:[0,0] op_sel_hi:[1,0]
    v_pk_mul_f32 v[104:105], v[104:105], v[232:233] op_sel:[0,1] op_sel_hi:[1,1]
    v_pk_mul_f32 v[106:107], v[106:107], v[232:233] op_sel:[0,1] op_sel_hi:[1,1]
    v_pk_mul_f32 v[108:109], v[108:109], v[234:235] op_sel:[0,0] op_sel_hi:[1,0]
    v_pk_mul_f32 v[110:111], v[110:111], v[234:235] op_sel:[0,0] op_sel_hi:[1,0]
    v_pk_mul_f32 v[112:113], v[112:113], v[234:235] op_sel:[0,1] op_sel_hi:[1,1]
    v_pk_mul_f32 v[114:115], v[114:115], v[234:235] op_sel:[0,1] op_sel_hi:[1,1]
    v_cvt_pk_bf16_f32 v100, v100, v101
    v_cvt_pk_bf16_f32 v101, v102, v103
    ds_write_b64 v3, v[100:101] offset:32
    v_xor_b32 v102, s96, v100
    v_xor_b32 v103, s96, v101
    ds_write_b64 v3, v[102:103] offset:112
    v_cvt_pk_bf16_f32 v104, v104, v105
    v_cvt_pk_bf16_f32 v105, v106, v107
    ds_write_b64 v3, v[104:105] offset:2592
    v_xor_b32 v106, s96, v104
    v_xor_b32 v107, s96, v105
    ds_write_b64 v3, v[106:107] offset:2672
    v_cvt_pk_bf16_f32 v108, v108, v109
    v_cvt_pk_bf16_f32 v109, v110, v111
    ds_write_b64 v3, v[108:109] offset:5152
    v_xor_b32 v110, s96, v108
    v_xor_b32 v111, s96, v109
    ds_write_b64 v3, v[110:111] offset:5232
    v_cvt_pk_bf16_f32 v112, v112, v113
    v_cvt_pk_bf16_f32 v113, v114, v115
    ds_write_b64 v3, v[112:113] offset:7712
    v_xor_b32 v114, s96, v112
    v_xor_b32 v115, s96, v113
    ds_write_b64 v3, v[114:115] offset:7792
    v_mfma_f32_16x16x32_bf16 v[84:87], v[164:167], v[36:39], v[84:87]
    v_mfma_f32_16x16x32_bf16 v[88:91], v[164:167], v[40:43], v[88:91]
    v_mfma_f32_16x16x32_bf16 v[92:95], v[164:167], v[44:47], v[92:95]
    v_mfma_f32_16x16x32_bf16 v[96:99], v[164:167], v[48:51], v[96:99]
    v_mfma_f32_16x16x32_bf16 v[84:87], v[168:171], v[52:55], v[84:87]
    v_mfma_f32_16x16x32_bf16 v[88:91], v[168:171], v[56:59], v[88:91]
    v_mfma_f32_16x16x32_bf16 v[92:95], v[168:171], v[60:63], v[92:95]
    v_mfma_f32_16x16x32_bf16 v[96:99], v[168:171], v[64:67], v[96:99]
    v_mfma_f32_16x16x32_bf16 v[84:87], v[172:175], v[68:71], v[84:87]
    v_mfma_f32_16x16x32_bf16 v[88:91], v[172:175], v[72:75], v[88:91]
    v_mfma_f32_16x16x32_bf16 v[92:95], v[172:175], v[76:79], v[92:95]
    v_mfma_f32_16x16x32_bf16 v[96:99], v[172:175], v[80:83], v[96:99]
    s_mov_b32 exec_hi, 0
    s_nop 3
    v_pk_mul_f32 v[84:85], v[84:85], v[232:233] op_sel:[0,0] op_sel_hi:[1,0]
    v_pk_mul_f32 v[86:87], v[86:87], v[232:233] op_sel:[0,0] op_sel_hi:[1,0]
    v_pk_mul_f32 v[88:89], v[88:89], v[232:233] op_sel:[0,1] op_sel_hi:[1,1]
    v_pk_mul_f32 v[90:91], v[90:91], v[232:233] op_sel:[0,1] op_sel_hi:[1,1]
    v_pk_mul_f32 v[92:93], v[92:93], v[234:235] op_sel:[0,0] op_sel_hi:[1,0]
    v_pk_mul_f32 v[94:95], v[94:95], v[234:235] op_sel:[0,0] op_sel_hi:[1,0]
    v_pk_mul_f32 v[96:97], v[96:97], v[234:235] op_sel:[0,1] op_sel_hi:[1,1]
    v_pk_mul_f32 v[98:99], v[98:99], v[234:235] op_sel:[0,1] op_sel_hi:[1,1]
    v_cvt_pk_bf16_f32 v84, v84, v85
    v_cvt_pk_bf16_f32 v85, v86, v87
    ds_write_b64 v3, v[84:85] offset:64
    v_xor_b32 v86, s96, v84
    v_xor_b32 v87, s96, v85
    ds_write_b64 v3, v[86:87] offset:144
    v_cvt_pk_bf16_f32 v88, v88, v89
    v_cvt_pk_bf16_f32 v89, v90, v91
    ds_write_b64 v3, v[88:89] offset:2624
    v_xor_b32 v90, s96, v88
    v_xor_b32 v91, s96, v89
    ds_write_b64 v3, v[90:91] offset:2704
    v_cvt_pk_bf16_f32 v92, v92, v93
    v_cvt_pk_bf16_f32 v93, v94, v95
    ds_write_b64 v3, v[92:93] offset:5184
    v_xor_b32 v94, s96, v92
    v_xor_b32 v95, s96, v93
    ds_write_b64 v3, v[94:95] offset:5264
    v_cvt_pk_bf16_f32 v96, v96, v97
    v_cvt_pk_bf16_f32 v97, v98, v99
    ds_write_b64 v3, v[96:97] offset:7744
    v_xor_b32 v98, s96, v96
    v_xor_b32 v99, s96, v97
    ds_write_b64 v3, v[98:99] offset:7824
    s_mov_b64 exec, -1
    s_waitcnt lgkmcnt(0)
    s_barrier
    ds_read2st64_b64 v[4:7], v200 offset0:0 offset1:156
    ds_read2st64_b64 v[8:11], v201 offset0:0 offset1:156
    ds_read2st64_b64 v[12:15], v202 offset0:0 offset1:156
    ds_read2st64_b64 v[16:19], v203 offset0:0 offset1:156
    ds_read2st64_b64 v[20:23], v200 offset0:4 offset1:160
    ds_read2st64_b64 v[24:27], v201 offset0:4 offset1:160
    ds_read2st64_b64 v[28:31], v202 offset0:4 offset1:160
    ds_read2st64_b64 v[32:35], v203 offset0:4 offset1:160
    ds_read2st64_b64 v[36:39], v200 offset0:8 offset1:164
    ds_read2st64_b64 v[40:43], v201 offset0:8 offset1:164
    ds_read2st64_b64 v[44:47], v202 offset0:8 offset1:164
    ds_read2st64_b64 v[48:51], v203 offset0:8 offset1:164
    s_waitcnt lgkmcnt(11)
    v_mfma_f32_16x16x32_bf16 v[84:87], v[176:179], v[4:7], 0
    s_waitcnt lgkmcnt(10)
    v_mfma_f32_16x16x32_bf16 v[84:87], v[180:183], v[8:11], v[84:87]
    s_waitcnt lgkmcnt(9)
    v_mfma_f32_16x16x32_bf16 v[84:87], v[184:187], v[12:15], v[84:87]
    s_waitcnt lgkmcnt(8)
    v_mfma_f32_16x16x32_bf16 v[84:87], v[188:191], v[16:19], v[84:87]
    s_waitcnt lgkmcnt(7)
    v_mfma_f32_16x16x32_bf16 v[88:91], v[176:179], v[20:23], 0
    s_waitcnt lgkmcnt(6)
    v_mfma_f32_16x16x32_bf16 v[88:91], v[180:183], v[24:27], v[88:91]
    s_waitcnt lgkmcnt(5)
    v_mfma_f32_16x16x32_bf16 v[88:91], v[184:187], v[28:31], v[88:91]
    s_waitcnt lgkmcnt(4)
    v_mfma_f32_16x16x32_bf16 v[88:91], v[188:191], v[32:35], v[88:91]
    s_waitcnt lgkmcnt(3)
    v_mfma_f32_16x16x32_bf16 v[92:95], v[176:179], v[36:39], 0
    s_waitcnt lgkmcnt(2)
    v_mfma_f32_16x16x32_bf16 v[92:95], v[180:183], v[40:43], v[92:95]
    s_waitcnt lgkmcnt(1)
    v_mfma_f32_16x16x32_bf16 v[92:95], v[184:187], v[44:47], v[92:95]
    s_waitcnt lgkmcnt(0)
    v_mfma_f32_16x16x32_bf16 v[92:95], v[188:191], v[48:51], v[92:95]
    v_cvt_pk_bf16_f32 v84, v84, v85
    v_cvt_pk_bf16_f32 v85, v86, v87
    buffer_store_dwordx2 v[84:85], v204, s[60:63], s86 offen
    v_cvt_pk_bf16_f32 v88, v88, v89
    v_cvt_pk_bf16_f32 v89, v90, v91
    buffer_store_dwordx2 v[88:89], v205, s[60:63], s86 offen
    s_nop 1
    v_cvt_pk_bf16_f32 v92, v92, v93
    v_cvt_pk_bf16_f32 v93, v94, v95
    buffer_store_dwordx2 v[92:93], v206, s[60:63], s86 offen
    s_endpgm
FINAL_L:
    s_and_b32 s6, s3, 3
    s_lshl_b32 s79, s4, 1
    s_and_b32 s78, s5, 1
    s_add_u32 s87, s79, s78
    s_lshl_b32 s79, s87, 8
    s_lshl_b32 s78, s6, 6
    s_add_u32 s78, s79, s78
    s_add_u32 s87, s78, 0xc36000
    s_and_b32 s79, s5, 1
    s_add_u32 s88, s79, 3
    v_mov_b32 v5, 0
    v_lshlrev_b32 v1, 4, v0
    s_lshl_b32 s79, s6, 10
    s_mul_i32 s78, s4, 0x6000
    s_add_u32 s78, s79, s78
    s_add_u32 s82, s78, 0xb60000
    s_mov_b32 s60, s22
    s_and_b32 s61, s23, 0xffff
    s_mov_b32 s62, 0x280000
    s_mov_b32 s63, 0x20000
    v_lshrrev_b32 v11, 4, v0
    v_and_b32 v10, 15, v0
    v_mul_u32_u24 v10, 0xa0, v10
    v_lshl_add_u32 v10, v11, 3, v10
    s_mul_i32 s79, s6, 0xa00
    s_add_u32 s79, s79, 0x600
    v_add_u32 v2, s79, v10
    v_and_b32 v12, 1, v0
    v_lshlrev_b32 v12, 4, v12
    v_mov_b32 v13, 0x3f80
    v_lshlrev_b32 v13, v12, v13
    v_mov_b32 v28, 0
    v_mov_b32 v29, 0
    v_mov_b32 v30, 0
    v_mov_b32 v31, 0
    v_mov_b32 v32, 0
    v_mov_b32 v33, 0
    v_mov_b32 v34, 0
    v_mov_b32 v35, 0
    v_mov_b32 v36, 0
    v_mov_b32 v37, 0
    v_mov_b32 v38, 0
    v_mov_b32 v39, 0
    v_mov_b32 v40, 0
    v_mov_b32 v41, 0
    v_mov_b32 v42, 0
    v_mov_b32 v43, 0
    s_mov_b32 exec_lo, 0x30003
    s_mov_b32 exec_hi, 0x30003
    v_mov_b32 v28, v13
    v_mov_b32 v30, v13
    s_mov_b32 exec_lo, 0xc000c
    s_mov_b32 exec_hi, 0xc000c
    v_mov_b32 v29, v13
    v_mov_b32 v31, v13
    s_mov_b32 exec_lo, 0x300030
    s_mov_b32 exec_hi, 0x300030
    v_mov_b32 v32, v13
    v_mov_b32 v34, v13
    s_mov_b32 exec_lo, 0xc000c0
    s_mov_b32 exec_hi, 0xc000c0
    v_mov_b32 v33, v13
    v_mov_b32 v35, v13
    s_mov_b32 exec_lo, 0x3000300
    s_mov_b32 exec_hi, 0x3000300
    v_mov_b32 v36, v13
    v_mov_b32 v38, v13
    s_mov_b32 exec_lo, 0xc000c00
    s_mov_b32 exec_hi, 0xc000c00
    v_mov_b32 v37, v13
    v_mov_b32 v39, v13
    s_mov_b32 exec_lo, 0x30003000
    s_mov_b32 exec_hi, 0x30003000
    v_mov_b32 v40, v13
    v_mov_b32 v42, v13
    s_mov_b32 exec_lo, 0xc000c000
    s_mov_b32 exec_hi, 0xc000c000
    v_mov_b32 v41, v13
    v_mov_b32 v43, v13
    s_mov_b64 exec, -1
    v_and_b32 v11, 15, v0
    v_lshrrev_b32 v10, 4, v0
    v_mul_u32_u24 v10, 0x5000, v10
    v_lshl_add_u32 v10, v11, 3, v10
    s_lshl_b32 s79, s6, 9
    s_add_u32 s79, s79, 0x600
    v_add_u32 v44, s79, v10
    v_add_u32 v45, 128, v44
    v_add_u32 v46, 256, v44
    v_add_u32 v47, 384, v44
    s_lshl_b32 s79, s6, 6
    v_add_u32 v12, s79, v0
    v_mul_u32_u24 v11, 0x667, v12
    v_lshrrev_b32 v52, 14, v11
    v_and_b32 v11, 1, v52
    v_mul_u32_u24 v11, 0x230, v11
    v_lshl_add_u32 v11, v12, 3, v11
    v_lshrrev_b32 v10, 6, v52
    v_mul_u32_u24 v10, 0x500, v10
    v_add_u32 v12, v11, v10
    v_lshrrev_b32 v52, 1, v52
    v_and_b32 v11, 31, v52
    v_mul_u32_u24 v11, 0x14000, v11
    v_add_u32 v11, v11, v12
    v_mul_u32_u24 v10, 0xa0, v52
    v_sub_u32 v52, v11, v10
    s_add_u32 s79, s6, 4
    s_lshl_b32 s79, s79, 6
    v_add_u32 v12, s79, v0
    v_mul_u32_u24 v11, 0x667, v12
    v_lshrrev_b32 v53, 14, v11
    v_and_b32 v11, 1, v53
    v_mul_u32_u24 v11, 0x230, v11
    v_lshl_add_u32 v11, v12, 3, v11
    v_lshrrev_b32 v10, 6, v53
    v_mul_u32_u24 v10, 0x500, v10
    v_add_u32 v12, v11, v10
    v_lshrrev_b32 v53, 1, v53
    v_and_b32 v11, 31, v53
    v_mul_u32_u24 v11, 0x14000, v11
    v_add_u32 v11, v11, v12
    v_mul_u32_u24 v10, 0xa0, v53
    v_sub_u32 v53, v11, v10
    s_mul_i32 s79, s4, 0xa00
    s_mul_i32 s78, s5, 0x50
    s_add_u32 s86, s79, s78
    v_mov_b32 v96, 0
    v_mov_b32 v97, 0
    v_mov_b32 v98, 0
    v_mov_b32 v99, 0
    s_mul_i32 s79, s6, 0xa00
    s_add_u32 s79, s79, 0x600
    v_lshl_add_u32 v14, v0, 4, s79
    s_cmp_eq_u32 s100, 0
    s_cbranch_scc1 L59
    s_mov_b32 s91, 0x40000
    v_mov_b32 v12, 0
L60:
    s_sub_u32 s91, s91, 1
    s_cbranch_scc1 L59
    s_sleep 1
    ds_read_b32 v13, v12 offset:52
    s_waitcnt lgkmcnt(0)
    s_waitcnt lgkmcnt(0)
    v_readfirstlane_b32 s90, v13
    s_cmp_ge_u32 s90, s100
    s_cbranch_scc0 L60
    s_nop 2
L59:
    ds_write_b128 v14, v[96:99] offset:20480
    ds_write_b128 v14, v[96:99] offset:21504
    s_mov_b32 exec_hi, 0
    ds_write_b128 v14, v[96:99] offset:22528
    s_mov_b64 exec, -1
    ds_write_b128 v14, v[96:99] offset:40960
    ds_write_b128 v14, v[96:99] offset:41984
    s_mov_b32 exec_hi, 0
    ds_write_b128 v14, v[96:99] offset:43008
    s_mov_b64 exec, -1
    ds_write_b128 v14, v[96:99] offset:61440
    ds_write_b128 v14, v[96:99] offset:62464
    s_mov_b32 exec_hi, 0
    ds_write_b128 v14, v[96:99] offset:63488
    s_mov_b64 exec, -1
    buffer_load_dword v4, v5, s[36:39], s87 offen offset:0 sc1
    s_waitcnt vmcnt(0)
    v_cmp_ne_u32 vcc, s88, v4
    s_cmp_eq_u64 vcc, 0
    s_cbranch_scc1 L61
    s_mov_b32 s89, 0x8000
L62:
    s_sub_u32 s89, s89, 1
    s_cbranch_scc1 L61
    s_sleep 4
    buffer_load_dword v4, v5, s[36:39], s87 offen offset:0 sc1
    s_waitcnt vmcnt(0)
    v_cmp_ne_u32 vcc, s88, v4
    s_cmp_eq_u64 vcc, 0
    s_cbranch_scc0 L62
L61:
    s_bitcmp1_b32 s5, 0
    s_mov_b32 s74, 0
    s_cselect_b32 s90, 8200, s74
    s_mov_b32 s74, 8
    s_cselect_b32 s91, 12288, s74
    s_mov_b32 s74, 4096
    s_cselect_b32 s92, 12296, s74
    s_mov_b32 s74, 4104
    s_cselect_b32 s93, 16384, s74
    s_mov_b32 s74, 8192
    s_cselect_b32 s94, 20480, s74
    s_add_u32 s90, s90, s82
    buffer_load_dwordx2 v[16:17], v1, s[36:39], s90 offen sc1
    s_add_u32 s91, s91, s82
    buffer_load_dwordx2 v[18:19], v1, s[36:39], s91 offen sc1
    s_add_u32 s92, s92, s82
    buffer_load_dwordx2 v[20:21], v1, s[36:39], s92 offen sc1
    s_add_u32 s93, s93, s82
    buffer_load_dwordx2 v[22:23], v1, s[36:39], s93 offen sc1
    s_add_u32 s94, s94, s82
    buffer_load_dwordx2 v[24:25], v1, s[36:39], s94 offen sc1
    s_waitcnt vmcnt(4)
    ds_write_b64 v2, v[16:17] offset:0
    s_waitcnt vmcnt(3)
    ds_write_b64 v2, v[18:19] offset:32
    s_waitcnt vmcnt(2)
    ds_write_b64 v2, v[20:21] offset:64
    s_waitcnt vmcnt(1)
    ds_write_b64 v2, v[22:23] offset:96
    s_waitcnt vmcnt(0)
    ds_write_b64 v2, v[24:25] offset:128
    s_waitcnt lgkmcnt(0)
    s_barrier
    ds_read2st64_b64 v[56:59], v44 offset0:0 offset1:156
    ds_read2st64_b64 v[60:63], v45 offset0:0 offset1:156
    ds_read2st64_b64 v[64:67], v46 offset0:0 offset1:156
    ds_read2st64_b64 v[68:71], v47 offset0:0 offset1:156
    ds_read2st64_b64 v[72:75], v44 offset0:4 offset1:160
    ds_read2st64_b64 v[76:79], v45 offset0:4 offset1:160
    ds_read2st64_b64 v[80:83], v46 offset0:4 offset1:160
    ds_read2st64_b64 v[84:87], v47 offset0:4 offset1:160
    s_waitcnt lgkmcnt(7)
    v_mfma_f32_16x16x32_bf16 v[88:91], v[28:31], v[56:59], 0
    s_waitcnt lgkmcnt(6)
    v_mfma_f32_16x16x32_bf16 v[88:91], v[32:35], v[60:63], v[88:91]
    s_waitcnt lgkmcnt(5)
    v_mfma_f32_16x16x32_bf16 v[88:91], v[36:39], v[64:67], v[88:91]
    s_waitcnt lgkmcnt(4)
    v_mfma_f32_16x16x32_bf16 v[88:91], v[40:43], v[68:71], v[88:91]
    s_waitcnt lgkmcnt(3)
    v_mfma_f32_16x16x32_bf16 v[92:95], v[28:31], v[72:75], 0
    s_waitcnt lgkmcnt(2)
    v_mfma_f32_16x16x32_bf16 v[92:95], v[32:35], v[76:79], v[92:95]
    s_waitcnt lgkmcnt(1)
    v_mfma_f32_16x16x32_bf16 v[92:95], v[36:39], v[80:83], v[92:95]
    s_waitcnt lgkmcnt(0)
    v_mfma_f32_16x16x32_bf16 v[92:95], v[40:43], v[84:87], v[92:95]
    v_cvt_pk_bf16_f32 v88, v88, v89
    v_cvt_pk_bf16_f32 v89, v90, v91
    buffer_store_dwordx2 v[88:89], v52, s[60:63], s86 offen
    s_nop 4
    v_cvt_pk_bf16_f32 v92, v92, v93
    v_cvt_pk_bf16_f32 v93, v94, v95
    buffer_store_dwordx2 v[92:93], v53, s[60:63], s86 offen
    s_endpgm
.p2align 8
.type F_TAB,@object
F_TAB:
.long 0x3f803f80,0x3f803f80,0x3f803f80,0x3f803f80,0x3f7d3f80,0x3f643f73,0x3e203e9e,0xbe20248d
.long 0x3f733f80,0x3f163f4f,0xbf73bf4f,0xbf73bf80,0x3f643f80,0x3e203f16,0xbee8bf4f,0x3ee8a554
.long 0x3f4f3f80,0xbe9e3e9e,0x3f4f3e9e,0x3f4f3f80,0x3f353f80,0xbf35248d,0x3f353f80,0xbf3525b0
.long 0x3f163f80,0xbf73be9e,0xbf163e9e,0xbf16bf80,0x3ee83f80,0xbf7dbf16,0xbf64bf4f,0x3f64a5f7
.long 0x3e9e3f80,0xbf4fbf4f,0x3e9ebf4f,0x3e9e3f80,0x3e203f80,0xbee8bf73,0x3f7d3e9e,0xbf7d261f
.long 0x248d3f80,0xa554bf80,0x261f3f80,0x269fbf80,0xbe203f80,0x3ee8bf73,0xbf7d3e9e,0x3f7da731
.long 0xbe9e3f80,0x3f4fbf4f,0xbe9ebf4f,0xbe9e3f80,0xbee83f80,0x3f7dbf16,0x3f64bf4f,0xbf64a68d
.long 0xbf163f80,0x3f73be9e,0x3f163e9e,0x3f16bf80,0xbf353f80,0x3f35a554,0xbf353f80,0x3f35a742
.long 0x3f803f80,0x3f803f80,0x3f803f80,0x3f803f80,0x3f353f4f,0x3ee83f16,0xbee8be9e,0xbf35bf16
.long 0x248d3e9e,0xbf16be9e,0xbf16bf4f,0xa554be9e,0xbf35be9e,0xbf7dbf73,0x3f7d3f4f,0x3f353f73
.long 0xbf80bf4f,0xbe9ebf4f,0xbe9e3e9e,0xbf80bf4f,0xbf35bf80,0x3f35a554,0xbf35bf80,0x3f35a5f7
.long 0xa554bf4f,0x3f733f4f,0x3f733e9e,0x261f3f4f,0x3f35be9e,0x3e203f73,0xbe203f4f,0xbf35bf73
.long 0x3f803e9e,0xbf4f3e9e,0xbf4fbf4f,0x3f803e9e,0x3f353f4f,0xbf64bf16,0x3f64be9e,0xbf353f16
.long 0x25b03f80,0xa5f7bf80,0x27393f80,0xa742bf80,0xbf353f4f,0x3f64bf16,0xbf64be9e,0x3f353f16
.long 0xbf803e9e,0x3f4f3e9e,0x3f4fbf4f,0xbf803e9e,0xbf35be9e,0xbe203f73,0x3e203f4f,0x3f35bf73
.long 0xa5f7bf4f,0xbf733f4f,0xbf733e9e,0xa60d3f4f,0x3f35bf80,0xbf352728,0x3f35bf80,0xbf3527ee
.long 0x3f803f80,0x3f803f80,0x3f803f80,0x3f803f80,0xbf64bf4f,0xbf7dbf73,0xbf35bf4f,0xbee8bf16
.long 0x3f163e9e,0x3f733f4f,0x25b03e9e,0xbf16be9e,0xbe203e9e,0xbf64bf16,0x3f353e9e,0x3f7d3f73
.long 0xbe9ebf4f,0x3f4f3e9e,0xbf80bf4f,0xbe9ebf4f,0x3f353f80,0xbf35261f,0x3f353f80,0xbf352739
.long 0xbf73bf4f,0x3f16be9e,0xa742bf4f,0x3f733f4f,0x3f7d3e9e,0xbee83f16,0xbf353e9e,0xbe20bf73
.long 0xbf4f3e9e,0x3e9ebf4f,0x3f803e9e,0xbf4f3e9e,0x3ee8bf4f,0xbe203f73,0xbf35bf4f,0x3f643f16
.long 0xa6543f80,0x2631bf80,0x27f73f80,0xa777bf80,0xbee8bf4f,0x3e203f73,0x3f35bf4f,0xbf643f16
.long 0x3f4f3e9e,0xbe9ebf4f,0xbf803e9e,0x3f4f3e9e,0xbf7d3e9e,0x3ee83f16,0x3f353e9e,0x3e20bf73
.long 0x3f73bf4f,0xbf16be9e,0xa78dbf4f,0xbf733f4f,0xbf353f80,0x3f35a777,0xbf353f80,0x3f35a796
.long 0x3f803f80,0x3f803f80,0x3f803f80,0x3f803f80,0xbf7dbf80,0xbf64bf73,0xbe20be9e,0x3e20a554
.long 0x3f733f80,0x3f163f4f,0xbf73bf4f,0xbf73bf80,0xbf64bf80,0xbe20bf16,0x3ee83f4f,0xbee8261f
.long 0x3f4f3f80,0xbe9e3e9e,0x3f4f3e9e,0x3f4f3f80,0xbf35bf80,0x3f35269f,0xbf35bf80,0x3f35a742
.long 0x3f163f80,0xbf73be9e,0xbf163e9e,0xbf16bf80,0xbee8bf80,0x3f7d3f16,0x3f643f4f,0xbf64a60d
.long 0x3e9e3f80,0xbf4fbf4f,0x3e9ebf4f,0x3e9e3f80,0xbe20bf80,0x3ee83f73,0xbf7dbe9e,0x3f7da777
.long 0xa60d3f80,0x278dbf80,0xa1373f80,0xa784bf80,0x3e20bf80,0xbee83f73,0x3f7dbe9e,0xbf7d2804
.long 0xbe9e3f80,0x3f4fbf4f,0xbe9ebf4f,0xbe9e3f80,0x3ee8bf80,0xbf7d3f16,0xbf643f4f,0x3f642754
.long 0xbf163f80,0x3f73be9e,0x3f163e9e,0x3f16bf80,0x3f35bf80,0xbf352804,0x3f35bf80,0xbf35268d
.long 0x80008000,0x80008000,0x80008000,0x80008000,0xbe208000,0xbee8be9e,0xbf7dbf73,0xbf7dbf80
.long 0xbe9e8000,0xbf4fbf16,0xbe9ebf16,0x3e9ea50d,0xbee88000,0xbf7dbf4f,0x3f643f16,0x3f643f80
.long 0xbf168000,0xbf73bf73,0x3f163f73,0xbf16258d,0xbf358000,0xbf35bf80,0xbf35258d,0xbf35bf80
.long 0xbf4f8000,0xbe9ebf73,0xbf4fbf73,0x3f4fa5d4,0xbf648000,0x3e20bf4f,0x3ee8bf16,0x3ee83f80
.long 0xbf738000,0x3f16bf16,0x3f733f16,0xbf73260d,0xbf7d8000,0x3f64be9e,0xbe203f73,0xbe20bf80
.long 0xbf808000,0x3f80a50d,0xbf80260d,0x3f80a630,0xbf7d8000,0x3f643e9e,0xbe20bf73,0xbe203f80
.long 0xbf738000,0x3f163f16,0x3f73bf16,0xbf732654,0xbf648000,0x3e203f4f,0x3ee83f16,0x3ee8bf80
.long 0xbf4f8000,0xbe9e3f73,0xbf4f3f73,0x3f4fa677,0xbf358000,0xbf353f80,0xbf352654,0xbf353f80
.long 0x80008000,0x80008000,0x80008000,0x80008000,0xbf35bf16,0xbf64bf4f,0xbf64bf73,0xbf35bf4f
.long 0xbf80bf73,0xbf4fbf73,0x3f4f3f16,0x3f803f73,0xbf35bf73,0x3e20be9e,0x3e203f16,0xbf35be9e
.long 0xa50dbf16,0x3f733f16,0xbf73bf73,0xa5d4bf16,0x3f35a50d,0x3f353f80,0x3f35a5d4,0x3f353f80
.long 0x3f803f16,0xbe9e3f16,0x3e9e3f73,0xbf80bf16,0x3f353f73,0xbf7dbe9e,0xbf7dbf16,0x3f35be9e
.long 0x258d3f73,0xbf16bf73,0x3f16bf16,0x26543f73,0xbf353f16,0x3ee8bf4f,0x3ee83f73,0xbf35bf4f
.long 0xbf80258d,0x3f80a5d4,0xbf802654,0x3f80a677,0xbf35bf16,0x3ee83f4f,0x3ee8bf73,0xbf353f4f
.long 0xa5d4bf73,0xbf163f73,0x3f163f16,0xa69fbf73,0x3f35bf73,0xbf7d3e9e,0xbf7d3f16,0x3f353e9e
.long 0x3f80bf16,0xbe9ebf16,0x3e9ebf73,0xbf803f16,0x3f35a5d4,0x3f35bf80,0x3f35a7a8,0x3f35bf80
.long 0x80008000,0x80008000,0x80008000,0x80008000,0xbee8bf16,0xbe20be9e,0x3f353f16,0x3f643f4f
.long 0x3f4f3f73,0x3e9e3f16,0xbf80bf73,0xbf4fbf73,0xbf7dbf73,0xbee8bf4f,0x3f353f73,0xbe203e9e
.long 0x3f733f16,0x3f163f73,0xa630bf16,0x3f733f16,0xbf35260d,0xbf35bf80,0xbf352654,0xbf35bf80
.long 0x3e9ebf16,0x3f4f3f73,0x3f803f16,0xbe9e3f16,0x3e203f73,0xbf64bf4f,0xbf35bf73,0x3f7d3e9e
.long 0xbf16bf73,0x3f733f16,0x26b03f73,0xbf16bf73,0x3f643f16,0xbf7dbe9e,0x3f35bf16,0xbee83f4f
.long 0xbf80268d,0x3f80a69f,0xbf8026d4,0x3f80a7b9,0x3f64bf16,0xbf7d3e9e,0x3f353f16,0xbee8bf4f
.long 0xbf163f73,0x3f73bf16,0xa7c2bf73,0xbf163f73,0x3e20bf73,0xbf643f4f,0xbf353f73,0x3f7dbe9e
.long 0x3e9e3f16,0x3f4fbf73,0x3f80bf16,0xbe9ebf16,0xbf3526d4,0xbf353f80,0xbf352828,0xbf353f80
.long 0x80008000,0x80008000,0x80008000,0x80008000,0x3e20a50d,0x3ee83e9e,0x3f7d3f73,0x3f7d3f80
.long 0xbe9e258d,0xbf4fbf16,0xbe9ebf16,0x3e9ea5d4,0x3ee8a5d4,0x3f7d3f4f,0xbf64bf16,0xbf64bf80
.long 0xbf16260d,0xbf73bf73,0x3f163f73,0xbf162654,0x3f35a630,0x3f353f80,0x3f35a677,0x3f353f80
.long 0xbf4f2654,0xbe9ebf73,0xbf4fbf73,0x3f4fa69f,0x3f64a677,0xbe203f4f,0xbee83f16,0xbee8bf80
.long 0xbf73268d,0x3f16bf16,0x3f733f16,0xbf7326d4,0x3f7da69f,0xbf643e9e,0x3e20bf73,0x3e203f80
.long 0xbf8026b0,0x3f80271f,0xbf8026f7,0x3f80a7c2,0x3f7da7b1,0xbf64be9e,0x3e203f73,0x3e20bf80
.long 0xbf7326d4,0x3f163f16,0x3f73bf16,0xbf73271f,0x3f64270d,0xbe20bf4f,0xbee8bf16,0xbee83f80
.long 0xbf4f26f7,0xbe9e3f73,0xbf4f3f73,0x3f4f268d,0x3f35a7c2,0x3f35bf80,0x3f35a86e,0x3f35bf80
.long 0x0,0x0,0x3f803f80,0x3f803f80,0x0,0x0,0x3ee83e9e,0x3f353f16
.long 0x0,0x0,0xbf16bf4f,0xa5f7be9e,0x0,0x0,0xbf7dbf4f,0xbf35bf73
.long 0x0,0x0,0xbe9e3e9e,0xbf80bf4f,0x0,0x0,0x3f353f80,0xbf35a654
.long 0x0,0x0,0x3f733e9e,0xa60d3f4f,0x0,0x0,0x3e20bf4f,0x3f353f73
.long 0x0,0x0,0xbf4fbf4f,0x3f803e9e,0x0,0x0,0xbf643e9e,0x3f35bf16
.long 0x0,0x0,0x28043f80,0xa78dbf80,0x0,0x0,0x3f643e9e,0xbf35bf16
.long 0x0,0x0,0x3f4fbf4f,0xbf803e9e,0x0,0x0,0xbe20bf4f,0xbf353f73
.long 0x0,0x0,0xbf733e9e,0x28163f4f,0x0,0x0,0xbf353f80,0x3f35a8ac
.long 0x0,0x0,0x3f803f80,0x3f803f80,0x0,0x0,0x3f643f4f,0x3f7d3f73
.long 0x0,0x0,0x3f163e9e,0x3f733f4f,0x0,0x0,0x3e20be9e,0x3f643f16
.long 0x0,0x0,0xbe9ebf4f,0x3f4f3e9e,0x0,0x0,0xbf35bf80,0x3f352631
.long 0x0,0x0,0xbf73bf4f,0x3f16be9e,0x0,0x0,0xbf7dbe9e,0x3ee8bf16
.long 0x0,0x0,0xbf4f3e9e,0x3e9ebf4f,0x0,0x0,0xbee83f4f,0x3e20bf73
.long 0x0,0x0,0x28093f80,0xa796bf80,0x0,0x0,0x3ee83f4f,0xbe20bf73
.long 0x0,0x0,0x3f4f3e9e,0xbe9ebf4f,0x0,0x0,0x3f7dbe9e,0xbee8bf16
.long 0x0,0x0,0x3f73bf4f,0xbf16be9e,0x0,0x0,0x3f35bf80,0xbf35281f
.long 0x0,0x0,0x0,0x0,0x0,0x0,0x0,0x0
.long 0x0,0x0,0x0,0x0,0x0,0x0,0x0,0x0
.long 0x0,0x0,0x0,0x0,0x0,0x0,0x0,0x0
.long 0x0,0x0,0x0,0x0,0x0,0x0,0x0,0x0
.long 0x0,0x0,0x0,0x0,0x0,0x0,0x0,0x0
.long 0x0,0x0,0x0,0x0,0x0,0x0,0x0,0x0
.long 0x0,0x0,0x0,0x0,0x0,0x0,0x0,0x0
.long 0x0,0x0,0x0,0x0,0x0,0x0,0x0,0x0
.long 0x0,0x0,0x0,0x0,0x0,0x0,0x0,0x0
.long 0x0,0x0,0x0,0x0,0x0,0x0,0x0,0x0
.long 0x0,0x0,0x0,0x0,0x0,0x0,0x0,0x0
.long 0x0,0x0,0x0,0x0,0x0,0x0,0x0,0x0
.long 0x0,0x0,0x0,0x0,0x0,0x0,0x0,0x0
.long 0x0,0x0,0x0,0x0,0x0,0x0,0x0,0x0
.long 0x0,0x0,0x0,0x0,0x0,0x0,0x0,0x0
.long 0x0,0x0,0x0,0x0,0x0,0x0,0x0,0x0
.long 0x0,0x0,0x80008000,0x80008000,0x0,0x0,0x3f643f73,0x3f353f4f
.long 0x0,0x0,0x3f4f3f16,0x3f803f73,0x0,0x0,0xbe20bf16,0x3f353e9e
.long 0x0,0x0,0xbf73bf73,0xa677bf16,0x0,0x0,0xbf35268d,0xbf35bf80
.long 0x0,0x0,0x3e9e3f73,0xbf80bf16,0x0,0x0,0x3f7d3f16,0xbf353e9e
.long 0x0,0x0,0x3f16bf16,0x26f73f73,0x0,0x0,0xbee8bf73,0x3f353f4f
.long 0x0,0x0,0xbf80270d,0x3f8026d4,0x0,0x0,0xbee83f73,0x3f35bf4f
.long 0x0,0x0,0x3f163f16,0x268dbf73,0x0,0x0,0x3f7dbf16,0xbf35be9e
.long 0x0,0x0,0x3e9ebf73,0xbf803f16,0x0,0x0,0xbf352754,0xbf353f80
.long 0x0,0x0,0x80008000,0x80008000,0x0,0x0,0x3ee83f16,0x3e203e9e
.long 0x0,0x0,0x3f4f3f73,0x3e9e3f16,0x0,0x0,0x3f7d3f73,0x3ee83f4f
.long 0x0,0x0,0x3f733f16,0x3f163f73,0x0,0x0,0x3f35a69f,0x3f353f80
.long 0x0,0x0,0x3e9ebf16,0x3f4f3f73,0x0,0x0,0xbe20bf73,0x3f643f4f
.long 0x0,0x0,0xbf16bf73,0x3f733f16,0x0,0x0,0xbf64bf16,0x3f7d3e9e
.long 0x0,0x0,0xbf80271f,0x3f8026b1,0x0,0x0,0xbf643f16,0x3f7dbe9e
.long 0x0,0x0,0xbf163f73,0x3f73bf16,0x0,0x0,0xbe203f73,0x3f64bf4f
.long 0x0,0x0,0x3e9e3f16,0x3f4fbf73,0x0,0x0,0x3f35a7f7,0x3f35bf80
.long 0x0,0x0,0x0,0x0,0x0,0x0,0x0,0x0
.long 0x0,0x0,0x0,0x0,0x0,0x0,0x0,0x0
.long 0x0,0x0,0x0,0x0,0x0,0x0,0x0,0x0
.long 0x0,0x0,0x0,0x0,0x0,0x0,0x0,0x0
.long 0x0,0x0,0x0,0x0,0x0,0x0,0x0,0x0
.long 0x0,0x0,0x0,0x0,0x0,0x0,0x0,0x0
.long 0x0,0x0,0x0,0x0,0x0,0x0,0x0,0x0
.long 0x0,0x0,0x0,0x0,0x0,0x0,0x0,0x0
.long 0x0,0x0,0x0,0x0,0x0,0x0,0x0,0x0
.long 0x0,0x0,0x0,0x0,0x0,0x0,0x0,0x0
.long 0x0,0x0,0x0,0x0,0x0,0x0,0x0,0x0
.long 0x0,0x0,0x0,0x0,0x0,0x0,0x0,0x0
.long 0x0,0x0,0x0,0x0,0x0,0x0,0x0,0x0
.long 0x0,0x0,0x0,0x0,0x0,0x0,0x0,0x0
.long 0x0,0x0,0x0,0x0,0x0,0x0,0x0,0x0
.long 0x0,0x0,0x0,0x0,0x0,0x0,0x0,0x0
.long 0x3f800000,0x3f800000,0x3f800000,0x3f800000,0x3f800000,0x3f7ffcd7,0x3f7ff35e,0x3f7fe394
.long 0x3f800000,0x3f7ff35e,0x3f7fcd79,0x3f7f8e56,0x3f800000,0x3f7fe394,0x3f7f8e56,0x3f7f0059
.long 0x3f800000,0x3f7fcd79,0x3f7f35f9,0x3f7e39bc,0x3f800000,0x3f7fb10f,0x3f7ec46d,0x3f7d3aac
.long 0x3f800000,0x3f7f8e56,0x3f7e39bc,0x3f7c0361,0x3f800000,0x3f7f654e,0x3f7d95f4,0x3f7a9421
.long 0x3f800000,0x3f7f35f9,0x3f7cd925,0x3f78ed3c,0x3f800000,0x3f7f0059,0x3f7c0361,0x3f770f11
.long 0x3f800000,0x3f7ec46d,0x3f7b14be,0x3f74fa0b,0x3f800000,0x3f7e8238,0x3f7a0d54,0x3f72ae9e
.long 0x3f800000,0x3f7e39bc,0x3f78ed3c,0x3f702d4f,0x3f800000,0x3f7deafa,0x3f77b493,0x3f6d76aa
.long 0x3f800000,0x3f7d95f4,0x3f766377,0x3f6a8b4b,0x3f800000,0x3f7d3aac,0x3f74fa0b,0x3f676bd8
.long 0x3f800000,0x3f800000,0x3f800000,0x3f800000,0x3f7fcd79,0x3f7fb10f,0x3f7f8e56,0x3f7f654e
.long 0x3f7f35f9,0x3f7ec46d,0x3f7e39bc,0x3f7d95f4,0x3f7e39bc,0x3f7d3aac,0x3f7c0361,0x3f7a9421
.long 0x3f7cd925,0x3f7b14be,0x3f78ed3c,0x3f766377,0x3f7b14be,0x3f7853f8,0x3f74fa0b,0x3f710908
.long 0x3f78ed3c,0x3f74fa0b,0x3f702d4f,0x3f6a8b4b,0x3f766377,0x3f710908,0x3f6a8b4b,0x3f62f219
.long 0x3f737871,0x3f6c835e,0x3f641901,0x3f5a46a0,0x3f702d4f,0x3f676bd8,0x3f5cdc29,0x3f50935b
.long 0x3f6c835e,0x3f61c598,0x3f54db31,0x3f45e403,0x3f687c12,0x3f5b941a,0x3f4c1d35,0x3f3a4582
.long 0x3f641901,0x3f54db31,0x3f42a9f7,0x3f2dc5e3,0x3f5f5be6,0x3f4d9f02,0x3f3889dc,0x3f207440
.long 0x3f5a46a0,0x3f45e403,0x3f2dc5e3,0x3f1260b2,0x3f54db31,0x3f3daef9,0x3f226799,0x3f039c3d
.long 0x3f800000,0x3f800000,0x3f800000,0x3f800000,0x3f7f35f9,0x3f7f0059,0x3f7ec46d,0x3f7e8238
.long 0x3f7cd925,0x3f7c0361,0x3f7b14be,0x3f7a0d54,0x3f78ed3c,0x3f770f11,0x3f74fa0b,0x3f72ae9e
.long 0x3f737871,0x3f702d4f,0x3f6c835e,0x3f687c12,0x3f6c835e,0x3f676bd8,0x3f61c598,0x3f5b941a
.long 0x3f641901,0x3f5cdc29,0x3f54db31,0x3f4c1d35,0x3f5a46a0,0x3f50935b,0x3f45e403,0x3f3a4582
.long 0x3f4f1bbd,0x3f42a9f7,0x3f3504f3,0x3f26423a,0x3f42a9f7,0x3f333bc6,0x3f226799,0x3f104f0e
.long 0x3f3504f3,0x3f226799,0x3f0e39da,0x3ef15aea,0x3f26423a,0x3f104f0e,0x3ef15aea,0x3ebf47d7
.long 0x3f167918,0x3efa2c90,0x3ec3ef15,0x3e8afa3e,0x3f05c277,0x3ed1c759,0x3e94a031,0x3e2a1c3f
.long 0x3ee87171,0x3ea7bf25,0x3e47c5c2,0x3d712283,0x3ec3ef15,0x3e78cfcc,0x3dc8bd36,0xbd48fb30
.long 0x3f800000,0x3f800000,0x3f800000,0x3f800000,0x3f7e39bc,0x3f7deafa,0x3f7d95f4,0x3f7d3aac
.long 0x3f78ed3c,0x3f77b493,0x3f766377,0x3f74fa0b,0x3f702d4f,0x3f6d76aa,0x3f6a8b4b,0x3f676bd8
.long 0x3f641901,0x3f5f5be6,0x3f5a46a0,0x3f54db31,0x3f54db31,0x3f4d9f02,0x3f45e403,0x3f3daef9
.long 0x3f42a9f7,0x3f3889dc,0x3f2dc5e3,0x3f226799,0x3f2dc5e3,0x3f207440,0x3f1260b2,0x3f039c3d
.long 0x3f167918,0x3f05c277,0x3ee87171,0x3ec3ef15,0x3efa2c90,0x3ed1c759,0x3ea7bf25,0x3e78cfcc
.long 0x3ec3ef15,0x3e94a031,0x3e47c5c2,0x3dc8bd36,0x3e8afa3e,0x3e2a1c3f,0x3d712283,0xbd48fb30
.long 0x3e20305b,0x3d20cee7,0xbda0af2a,0xbe47c5c2,0x3d20cee7,0xbdb4b86a,0xbe5b73dc,0xbeac7cd4
.long 0xbda0af2a,0xbe5b73dc,0xbeb13641,0xbef15aea,0xbe47c5c2,0xbeac7cd4,0xbef15aea,0xbf187fc0
.long 0x80000000,0x80000000,0x80000000,0x80000000,0x80000000,0xbc20d8d2,0xbca0d6d6,0xbcf13d4c
.long 0x80000000,0xbca0d6d6,0xbd20cee7,0xbd712283,0x80000000,0xbcf13d4c,0xbd712283,0xbdb4b86a
.long 0x80000000,0xbd20cee7,0xbda0af2a,0xbdf0b772,0x80000000,0xbd48fb30,0xbdc8bd36,0xbe164083
.long 0x80000000,0xbd712283,0xbdf0b772,0xbe3403f1,0x80000000,0xbd8ca1f2,0xbe0c4cf7,0xbe519f65
.long 0x80000000,0xbda0af2a,0xbe20305b,0xbe6f0c4d,0x80000000,0xbdb4b86a,0xbe3403f1,0xbe862210
.long 0x80000000,0xbdc8bd36,0xbe47c5c2,0xbe94a031,0x80000000,0xbddcbd0d,0xbe5b73dc,0xbea2fd52
.long 0x80000000,0xbdf0b772,0xbe6f0c4d,0xbeb13641,0x80000000,0xbe0255f4,0xbe814693,0xbebf47d7
.long 0x80000000,0xbe0c4cf7,0xbe8afa3e,0xbecd2ef3,0x80000000,0xbe164083,0xbe94a031,0xbedae880
.long 0x80000000,0x80000000,0x80000000,0x80000000,0xbd20cee7,0xbd48fb30,0xbd712283,0xbd8ca1f2
.long 0xbda0af2a,0xbdc8bd36,0xbdf0b772,0xbe0c4cf7,0xbdf0b772,0xbe164083,0xbe3403f1,0xbe519f65
.long 0xbe20305b,0xbe47c5c2,0xbe6f0c4d,0xbe8afa3e,0xbe47c5c2,0xbe78cfcc,0xbe94a031,0xbeac7cd4
.long 0xbe6f0c4d,0xbe94a031,0xbeb13641,0xbecd2ef3,0xbe8afa3e,0xbeac7cd4,0xbecd2ef3,0xbeece91a
.long 0xbe9e377a,0xbec3ef15,0xbee87171,0xbf05c277,0xbeb13641,0xbedae880,0xbf0172c3,0xbf146eba
.long 0xbec3ef15,0xbef15aea,0xbf0e39da,0xbf226799,0xbed65a92,0xbf039c3d,0xbf1a82a4,0xbf2f9c32
.long 0xbee87171,0xbf0e39da,0xbf26423a,0xbf3bfc8f,0xbefa2c90,0xbf187fc0,0xbf316e2c,0xbf4779bc
.long 0xbf05c277,0xbf226799,0xbf3bfc8f,0xbf5205d4,0xbf0e39da,0xbf2beb4a,0xbf45e403,0xbf5b941a
.long 0x80000000,0x80000000,0x80000000,0x80000000,0xbda0af2a,0xbdb4b86a,0xbdc8bd36,0xbddcbd0d
.long 0xbe20305b,0xbe3403f1,0xbe47c5c2,0xbe5b73dc,0xbe6f0c4d,0xbe862210,0xbe94a031,0xbea2fd52
.long 0xbe9e377a,0xbeb13641,0xbec3ef15,0xbed65a92,0xbec3ef15,0xbedae880,0xbef15aea,0xbf039c3d
.long 0xbee87171,0xbf0172c3,0xbf0e39da,0xbf1a82a4,0xbf05c277,0xbf146eba,0xbf226799,0xbf2f9c32
.long 0xbf167918,0xbf26423a,0xbf3504f3,0xbf42a9f7,0xbf26423a,0xbf36c9a9,0xbf45e403,0xbf53731f
.long 0xbf3504f3,0xbf45e403,0xbf54db31,0xbf61c598,0xbf42a9f7,0xbf53731f,0xbf61c598,0xbf6d76aa
.long 0xbf4f1bbd,0xbf5f5be6,0xbf6c835e,0xbf766377,0xbf5a46a0,0xbf698690,0xbf74fa0b,0xbf7c7160
.long 0xbf641901,0xbf71decf,0xbf7b14be,0xbf7f8e56,0xbf6c835e,0xbf7853f8,0xbf7ec46d,0xbf7fb10f
.long 0x80000000,0x80000000,0x80000000,0x80000000,0xbdf0b772,0xbe0255f4,0xbe0c4cf7,0xbe164083
.long 0xbe6f0c4d,0xbe814693,0xbe8afa3e,0xbe94a031,0xbeb13641,0xbebf47d7,0xbecd2ef3,0xbedae880
.long 0xbee87171,0xbefa2c90,0xbf05c277,0xbf0e39da,0xbf0e39da,0xbf187fc0,0xbf226799,0xbf2beb4a
.long 0xbf26423a,0xbf316e2c,0xbf3bfc8f,0xbf45e403,0xbf3bfc8f,0xbf4779bc,0xbf5205d4,0xbf5b941a
.long 0xbf4f1bbd,0xbf5a46a0,0xbf641901,0xbf6c835e,0xbf5f5be6,0xbf698690,0xbf71decf,0xbf7853f8
.long 0xbf6c835e,0xbf74fa0b,0xbf7b14be,0xbf7ec46d,0xbf766377,0xbf7c7160,0xbf7f8e56,0xbf7fb10f
.long 0xbf7cd925,0xbf7fcd79,0xbf7f35f9,0xbf7b14be,0xbf7fcd79,0xbf7f0059,0xbf7a0d54,0xbf710908
.long 0xbf7f35f9,0xbf7a0d54,0xbf702d4f,0xbf61c598,0xbf7b14be,0xbf710908,0xbf61c598,0xbf4d9f02
.long 0xbf4f3f80,0x3e9e3e9e,0xbf4f3e9e,0xbf4f3f80,0xbf643f80,0xbe203f16,0x3ee8bf4f,0xbee8a654
.long 0xbf733f80,0xbf163f4f,0x3f73bf4f,0x3f73bf80,0xbf7d3f80,0xbf643f73,0xbe203e9e,0x3e202631
.long 0xbf803f80,0xbf803f80,0xbf803f80,0xbf803f80,0xbf7d3f80,0xbf643f73,0xbe203e9e,0x3e20a60d
.long 0xbf733f80,0xbf163f4f,0x3f73bf4f,0x3f73bf80,0xbf643f80,0xbe203f16,0x3ee8bf4f,0xbee8a765
.long 0xbf4f3f80,0x3e9e3e9e,0xbf4f3e9e,0xbf4f3f80,0xbf353f80,0x3f3525b0,0xbf353f80,0x3f35a58e
.long 0xbf163f80,0x3f73be9e,0x3f163e9e,0x3f16bf80,0xbee83f80,0x3f7dbf16,0x3f64bf4f,0xbf64a777
.long 0xbe9e3f80,0x3f4fbf4f,0xbe9ebf4f,0xbe9e3f80,0xbe203f80,0x3ee8bf73,0xbf7d3e9e,0x3f7da137
.long 0xa5543f80,0x2728bf80,0xa7773f80,0x2804bf80,0x3e203f80,0xbee8bf73,0x3f7d3e9e,0xbf7da784
.long 0x3f80bf4f,0x3e9ebf4f,0x3e9e3e9e,0x3f80bf4f,0x3f35be9e,0x3f7dbf73,0xbf7d3f4f,0xbf353f73
.long 0x261f3e9e,0x3f16be9e,0x3f16bf4f,0xa777be9e,0xbf353f4f,0xbee83f16,0x3ee8be9e,0x3f35bf16
.long 0xbf803f80,0xbf803f80,0xbf803f80,0xbf803f80,0xbf353f4f,0xbee83f16,0x3ee8be9e,0x3f35bf16
.long 0xa7313e9e,0x3f16be9e,0x3f16bf4f,0x2804be9e,0x3f35be9e,0x3f7dbf73,0xbf7d3f4f,0xbf353f73
.long 0x3f80bf4f,0x3e9ebf4f,0x3e9e3e9e,0x3f80bf4f,0x3f35bf80,0xbf35a742,0x3f35bf80,0xbf352766
.long 0xa68dbf4f,0xbf733f4f,0xbf733e9e,0x27543f4f,0xbf35be9e,0xbe203f73,0x3e203f4f,0x3f35bf73
.long 0xbf803e9e,0x3f4f3e9e,0x3f4fbf4f,0xbf803e9e,0xbf353f4f,0x3f64bf16,0xbf64be9e,0x3f353f16
.long 0xa7423f80,0x27eebf80,0xa7963f80,0x268dbf80,0x3f353f4f,0xbf64bf16,0x3f64be9e,0xbf353f16
.long 0x3e9ebf4f,0xbf4f3e9e,0x3f80bf4f,0x3e9ebf4f,0x3e203e9e,0x3f64bf16,0xbf353e9e,0xbf7d3f73
.long 0xbf163e9e,0xbf733f4f,0x268d3e9e,0x3f16be9e,0x3f64bf4f,0x3f7dbf73,0x3f35bf4f,0x3ee8bf16
.long 0xbf803f80,0xbf803f80,0xbf803f80,0xbf803f80,0x3f64bf4f,0x3f7dbf73,0x3f35bf4f,0x3ee8bf16
.long 0xbf163e9e,0xbf733f4f,0xa85d3e9e,0x3f16be9e,0x3e203e9e,0x3f64bf16,0xbf353e9e,0xbf7d3f73
.long 0x3e9ebf4f,0xbf4f3e9e,0x3f80bf4f,0x3e9ebf4f,0xbf353f80,0x3f35268d,0xbf353f80,0x3f35a7b1
.long 0x3f73bf4f,0xbf16be9e,0xa7b1bf4f,0xbf733f4f,0xbf7d3e9e,0x3ee83f16,0x3f353e9e,0x3e20bf73
.long 0x3f4f3e9e,0xbe9ebf4f,0xbf803e9e,0x3f4f3e9e,0xbee8bf4f,0x3e203f73,0x3f35bf4f,0xbf643f16
.long 0xa8ac3f80,0x281fbf80,0xa7e53f80,0x2839bf80,0x3ee8bf4f,0xbe203f73,0xbf35bf4f,0x3f643f16
.long 0xbf4f3f80,0x3e9e3e9e,0xbf4f3e9e,0xbf4f3f80,0x3f64bf80,0x3e20bf16,0xbee83f4f,0x3ee8a7b1
.long 0xbf733f80,0xbf163f4f,0x3f73bf4f,0x3f73bf80,0x3f7dbf80,0x3f64bf73,0x3e20be9e,0xbe20281f
.long 0xbf803f80,0xbf803f80,0xbf803f80,0xbf803f80,0x3f7dbf80,0x3f64bf73,0x3e20be9e,0xbe2026d4
.long 0xbf733f80,0xbf163f4f,0x3f73bf4f,0x3f73bf80,0x3f64bf80,0x3e20bf16,0xbee83f4f,0x3ee82896
.long 0xbf4f3f80,0x3e9e3e9e,0xbf4f3e9e,0xbf4f3f80,0x3f35bf80,0xbf35270d,0x3f35bf80,0xbf35a7e5
.long 0xbf163f80,0x3f73be9e,0x3f163e9e,0x3f16bf80,0x3ee8bf80,0xbf7d3f16,0xbf643f4f,0x3f642839
.long 0xbe9e3f80,0x3f4fbf4f,0xbe9ebf4f,0xbe9e3f80,0x3e20bf80,0xbee83f73,0x3f7dbe9e,0xbf7da880
.long 0xa8653f80,0x2896bf80,0xa8803f80,0x28a3bf80,0xbe20bf80,0x3ee83f73,0xbf7dbe9e,0x3f7d28a3
.long 0xbf168000,0xbf733f73,0x3f16bf73,0xbf16268d,0xbee88000,0xbf7d3f4f,0x3f64bf16,0x3f64bf80
.long 0xbe9e8000,0xbf4f3f16,0xbe9e3f16,0x3e9ea69f,0xbe208000,0xbee83e9e,0xbf7d3f73,0xbf7d3f80
.long 0xa50d8000,0xa5d4258d,0xa69f268d,0x271f26b0,0x3e208000,0x3ee8be9e,0x3f7dbf73,0x3f7dbf80
.long 0x3e9e8000,0x3f4fbf16,0x3e9ebf16,0xbe9ea7b1,0x3ee88000,0x3f7dbf4f,0xbf643f16,0xbf643f80
.long 0x3f168000,0x3f73bf73,0xbf163f73,0x3f1626d4,0x3f358000,0x3f35bf80,0x3f3526b0,0x3f35bf80
.long 0x3f4f8000,0x3e9ebf73,0x3f4fbf73,0xbf4f270d,0x3f648000,0xbe20bf4f,0xbee8bf16,0xbee83f80
.long 0x3f738000,0xbf16bf16,0xbf733f16,0x3f7326f7,0x3f7d8000,0xbf64be9e,0x3e203f73,0x3e20bf80
.long 0x3f808000,0xbf80a5d4,0x3f8026d4,0xbf80a7c2,0x3f7d8000,0xbf643e9e,0x3e20bf73,0x3e203f80
.long 0x260d3f16,0x3f73bf16,0xbf733f73,0x26d43f16,0xbf353f73,0x3e203e9e,0x3e20bf16,0xbf353e9e
.long 0xbf803f73,0xbf4f3f73,0x3f4fbf16,0x3f80bf73,0xbf353f16,0xbf643f4f,0xbf643f73,0xbf353f4f
.long 0xa630260d,0xa6772654,0xa7b926d4,0xa7c226f7,0x3f35bf16,0x3f64bf4f,0x3f64bf73,0x3f35bf4f
.long 0x3f80bf73,0x3f4fbf73,0xbf4f3f16,0xbf803f73,0x3f35bf73,0xbe20be9e,0xbe203f16,0x3f35be9e
.long 0x2654bf16,0xbf733f16,0x3f73bf73,0x271fbf16,0xbf35a630,0xbf353f80,0xbf35a7c2,0xbf353f80
.long 0xbf803f16,0x3e9e3f16,0xbe9e3f73,0x3f80bf16,0xbf353f73,0x3f7dbe9e,0x3f7dbf16,0xbf35be9e
.long 0xa6773f73,0x3f16bf73,0xbf16bf16,0x268d3f73,0x3f353f16,0xbee8bf4f,0xbee83f73,0x3f35bf4f
.long 0x3f802654,0xbf80a7a8,0x3f802828,0xbf80a86e,0x3f35bf16,0xbee83f4f,0xbee8bf73,0x3f353f4f
.long 0x3f73bf16,0x3f16bf73,0x27303f16,0x3f73bf16,0xbf7d3f73,0xbee83f4f,0x3f35bf73,0xbe20be9e
.long 0x3f4fbf73,0x3e9ebf16,0xbf803f73,0xbf4f3f73,0xbee83f16,0xbe203e9e,0x3f35bf16,0x3f64bf4f
.long 0x26d4270d,0x26b1271f,0xa8772754,0xa7f72839,0x3ee8bf16,0x3e20be9e,0xbf353f16,0xbf643f4f
.long 0xbf4f3f73,0xbe9e3f16,0x3f80bf73,0x3f4fbf73,0x3f7dbf73,0x3ee8bf4f,0xbf353f73,0x3e203e9e
.long 0xbf733f16,0xbf163f73,0x2842bf16,0xbf733f16,0x3f352730,0x3f35bf80,0x3f352842,0x3f35bf80
.long 0xbe9ebf16,0xbf4f3f73,0xbf803f16,0x3e9e3f16,0xbe203f73,0x3f64bf4f,0x3f35bf73,0xbf7d3e9e
.long 0x3f16bf73,0xbf733f16,0xa80d3f73,0x3f16bf73,0xbf643f16,0x3f7dbe9e,0xbf35bf16,0x3ee83f4f
.long 0x3f802754,0xbf80a7f7,0x3f8028a8,0xbf80a816,0xbf64bf16,0x3f7d3e9e,0xbf353f16,0x3ee8bf4f
.long 0xbf16270d,0xbf733f73,0x3f16bf73,0xbf162754,0x3ee826d4,0x3f7dbf4f,0xbf643f16,0xbf643f80
.long 0xbe9e271f,0xbf4f3f16,0xbe9e3f16,0x3e9ea7f7,0x3e2026b1,0x3ee8be9e,0x3f7dbf73,0x3f7dbf80
.long 0x268d2730,0x280da79f,0x21b72777,0xa8042842,0xbe20268d,0xbee83e9e,0xbf7d3f73,0xbf7d3f80
.long 0x3e9e2831,0x3f4fbf16,0x3e9ebf16,0xbe9ea884,0xbee8a7e5,0xbf7d3f4f,0x3f64bf16,0x3f64bf80
.long 0x3f162754,0x3f73bf73,0xbf163f73,0x3f16279f,0xbf35260e,0xbf353f80,0xbf3527e6,0xbf353f80
.long 0x3f4fa78d,0x3e9ebf73,0x3f4fbf73,0xbf4f27d4,0xbf64a7f7,0x3e203f4f,0x3ee83f16,0x3ee8bf80
.long 0x3f732777,0xbf16bf16,0xbf733f16,0x3f73a70d,0xbf7d21b7,0x3f643e9e,0xbe20bf73,0xbe203f80
.long 0x3f802842,0xbf80a884,0x3f8028ee,0xbf80a70d,0xbf7da804,0x3f64be9e,0xbe203f73,0xbe20bf80
.long 0x0,0x0,0x3e9e3e9e,0x3f80bf4f,0x0,0x0,0x3f7dbf4f,0x3f35bf73
.long 0x0,0x0,0x3f16bf4f,0x26d4be9e,0x0,0x0,0xbee83e9e,0xbf353f16
.long 0x0,0x0,0xbf803f80,0xbf803f80,0x0,0x0,0xbee83e9e,0xbf353f16
.long 0x0,0x0,0x3f16bf4f,0x289abe9e,0x0,0x0,0x3f7dbf4f,0x3f35bf73
.long 0x0,0x0,0x3e9e3e9e,0x3f80bf4f,0x0,0x0,0xbf353f80,0x3f352777
.long 0x0,0x0,0xbf733e9e,0xa8043f4f,0x0,0x0,0xbe20bf4f,0xbf353f73
.long 0x0,0x0,0x3f4fbf4f,0xbf803e9e,0x0,0x0,0x3f643e9e,0xbf35bf16
.long 0x0,0x0,0xa8c73f80,0xa731bf80,0x0,0x0,0xbf643e9e,0x3f35bf16
.long 0x0,0x0,0x3e9ebf4f,0xbf4f3e9e,0x0,0x0,0xbe20be9e,0xbf643f16
.long 0x0,0x0,0xbf163e9e,0xbf733f4f,0x0,0x0,0xbf643f4f,0xbf7d3f73
.long 0x0,0x0,0xbf803f80,0xbf803f80,0x0,0x0,0xbf643f4f,0xbf7d3f73
.long 0x0,0x0,0xbf163e9e,0xbf733f4f,0x0,0x0,0xbe20be9e,0xbf643f16
.long 0x0,0x0,0x3e9ebf4f,0xbf4f3e9e,0x0,0x0,0x3f35bf80,0xbf35a60d
.long 0x0,0x0,0x3f73bf4f,0xbf16be9e,0x0,0x0,0x3f7dbe9e,0xbee8bf16
.long 0x0,0x0,0x3f4f3e9e,0xbe9ebf4f,0x0,0x0,0x3ee83f4f,0xbe20bf73
.long 0x0,0x0,0xa9073f80,0x2918bf80,0x0,0x0,0xbee83f4f,0x3e20bf73
.long 0x0,0x0,0x0,0x0,0x0,0x0,0x0,0x0
.long 0x0,0x0,0x0,0x0,0x0,0x0,0x0,0x0
.long 0x0,0x0,0x0,0x0,0x0,0x0,0x0,0x0
.long 0x0,0x0,0x0,0x0,0x0,0x0,0x0,0x0
.long 0x0,0x0,0x0,0x0,0x0,0x0,0x0,0x0
.long 0x0,0x0,0x0,0x0,0x0,0x0,0x0,0x0
.long 0x0,0x0,0x0,0x0,0x0,0x0,0x0,0x0
.long 0x0,0x0,0x0,0x0,0x0,0x0,0x0,0x0
.long 0x0,0x0,0x0,0x0,0x0,0x0,0x0,0x0
.long 0x0,0x0,0x0,0x0,0x0,0x0,0x0,0x0
.long 0x0,0x0,0x0,0x0,0x0,0x0,0x0,0x0
.long 0x0,0x0,0x0,0x0,0x0,0x0,0x0,0x0
.long 0x0,0x0,0x0,0x0,0x0,0x0,0x0,0x0
.long 0x0,0x0,0x0,0x0,0x0,0x0,0x0,0x0
.long 0x0,0x0,0x0,0x0,0x0,0x0,0x0,0x0
.long 0x0,0x0,0x0,0x0,0x0,0x0,0x0,0x0
.long 0x0,0x0,0xbf733f73,0x27773f16,0x0,0x0,0xbe203f16,0x3f35be9e
.long 0x0,0x0,0x3f4fbf16,0x3f80bf73,0x0,0x0,0x3f64bf73,0x3f35bf4f
.long 0x0,0x0,0xa884278d,0xa80da754,0x0,0x0,0xbf643f73,0xbf353f4f
.long 0x0,0x0,0xbf4f3f16,0xbf803f73,0x0,0x0,0x3e20bf16,0xbf353e9e
.long 0x0,0x0,0x3f73bf73,0xa70dbf16,0x0,0x0,0x3f3527b0,0x3f35bf80
.long 0x0,0x0,0xbe9e3f73,0x3f80bf16,0x0,0x0,0xbf7d3f16,0x3f353e9e
.long 0x0,0x0,0xbf16bf16,0xa8963f73,0x0,0x0,0x3ee8bf73,0xbf353f4f
.long 0x0,0x0,0x3f8027d4,0xbf80a92c,0x0,0x0,0x3ee83f73,0xbf35bf4f
.long 0x0,0x0,0x3f73bf16,0x3f16bf73,0x0,0x0,0x3f7dbf73,0x3ee8bf4f
.long 0x0,0x0,0x3f4fbf73,0x3e9ebf16,0x0,0x0,0x3ee8bf16,0x3e20be9e
.long 0x0,0x0,0xa889279f,0xa816a731,0x0,0x0,0xbee83f16,0xbe203e9e
.long 0x0,0x0,0xbf4f3f73,0xbe9e3f16,0x0,0x0,0xbf7d3f73,0xbee83f4f
.long 0x0,0x0,0xbf733f16,0xbf163f73,0x0,0x0,0xbf35a70d,0xbf353f80
.long 0x0,0x0,0xbe9ebf16,0xbf4f3f73,0x0,0x0,0x3e20bf73,0xbf643f4f
.long 0x0,0x0,0x3f16bf73,0xbf733f16,0x0,0x0,0x3f64bf16,0xbf7d3e9e
.long 0x0,0x0,0x3f802877,0xbf80a89f,0x0,0x0,0x3f643f16,0xbf7dbe9e
.long 0x0,0x0,0x0,0x0,0x0,0x0,0x0,0x0
.long 0x0,0x0,0x0,0x0,0x0,0x0,0x0,0x0
.long 0x0,0x0,0x0,0x0,0x0,0x0,0x0,0x0
.long 0x0,0x0,0x0,0x0,0x0,0x0,0x0,0x0
.long 0x0,0x0,0x0,0x0,0x0,0x0,0x0,0x0
.long 0x0,0x0,0x0,0x0,0x0,0x0,0x0,0x0
.long 0x0,0x0,0x0,0x0,0x0,0x0,0x0,0x0
.long 0x0,0x0,0x0,0x0,0x0,0x0,0x0,0x0
.long 0x0,0x0,0x0,0x0,0x0,0x0,0x0,0x0
.long 0x0,0x0,0x0,0x0,0x0,0x0,0x0,0x0
.long 0x0,0x0,0x0,0x0,0x0,0x0,0x0,0x0
.long 0x0,0x0,0x0,0x0,0x0,0x0,0x0,0x0
.long 0x0,0x0,0x0,0x0,0x0,0x0,0x0,0x0
.long 0x0,0x0,0x0,0x0,0x0,0x0,0x0,0x0
.long 0x0,0x0,0x0,0x0,0x0,0x0,0x0,0x0
.long 0x0,0x0,0x0,0x0,0x0,0x0,0x0,0x0
.long 0x3f800000,0x3f7cd925,0x3f737871,0x3f641901,0x3f800000,0x3f7c7160,0x3f71decf,0x3f609384
.long 0x3f800000,0x3f7c0361,0x3f702d4f,0x3f5cdc29,0x3f800000,0x3f7b8f2a,0x3f6e641a,0x3f58f3c4
.long 0x3f800000,0x3f7b14be,0x3f6c835e,0x3f54db31,0x3f800000,0x3f7a9421,0x3f6a8b4b,0x3f50935b
.long 0x3f800000,0x3f7a0d54,0x3f687c12,0x3f4c1d35,0x3f800000,0x3f79805c,0x3f6655e7,0x3f4779bc
.long 0x3f800000,0x3f78ed3c,0x3f641901,0x3f42a9f7,0x3f800000,0x3f7853f8,0x3f61c598,0x3f3daef9
.long 0x3f800000,0x3f77b493,0x3f5f5be6,0x3f3889dc,0x3f800000,0x3f770f11,0x3f5cdc29,0x3f333bc6
.long 0x3f800000,0x3f766377,0x3f5a46a0,0x3f2dc5e3,0x3f800000,0x3f75b1c9,0x3f579b8c,0x3f28296a
.long 0x3f800000,0x3f74fa0b,0x3f54db31,0x3f226799,0x3f800000,0x3f743c41,0x3f5205d4,0x3f1c81b9
.long 0x3f4f1bbd,0x3f3504f3,0x3f167918,0x3ee87171,0x3f490a88,0x3f2beb4a,0x3f0a04f8,0x3ec8917e
.long 0x3f42a9f7,0x3f226799,0x3efa2c90,0x3ea7bf25,0x3f3bfc8f,0x3f187fc0,0x3edf7108,0x3e862210
.long 0x3f3504f3,0x3f0e39da,0x3ec3ef15,0x3e47c5c2,0x3f2dc5e3,0x3f039c3d,0x3ea7bf25,0x3e0255f4
.long 0x3f26423a,0x3ef15aea,0x3e8afa3e,0x3d712283,0x3f1e7cf1,0x3edae880,0x3e5b73dc,0xbc20d8d2
.long 0x3f167918,0x3ec3ef15,0x3e20305b,0xbda0af2a,0x3f0e39da,0x3eac7cd4,0x3dc8bd36,0xbe164083
.long 0x3f05c277,0x3e94a031,0x3d20cee7,0xbe5b73dc,0x3efa2c90,0x3e78cfcc,0xbca0d6d6,0xbe8fcefe
.long 0x3ee87171,0x3e47c5c2,0xbda0af2a,0xbeb13641,0x3ed65a92,0x3e164083,0xbe0c4cf7,0xbed1c759
.long 0x3ec3ef15,0x3dc8bd36,0xbe47c5c2,0xbef15aea,0x3eb13641,0x3d48fb30,0xbe814693,0xbf07e565
.long 0x3e9e377a,0x3e20305b,0x248d3132,0xbe20305b,0x3e6f0c4d,0x3d8ca1f2,0xbdc8bd36,0xbe862210
.long 0x3e20305b,0xbca0d6d6,0xbe47c5c2,0xbeba9be1,0x3da0af2a,0xbddcbd0d,0xbe94a031,0xbeece91a
.long 0x248d3132,0xbe47c5c2,0xbec3ef15,0xbf0e39da,0xbda0af2a,0xbe8fcefe,0xbef15aea,0xbf2456f1
.long 0xbe20305b,0xbeba9be1,0xbf0e39da,0xbf3889dc,0xbe6f0c4d,0xbee3f40d,0xbf226799,0xbf4a965e
.long 0xbe9e377a,0xbf05c277,0xbf3504f3,0xbf5a46a0,0xbec3ef15,0xbf187fc0,0xbf45e403,0xbf676bd8
.long 0xbee87171,0xbf2a0c73,0xbf54db31,0xbf71decf,0xbf05c277,0xbf3a4582,0xbf61c598,0xbf79805c
.long 0xbf167918,0xbf490a88,0xbf6c835e,0xbf7e39bc,0xbf26423a,0xbf563e03,0xbf74fa0b,0xbf7ffcd7
.long 0xbf3504f3,0xbf61c598,0xbf7b14be,0xbf7ec46d,0xbf42a9f7,0xbf6b8a3d,0xbf7ec46d,0xbf7a9421
.long 0xbe9e377a,0xbee87171,0xbf167918,0xbf3504f3,0xbed65a92,0xbf104f0e,0xbf316e2c,0xbf4d9f02
.long 0xbf05c277,0xbf2a0c73,0xbf490a88,0xbf61c598,0xbf1e7cf1,0xbf4105b8,0xbf5cdc29,0xbf710908
.long 0xbf3504f3,0xbf54db31,0xbf6c835e,0xbf7b14be,0xbf490a88,0xbf653a48,0xbf77b493,0xbf7fb10f
.long 0xbf5a46a0,0xbf71decf,0xbf7e39bc,0xbf7ec46d,0xbf687c12,0xbf7a9421,0xbf7ff35e,0xbf7853f8
.long 0xbf737871,0xbf7f35f9,0xbf7cd925,0xbf6c835e,0xbf7b14be,0xbf7fb10f,0xbf74fa0b,0xbf5b941a
.long 0xbf7f35f9,0xbf7c0361,0xbf687c12,0xbf45e403,0xbf7fcd79,0xbf743c41,0xbf579b8c,0xbf2beb4a
.long 0xbf7cd925,0xbf687c12,0xbf42a9f7,0xbf0e39da,0xbf766377,0xbf58f3c4,0xbf2a0c73,0xbedae880
.long 0xbf6c835e,0xbf45e403,0xbf0e39da,0xbe94a031,0xbf5f5be6,0xbf2f9c32,0xbedf7108,0xbe164083
.long 0x80000000,0xbe20305b,0xbe9e377a,0xbee87171,0x80000000,0xbe2a1c3f,0xbea7bf25,0xbef5c6c5
.long 0x80000000,0xbe3403f1,0xbeb13641,0xbf0172c3,0x80000000,0xbe3de731,0xbeba9be1,0xbf07e565
.long 0x80000000,0xbe47c5c2,0xbec3ef15,0xbf0e39da,0x80000000,0xbe519f65,0xbecd2ef3,0xbf146eba
.long 0x80000000,0xbe5b73dc,0xbed65a92,0xbf1a82a4,0x80000000,0xbe6542e9,0xbedf7108,0xbf207440
.long 0x80000000,0xbe6f0c4d,0xbee87171,0xbf26423a,0x80000000,0xbe78cfcc,0xbef15aea,0xbf2beb4a
.long 0x80000000,0xbe814693,0xbefa2c90,0xbf316e2c,0x80000000,0xbe862210,0xbf0172c3,0xbf36c9a9
.long 0x80000000,0xbe8afa3e,0xbf05c277,0xbf3bfc8f,0x80000000,0xbe8fcefe,0xbf0a04f8,0xbf4105b8
.long 0x80000000,0xbe94a031,0xbf0e39da,0xbf45e403,0x80000000,0xbe996dba,0xbf1260b2,0xbf4a965e
.long 0xbf167918,0xbf3504f3,0xbf4f1bbd,0xbf641901,0xbf1e7cf1,0xbf3daef9,0xbf579b8c,0xbf6b8a3d
.long 0xbf26423a,0xbf45e403,0xbf5f5be6,0xbf71decf,0xbf2dc5e3,0xbf4d9f02,0xbf6655e7,0xbf770f11
.long 0xbf3504f3,0xbf54db31,0xbf6c835e,0xbf7b14be,0xbf3bfc8f,0xbf5b941a,0xbf71decf,0xbf7deafa
.long 0xbf42a9f7,0xbf61c598,0xbf766377,0xbf7f8e56,0xbf490a88,0xbf676bd8,0xbf7a0d54,0xbf7ffcd7
.long 0xbf4f1bbd,0xbf6c835e,0xbf7cd925,0xbf7f35f9,0xbf54db31,0xbf710908,0xbf7ec46d,0xbf7d3aac
.long 0xbf5a46a0,0xbf74fa0b,0xbf7fcd79,0xbf7a0d54,0xbf5f5be6,0xbf7853f8,0xbf7ff35e,0xbf75b1c9
.long 0xbf641901,0xbf7b14be,0xbf7f35f9,0xbf702d4f,0xbf687c12,0xbf7d3aac,0xbf7d95f4,0xbf698690
.long 0xbf6c835e,0xbf7ec46d,0xbf7b14be,0xbf61c598,0xbf702d4f,0xbf7fb10f,0xbf77b493,0xbf58f3c4
.long 0xbf737871,0xbf7cd925,0xbf800000,0xbf7cd925,0xbf78ed3c,0xbf7f654e,0xbf7ec46d,0xbf770f11
.long 0xbf7cd925,0xbf7ff35e,0xbf7b14be,0xbf6e641a,0xbf7f35f9,0xbf7e8238,0xbf74fa0b,0xbf62f219
.long 0xbf800000,0xbf7b14be,0xbf6c835e,0xbf54db31,0xbf7f35f9,0xbf75b1c9,0xbf61c598,0xbf444969
.long 0xbf7cd925,0xbf6e641a,0xbf54db31,0xbf316e2c,0xbf78ed3c,0xbf653a48,0xbf45e403,0xbf1c81b9
.long 0xbf737871,0xbf5a46a0,0xbf3504f3,0xbf05c277,0xbf6c835e,0xbf4d9f02,0xbf226799,0xbedae880
.long 0xbf641901,0xbf3f5cb5,0xbf0e39da,0xbea7bf25,0xbf5a46a0,0xbf2f9c32,0xbef15aea,0xbe6542e9
.long 0xbf4f1bbd,0xbf1e7cf1,0xbec3ef15,0xbdf0b772,0xbf42a9f7,0xbf0c2124,0xbe94a031,0xbc20d8d2
.long 0xbf3504f3,0xbef15aea,0xbe47c5c2,0x3dc8bd36,0xbf26423a,0xbec8917e,0xbdc8bd36,0x3e519f65
.long 0xbf737871,0xbf641901,0xbf4f1bbd,0xbf3504f3,0xbf687c12,0xbf53731f,0xbf3889dc,0xbf187fc0
.long 0xbf5a46a0,0xbf3f5cb5,0xbf1e7cf1,0xbef15aea,0xbf490a88,0xbf28296a,0xbf0172c3,0xbeac7cd4
.long 0xbf3504f3,0xbf0e39da,0xbec3ef15,0xbe47c5c2,0xbf1e7cf1,0xbee3f40d,0xbe814693,0xbd48fb30
.long 0xbf05c277,0xbea7bf25,0xbdf0b772,0x3dc8bd36,0xbed65a92,0xbe519f65,0x3ca0d6d6,0x3e78cfcc
.long 0xbe9e377a,0xbda0af2a,0x3e20305b,0x3ec3ef15,0xbe47c5c2,0x3d48fb30,0x3e94a031,0x3f039c3d
.long 0xbda0af2a,0x3e3403f1,0x3ed65a92,0x3f226799,0x3d20cee7,0x3e996dba,0x3f0a04f8,0x3f3daef9
.long 0x3e20305b,0x3ed65a92,0x3f26423a,0x3f54db31,0x3e8afa3e,0x3f07e565,0x3f3f5cb5,0x3f676bd8
.long 0x3ec3ef15,0x3f226799,0x3f54db31,0x3f74fa0b,0x3efa2c90,0x3f3a4582,0x3f6655e7,0x3f7d3aac
.long 0x3f803f80,0x3f803f80,0x0,0x0,0x3f6d3f80,0x3ec43f35,0x3ec40000,0x3f6d3f35
.long 0x3f353f80,0xbf35248d,0x3f350000,0x3f353f80,0x3ec43f80,0xbf6dbf35,0x3f6d0000,0xbec43f35
.long 0x248d3f80,0xa554bf80,0x3f800000,0xbf80250d,0xbec43f80,0x3f6dbf35,0x3f6d0000,0xbec4bf35
.long 0xbf353f80,0x3f35a554,0x3f350000,0x3f35bf80,0xbf6d3f80,0xbec43f35,0x3ec40000,0x3f6dbf35
.long 0xbf803f80,0xbf803f80,0x250d0000,0x25d4a58d,0xbf6d3f80,0xbec43f35,0xbec40000,0xbf6d3f35
.long 0xbf353f80,0x3f3525b0,0xbf350000,0xbf353f80,0xbec43f80,0x3f6dbf35,0xbf6d0000,0x3ec43f35
.long 0xa5543f80,0x261fbf80,0xbf800000,0x3f8025d4,0x3ec43f80,0xbf6dbf35,0xbf6d0000,0x3ec4bf35
.long 0x3f353f80,0xbf35a5f7,0xbf350000,0xbf35bf80,0x3f6d3f80,0x3ec43f35,0xbec40000,0xbf6dbf35
.long 0x3f803f80,0x3f803f80,0x0,0x0,0xbec4248d,0xbf6dbf35,0x3f6d3f80,0x3ec43f35
.long 0xbf35bf80,0x3f35a554,0xbf35250d,0xbf35bf80,0x3f6da554,0xbec43f35,0xbec4bf80,0x3f6d3f35
.long 0x25b03f80,0xa5f7bf80,0x3f80a58d,0xbf8025d4,0xbf6d25b0,0x3ec43f35,0xbec43f80,0x3f6dbf35
.long 0x3f35bf80,0xbf35261f,0xbf3525d4,0xbf353f80,0x3ec4a5f7,0x3f6dbf35,0x3f6dbf80,0x3ec4bf35
.long 0xbf803f80,0xbf803f80,0x2630a60d,0x2677a654,0x3ec4261f,0x3f6dbf35,0xbf6d3f80,0xbec43f35
.long 0x3f35bf80,0xbf35a742,0x3f352630,0x3f35bf80,0xbf6da731,0x3ec43f35,0x3ec4bf80,0xbf6d3f35
.long 0xa7423f80,0xa60dbf80,0xbf80a654,0x3f80269f,0x3f6da68d,0xbec43f35,0x3ec43f80,0xbf6dbf35
.long 0xbf35bf80,0x3f35a60d,0x3f352677,0x3f353f80,0xbec4a742,0xbf6dbf35,0xbf6dbf80,0xbec4bf35
.long 0x3f803f80,0x3f803f80,0x0,0x0,0xbf6dbf80,0xbec4bf35,0xbec4250d,0xbf6dbf35
.long 0x3f353f80,0xbf3525b0,0x3f35a58d,0x3f353f80,0xbec4bf80,0x3f6d3f35,0xbf6d25d4,0x3ec4bf35
.long 0x261f3f80,0xa731bf80,0x3f80a60d,0xbf802630,0x3ec4bf80,0xbf6d3f35,0xbf6d2630,0x3ec43f35
.long 0xbf353f80,0x3f35a742,0x3f35a654,0x3f35bf80,0x3f6dbf80,0x3ec4bf35,0xbec42677,0xbf6d3f35
.long 0xbf803f80,0xbf803f80,0x269fa68d,0x27b1a6b0,0x3f6dbf80,0x3ec4bf35,0x3ec4269f,0x3f6dbf35
.long 0xbf353f80,0x3f35a58e,0xbf35a6b0,0xbf353f80,0x3ec4bf80,0xbf6d3f35,0x3f6d27b1,0xbec4bf35
.long 0xa7773f80,0x258dbf80,0xbf80a6d4,0x3f8027c2,0xbec4bf80,0x3f6d3f35,0x3f6da70d,0xbec43f35
.long 0x3f353f80,0xbf35a78d,0xbf35a6f7,0xbf35bf80,0xbf6dbf80,0xbec4bf35,0x3ec427c2,0x3f6d3f35
.long 0x3f803f80,0x3f803f80,0x0,0x0,0x3ec4a554,0x3f6d3f35,0xbf6dbf80,0xbec4bf35
.long 0xbf35bf80,0x3f35a5f7,0xbf3525d4,0xbf35bf80,0xbf6d261f,0x3ec4bf35,0x3ec43f80,0xbf6dbf35
.long 0xa68d3f80,0xa742bf80,0x3f80a654,0xbf802677,0x3f6da742,0xbec4bf35,0x3ec4bf80,0xbf6d3f35
.long 0x3f35bf80,0xbf35a60d,0xbf35269f,0xbf353f80,0xbec4a60d,0xbf6d3f35,0xbf6d3f80,0xbec43f35
.long 0xbf803f80,0xbf803f80,0xa70da6d4,0x27c2a6f7,0xbec4a777,0xbf6d3f35,0x3f6dbf80,0x3ec4bf35
.long 0x3f35bf80,0xbf35a78d,0x3f3527c2,0x3f35bf80,0x3f6d2804,0xbec4bf35,0xbec43f80,0x3f6dbf35
.long 0xa7963f80,0x268dbf80,0xbf80a71f,0x3f80a68d,0xbf6d2754,0x3ec4bf35,0xbec4bf80,0x3f6d3f35
.long 0xbf35bf80,0x3f352816,0x3f35a68d,0x3f353f80,0x3ec42889,0x3f6d3f35,0x3f6d3f80,0x3ec43f35
.long 0x80008000,0x80008000,0x3f803f80,0x3f803f80,0xbec48000,0xbf6dbf35,0x3f6d3f80,0x3ec43f35
.long 0xbf358000,0xbf35bf80,0x3f353f80,0xbf35248d,0xbf6d8000,0x3ec4bf35,0x3ec43f80,0xbf6dbf35
.long 0xbf808000,0x3f80a50d,0x248d3f80,0xa554bf80,0xbf6d8000,0x3ec43f35,0xbec43f80,0x3f6dbf35
.long 0xbf358000,0xbf353f80,0xbf353f80,0x3f35a554,0xbec48000,0xbf6d3f35,0xbf6d3f80,0xbec43f35
.long 0x250d0000,0x25d4a58d,0x3f80bf80,0x3f80bf80,0xbec40000,0xbf6d3f35,0x3f6dbf80,0x3ec4bf35
.long 0xbf350000,0xbf353f80,0x3f35bf80,0xbf35a5b0,0xbf6d0000,0x3ec43f35,0x3ec4bf80,0xbf6d3f35
.long 0xbf800000,0x3f8025d4,0x2554bf80,0xa61f3f80,0xbf6d0000,0x3ec4bf35,0xbec4bf80,0x3f6d3f35
.long 0xbf350000,0xbf35bf80,0xbf35bf80,0x3f3525f7,0xbec40000,0xbf6dbf35,0xbf6dbf80,0xbec4bf35
.long 0x80008000,0x80008000,0x3f803f80,0x3f803f80,0xbf6dbf80,0xbec4bf35,0xbec4248d,0xbf6dbf35
.long 0x3f35a50d,0x3f353f80,0xbf35bf80,0x3f35a554,0x3ec43f80,0xbf6dbf35,0x3f6da554,0xbec43f35
.long 0xbf80258d,0x3f80a5d4,0x25b03f80,0xa5f7bf80,0x3ec4bf80,0xbf6d3f35,0xbf6d25b0,0x3ec43f35
.long 0x3f35a5d4,0x3f35bf80,0x3f35bf80,0xbf35261f,0xbf6d3f80,0xbec43f35,0x3ec4a5f7,0x3f6dbf35
.long 0x2630a60d,0x2677a654,0x3f80bf80,0x3f80bf80,0xbf6d3f80,0xbec43f35,0xbec4a61f,0xbf6d3f35
.long 0x3f352630,0x3f35bf80,0xbf353f80,0x3f352742,0x3ec4bf80,0xbf6d3f35,0x3f6d2731,0xbec4bf35
.long 0xbf80a654,0x3f80269f,0x2742bf80,0x260d3f80,0x3ec43f80,0xbf6dbf35,0xbf6d268d,0x3ec4bf35
.long 0x3f352677,0x3f353f80,0x3f353f80,0xbf35260d,0xbf6dbf80,0xbec4bf35,0x3ec42742,0x3f6d3f35
.long 0x80008000,0x80008000,0x3f803f80,0x3f803f80,0x3ec4a50d,0x3f6d3f35,0xbf6dbf80,0xbec4bf35
.long 0xbf35258d,0xbf35bf80,0x3f353f80,0xbf3525b0,0x3f6da5d4,0xbec43f35,0xbec4bf80,0x3f6d3f35
.long 0xbf80260d,0x3f80a630,0x261f3f80,0xa731bf80,0x3f6da630,0xbec4bf35,0x3ec4bf80,0xbf6d3f35
.long 0xbf352654,0xbf353f80,0xbf353f80,0x3f35a742,0x3ec4a677,0x3f6dbf35,0x3f6dbf80,0x3ec4bf35
.long 0x269fa68d,0x27b1a6b0,0x3f80bf80,0x3f80bf80,0x3ec4269f,0x3f6dbf35,0xbf6d3f80,0xbec43f35
.long 0xbf35a6b0,0xbf353f80,0x3f35bf80,0xbf35258e,0x3f6d27b1,0xbec4bf35,0xbec43f80,0x3f6dbf35
.long 0xbf80a6d4,0x3f8027c2,0x2777bf80,0xa58d3f80,0x3f6da70d,0xbec43f35,0x3ec43f80,0xbf6dbf35
.long 0xbf35a6f7,0xbf35bf80,0xbf35bf80,0x3f35278d,0x3ec427c2,0x3f6d3f35,0x3f6d3f80,0x3ec43f35
.long 0x80008000,0x80008000,0x3f803f80,0x3f803f80,0x3f6d3f80,0x3ec43f35,0x3ec4a554,0x3f6d3f35
.long 0x3f35a5d4,0x3f353f80,0xbf35bf80,0x3f35a5f7,0xbec4bf80,0x3f6d3f35,0xbf6d261f,0x3ec4bf35
.long 0xbf802654,0x3f80a677,0xa68d3f80,0xa742bf80,0xbec43f80,0x3f6dbf35,0x3f6da742,0xbec4bf35
.long 0x3f35a69f,0x3f35bf80,0x3f35bf80,0xbf35a60d,0x3f6dbf80,0x3ec4bf35,0xbec4a60d,0xbf6d3f35
.long 0xa70da6d4,0x27c2a6f7,0x3f80bf80,0x3f80bf80,0x3f6dbf80,0x3ec4bf35,0x3ec42777,0x3f6dbf35
.long 0x3f3527c2,0x3f35bf80,0xbf353f80,0x3f35278d,0xbec43f80,0x3f6dbf35,0xbf6da804,0x3ec43f35
.long 0xbf80a71f,0x3f80a68d,0x2796bf80,0xa68d3f80,0xbec4bf80,0x3f6d3f35,0x3f6da754,0xbec43f35
.long 0x3f35a68d,0x3f353f80,0x3f353f80,0xbf35a816,0x3f6d3f80,0x3ec43f35,0xbec4a889,0xbf6dbf35
.long 0x3f803f80,0x3f803f80,0x3f803f80,0x3f803f80,0x3f7b3f80,0x3f553f6d,0xbf7bbf80,0xbf55bf6d
.long 0x3f6d3f80,0x3ec43f35,0x3f6d3f80,0x3ec43f35,0x3f553f80,0xbe483ec4,0xbf55bf80,0x3e48bec4
.long 0x3f353f80,0xbf35248d,0x3f353f80,0xbf35248d,0x3f0e3f80,0xbf7bbec4,0xbf0ebf80,0x3f7b3ec4
.long 0x3ec43f80,0xbf6dbf35,0x3ec43f80,0xbf6dbf35,0x3e483f80,0xbf0ebf6d,0xbe48bf80,0x3f0e3f6d
.long 0x248d3f80,0xa554bf80,0x248d3f80,0xa554bf80,0xbe483f80,0x3f0ebf6d,0x3e48bf80,0xbf0e3f6d
.long 0xbec43f80,0x3f6dbf35,0xbec43f80,0x3f6dbf35,0xbf0e3f80,0x3f7bbec4,0x3f0ebf80,0xbf7b3ec4
.long 0xbf353f80,0x3f35a554,0xbf353f80,0x3f35a554,0xbf553f80,0x3e483ec4,0x3f55bf80,0xbe48bec4
.long 0xbf6d3f80,0xbec43f35,0xbf6d3f80,0xbec43f35,0xbf7b3f80,0xbf553f6d,0x3f7bbf80,0x3f55bf6d
.long 0x3f803f80,0x3f803f80,0x3f803f80,0x3f803f80,0x3f0e3f35,0x3e483ec4,0xbf0ebf35,0xbe48bec4
.long 0xbec4248d,0xbf6dbf35,0xbec4248d,0xbf6dbf35,0xbf7bbf35,0xbf0ebf6d,0x3f7b3f35,0x3f0e3f6d
.long 0xbf35bf80,0x3f35a554,0xbf35bf80,0x3f35a554,0x3e48bf35,0x3f553f6d,0xbe483f35,0xbf55bf6d
.long 0x3f6da554,0xbec43f35,0x3f6da554,0xbec43f35,0x3f553f35,0xbf7bbec4,0xbf55bf35,0x3f7b3ec4
.long 0x248d3f80,0xa554bf80,0x248d3f80,0xa554bf80,0xbf553f35,0x3f7bbec4,0x3f55bf35,0xbf7b3ec4
.long 0xbf6d248d,0x3ec43f35,0xbf6d248d,0x3ec43f35,0xbe48bf35,0xbf553f6d,0x3e483f35,0x3f55bf6d
.long 0x3f35bf80,0xbf35248d,0x3f35bf80,0xbf35248d,0x3f7bbf35,0x3f0ebf6d,0xbf7b3f35,0xbf0e3f6d
.long 0x3ec4a554,0x3f6dbf35,0x3ec4a554,0x3f6dbf35,0xbf0e3f35,0xbe483ec4,0x3f0ebf35,0x3e48bec4
.long 0x3f803f80,0x3f803f80,0x3f803f80,0x3f803f80,0xbe48248d,0xbf0ebec4,0x3e48a554,0x3f0e3ec4
.long 0xbf6dbf80,0xbec4bf35,0xbf6dbf80,0xbec4bf35,0x3f0ea554,0x3f7b3f6d,0xbf0e248d,0xbf7bbf6d
.long 0x3f353f80,0xbf35248d,0x3f353f80,0xbf35248d,0xbf55248d,0xbe48bf6d,0x3f55a554,0x3e483f6d
.long 0xbec4bf80,0x3f6d3f35,0xbec4bf80,0x3f6d3f35,0x3f7ba554,0xbf553ec4,0xbf7b248d,0x3f55bec4
.long 0x248d3f80,0xa554bf80,0x248d3f80,0xa554bf80,0xbf7b248d,0x3f553ec4,0x3f7ba554,0xbf55bec4
.long 0x3ec4bf80,0xbf6d3f35,0x3ec4bf80,0xbf6d3f35,0x3f55a554,0x3e48bf6d,0xbf55248d,0xbe483f6d
.long 0xbf353f80,0x3f35a554,0xbf353f80,0x3f35a554,0xbf0e248d,0xbf7b3f6d,0x3f0ea554,0x3f7bbf6d
.long 0x3f6dbf80,0x3ec4bf35,0x3f6dbf80,0x3ec4bf35,0x3e48a554,0x3f0ebec4,0xbe48248d,0xbf0e3ec4
.long 0x3f803f80,0x3f803f80,0x3f803f80,0x3f803f80,0xbf55bf35,0xbf7bbf6d,0x3f553f35,0x3f7b3f6d
.long 0x3ec4a554,0x3f6d3f35,0x3ec4a554,0x3f6d3f35,0x3e483f35,0xbf55bec4,0xbe48bf35,0x3f553ec4
.long 0xbf35bf80,0x3f35a554,0xbf35bf80,0x3f35a554,0x3f7b3f35,0xbf0e3ec4,0xbf7bbf35,0x3f0ebec4
.long 0xbf6d248d,0x3ec4bf35,0xbf6d248d,0x3ec4bf35,0x3f0ebf35,0xbe483f6d,0xbf0e3f35,0x3e48bf6d
.long 0x248d3f80,0xa554bf80,0x248d3f80,0xa554bf80,0xbf0ebf35,0x3e483f6d,0x3f0e3f35,0xbe48bf6d
.long 0x3f6da554,0xbec4bf35,0x3f6da554,0xbec4bf35,0xbf7b3f35,0x3f0e3ec4,0x3f7bbf35,0xbf0ebec4
.long 0x3f35bf80,0xbf35248d,0x3f35bf80,0xbf35248d,0xbe483f35,0x3f55bec4,0x3e48bf35,0xbf553ec4
.long 0xbec4248d,0xbf6d3f35,0xbec4248d,0xbf6d3f35,0x3f55bf35,0x3f7bbf6d,0xbf553f35,0xbf7b3f6d
.long 0x3f803f80,0x3f803f80,0x3f803f80,0x3f803f80,0x3f753f7f,0x3f463f62,0xbf75bf7f,0xbf46bf62
.long 0x3f553f7b,0x3e483f0e,0x3f553f7b,0x3e483f0e,0x3f223f75,0xbef13dc9,0xbf22bf75,0x3ef1bdc9
.long 0x3ec43f6d,0xbf6dbec4,0x3ec43f6d,0xbf6dbec4,0x3dc93f62,0xbf75bf46,0xbdc9bf62,0x3f753f46
.long 0xbe483f55,0xbf0ebf7b,0xbe483f55,0xbf0ebf7b,0xbef13f46,0x3dc9bf75,0x3ef1bf46,0xbdc93f75
.long 0xbf353f35,0x3f35bf35,0xbf353f35,0x3f35bf35,0xbf623f22,0x3f7fbe95,0x3f62bf22,0xbf7f3e95
.long 0xbf7b3f0e,0x3f553e48,0xbf7b3f0e,0x3f553e48,0xbf7f3ef1,0x3e953f22,0x3f7fbef1,0xbe95bf22
.long 0xbf6d3ec4,0xbec43f6d,0xbf6d3ec4,0xbec43f6d,0xbf463e95,0xbf623f7f,0x3f46be95,0x3f62bf7f
.long 0xbf0e3e48,0xbf7b3f55,0xbf0e3e48,0xbf7b3f55,0xbe953dc9,0xbf223ef1,0x3e95bdc9,0x3f22bef1
.long 0x3f803f80,0x3f803f80,0x3f803f80,0x3f803f80,0x3ef13f22,0x3dc93e95,0xbef1bf22,0xbdc9be95
.long 0xbf0ebe48,0xbf7bbf55,0xbf0ebe48,0xbf7bbf55,0xbf7fbf62,0xbe95bf46,0x3f7f3f62,0x3e953f46
.long 0xbec4bf6d,0x3f6d3ec4,0xbec4bf6d,0x3f6d3ec4,0x3f22be95,0x3ef13f7f,0xbf223e95,0xbef1bf7f
.long 0x3f7b3f0e,0xbf553e48,0x3f7b3f0e,0xbf553e48,0x3e953f7f,0xbf22bf62,0xbe95bf7f,0x3f223f62
.long 0xbf353f35,0x3f35bf35,0xbf353f35,0x3f35bf35,0xbf75bdc9,0x3f463ef1,0x3f753dc9,0xbf46bef1
.long 0xbe48bf55,0xbf0e3f7b,0xbe48bf55,0xbf0e3f7b,0x3f46bf75,0xbf623dc9,0xbf463f75,0x3f62bdc9
.long 0x3f6dbec4,0x3ec4bf6d,0x3f6dbec4,0x3ec4bf6d,0x3dc93ef1,0x3f75bf22,0xbdc9bef1,0xbf753f22
.long 0xbf553f7b,0xbe483f0e,0xbf553f7b,0xbe483f0e,0xbf623f46,0xbf7f3f75,0x3f62bf46,0x3f7fbf75
.long 0x3f803f80,0x3f803f80,0x3f803f80,0x3f803f80,0xbe95bdc9,0xbf22bef1,0x3e953dc9,0x3f223ef1
.long 0xbf55bf7b,0xbe48bf0e,0xbf55bf7b,0xbe48bf0e,0x3f463e95,0x3f623f7f,0xbf46be95,0xbf62bf7f
.long 0x3ec43f6d,0xbf6dbec4,0x3ec43f6d,0xbf6dbec4,0xbf7fbef1,0x3e95bf22,0x3f7f3ef1,0xbe953f22
.long 0x3e48bf55,0x3f0e3f7b,0x3e48bf55,0x3f0e3f7b,0x3f623f22,0xbf7fbe95,0xbf62bf22,0x3f7f3e95
.long 0xbf353f35,0x3f35bf35,0xbf353f35,0x3f35bf35,0xbef1bf46,0x3dc93f75,0x3ef13f46,0xbdc9bf75
.long 0x3f7bbf0e,0xbf55be48,0x3f7bbf0e,0xbf55be48,0xbdc93f62,0x3f75bf46,0x3dc9bf62,0xbf753f46
.long 0xbf6d3ec4,0xbec43f6d,0xbf6d3ec4,0xbec43f6d,0x3f22bf75,0xbef1bdc9,0xbf223f75,0x3ef13dc9
.long 0x3f0ebe48,0x3f7bbf55,0x3f0ebe48,0x3f7bbf55,0xbf753f7f,0xbf463f62,0x3f75bf7f,0x3f46bf62
.long 0x3f803f80,0x3f803f80,0x3f803f80,0x3f803f80,0xbf62bf46,0xbf7fbf75,0x3f623f46,0x3f7f3f75
.long 0x3f0e3e48,0x3f7b3f55,0x3f0e3e48,0x3f7b3f55,0xbdc93ef1,0xbf75bf22,0x3dc9bef1,0x3f753f22
.long 0xbec4bf6d,0x3f6d3ec4,0xbec4bf6d,0x3f6d3ec4,0x3f463f75,0xbf62bdc9,0xbf46bf75,0x3f623dc9
.long 0xbf7bbf0e,0x3f55be48,0xbf7bbf0e,0x3f55be48,0x3f75bdc9,0xbf463ef1,0xbf753dc9,0x3f46bef1
.long 0xbf353f35,0x3f35bf35,0xbf353f35,0x3f35bf35,0x3e95bf7f,0xbf223f62,0xbe953f7f,0x3f22bf62
.long 0x3e483f55,0x3f0ebf7b,0x3e483f55,0x3f0ebf7b,0xbf22be95,0xbef13f7f,0x3f223e95,0x3ef1bf7f
.long 0x3f6dbec4,0x3ec4bf6d,0x3f6dbec4,0x3ec4bf6d,0xbf7f3f62,0xbe953f46,0x3f7fbf62,0x3e95bf46
.long 0x3f55bf7b,0x3e48bf0e,0x3f55bf7b,0x3e48bf0e,0xbef13f22,0xbdc93e95,0x3ef1bf22,0x3dc9be95
.long 0xbf803f80,0xbf803f80,0xbf803f80,0xbf803f80,0xbf7b3f80,0xbf553f6d,0x3f7bbf80,0x3f55bf6d
.long 0xbf6d3f80,0xbec43f35,0xbf6d3f80,0xbec43f35,0xbf553f80,0x3e483ec4,0x3f55bf80,0xbe48bec4
.long 0xbf353f80,0x3f35248d,0xbf353f80,0x3f35248d,0xbf0e3f80,0x3f7bbec4,0x3f0ebf80,0xbf7b3ec4
.long 0xbec43f80,0x3f6dbf35,0xbec43f80,0x3f6dbf35,0xbe483f80,0x3f0ebf6d,0x3e48bf80,0xbf0e3f6d
.long 0xa5543f80,0x248dbf80,0xa5543f80,0x248dbf80,0x3e483f80,0xbf0ebf6d,0xbe48bf80,0x3f0e3f6d
.long 0x3ec43f80,0xbf6dbf35,0x3ec43f80,0xbf6dbf35,0x3f0e3f80,0xbf7bbec4,0xbf0ebf80,0x3f7b3ec4
.long 0x3f353f80,0xbf35a554,0x3f353f80,0xbf35a554,0x3f553f80,0xbe483ec4,0xbf55bf80,0x3e48bec4
.long 0x3f6d3f80,0x3ec43f35,0x3f6d3f80,0x3ec43f35,0x3f7b3f80,0x3f553f6d,0xbf7bbf80,0xbf55bf6d
.long 0xbf803f80,0xbf803f80,0xbf803f80,0xbf803f80,0xbf0e3f35,0xbe483ec4,0x3f0ebf35,0x3e48bec4
.long 0x3ec4248d,0x3f6dbf35,0x3ec4248d,0x3f6dbf35,0x3f7bbf35,0x3f0ebf6d,0xbf7b3f35,0xbf0e3f6d
.long 0x3f35bf80,0xbf35a554,0x3f35bf80,0xbf35a554,0xbe48bf35,0xbf553f6d,0x3e483f35,0x3f55bf6d
.long 0xbf6da554,0x3ec43f35,0xbf6da554,0x3ec43f35,0xbf553f35,0x3f7bbec4,0x3f55bf35,0xbf7b3ec4
.long 0xa5543f80,0x248dbf80,0xa5543f80,0x248dbf80,0x3f553f35,0xbf7bbec4,0xbf55bf35,0x3f7b3ec4
.long 0x3f6d248d,0xbec43f35,0x3f6d248d,0xbec43f35,0x3e48bf35,0x3f553f6d,0xbe483f35,0xbf55bf6d
.long 0xbf35bf80,0x3f35248d,0xbf35bf80,0x3f35248d,0xbf7bbf35,0xbf0ebf6d,0x3f7b3f35,0x3f0e3f6d
.long 0xbec4a554,0xbf6dbf35,0xbec4a554,0xbf6dbf35,0x3f0e3f35,0x3e483ec4,0xbf0ebf35,0xbe48bec4
.long 0xbf803f80,0xbf803f80,0xbf803f80,0xbf803f80,0x3e48248d,0x3f0ebec4,0xbe48a554,0xbf0e3ec4
.long 0x3f6dbf80,0x3ec4bf35,0x3f6dbf80,0x3ec4bf35,0xbf0ea554,0xbf7b3f6d,0x3f0e248d,0x3f7bbf6d
.long 0xbf353f80,0x3f35248d,0xbf353f80,0x3f35248d,0x3f55248d,0x3e48bf6d,0xbf55a554,0xbe483f6d
.long 0x3ec4bf80,0xbf6d3f35,0x3ec4bf80,0xbf6d3f35,0xbf7ba554,0x3f553ec4,0x3f7b248d,0xbf55bec4
.long 0xa5543f80,0x248dbf80,0xa5543f80,0x248dbf80,0x3f7b248d,0xbf553ec4,0xbf7ba554,0x3f55bec4
.long 0xbec4bf80,0x3f6d3f35,0xbec4bf80,0x3f6d3f35,0xbf55a554,0xbe48bf6d,0x3f55248d,0x3e483f6d
.long 0x3f353f80,0xbf35a554,0x3f353f80,0xbf35a554,0x3f0e248d,0x3f7b3f6d,0xbf0ea554,0xbf7bbf6d
.long 0xbf6dbf80,0xbec4bf35,0xbf6dbf80,0xbec4bf35,0xbe48a554,0xbf0ebec4,0x3e48248d,0x3f0e3ec4
.long 0xbf803f80,0xbf803f80,0xbf803f80,0xbf803f80,0x3f55bf35,0x3f7bbf6d,0xbf553f35,0xbf7b3f6d
.long 0xbec4a554,0xbf6d3f35,0xbec4a554,0xbf6d3f35,0xbe483f35,0x3f55bec4,0x3e48bf35,0xbf553ec4
.long 0x3f35bf80,0xbf35a554,0x3f35bf80,0xbf35a554,0xbf7b3f35,0x3f0e3ec4,0x3f7bbf35,0xbf0ebec4
.long 0x3f6d248d,0xbec4bf35,0x3f6d248d,0xbec4bf35,0xbf0ebf35,0x3e483f6d,0x3f0e3f35,0xbe48bf6d
.long 0xa5543f80,0x248dbf80,0xa5543f80,0x248dbf80,0x3f0ebf35,0xbe483f6d,0xbf0e3f35,0x3e48bf6d
.long 0xbf6da554,0x3ec4bf35,0xbf6da554,0x3ec4bf35,0x3f7b3f35,0xbf0e3ec4,0xbf7bbf35,0x3f0ebec4
.long 0xbf35bf80,0x3f35248d,0xbf35bf80,0x3f35248d,0x3e483f35,0xbf55bec4,0xbe48bf35,0x3f553ec4
.long 0x3ec4248d,0x3f6d3f35,0x3ec4248d,0x3f6d3f35,0xbf55bf35,0xbf7bbf6d,0x3f553f35,0x3f7b3f6d
.long 0xa554248d,0xa554248d,0xa554248d,0xa554248d,0x3e95bdc9,0x3f22bef1,0xbe953dc9,0xbf223ef1
.long 0x3f0ebe48,0x3f7bbf55,0x3f0ebe48,0x3f7bbf55,0x3f46be95,0x3f62bf7f,0xbf463e95,0xbf623f7f
.long 0x3f6dbec4,0x3ec4bf6d,0x3f6dbec4,0x3ec4bf6d,0x3f7fbef1,0xbe95bf22,0xbf7f3ef1,0x3e953f22
.long 0x3f7bbf0e,0xbf55be48,0x3f7bbf0e,0xbf55be48,0x3f62bf22,0xbf7f3e95,0xbf623f22,0x3f7fbe95
.long 0x3f35bf35,0xbf353f35,0x3f35bf35,0xbf353f35,0x3ef1bf46,0xbdc93f75,0xbef13f46,0x3dc9bf75
.long 0x3e48bf55,0x3f0e3f7b,0x3e48bf55,0x3f0e3f7b,0xbdc9bf62,0x3f753f46,0x3dc93f62,0xbf75bf46
.long 0xbec4bf6d,0x3f6d3ec4,0xbec4bf6d,0x3f6d3ec4,0xbf22bf75,0x3ef1bdc9,0x3f223f75,0xbef13dc9
.long 0xbf55bf7b,0xbe48bf0e,0xbf55bf7b,0xbe48bf0e,0xbf75bf7f,0xbf46bf62,0x3f753f7f,0x3f463f62
.long 0xa554248d,0xa554248d,0xa554248d,0xa554248d,0x3f62bf46,0x3f7fbf75,0xbf623f46,0xbf7f3f75
.long 0x3f55bf7b,0x3e48bf0e,0x3f55bf7b,0x3e48bf0e,0xbdc9bef1,0xbf753f22,0x3dc93ef1,0x3f75bf22
.long 0xbf6d3ec4,0xbec43f6d,0xbf6d3ec4,0xbec43f6d,0xbf463f75,0x3f62bdc9,0x3f46bf75,0xbf623dc9
.long 0x3e483f55,0x3f0ebf7b,0x3e483f55,0x3f0ebf7b,0x3f753dc9,0xbf46bef1,0xbf75bdc9,0x3f463ef1
.long 0x3f35bf35,0xbf353f35,0x3f35bf35,0xbf353f35,0xbe95bf7f,0x3f223f62,0x3e953f7f,0xbf22bf62
.long 0xbf7bbf0e,0x3f55be48,0xbf7bbf0e,0x3f55be48,0xbf223e95,0xbef1bf7f,0x3f22be95,0x3ef13f7f
.long 0x3ec43f6d,0xbf6dbec4,0x3ec43f6d,0xbf6dbec4,0x3f7f3f62,0x3e953f46,0xbf7fbf62,0xbe95bf46
.long 0x3f0e3e48,0x3f7b3f55,0x3f0e3e48,0x3f7b3f55,0xbef1bf22,0xbdc9be95,0x3ef13f22,0x3dc93e95
.long 0xa554248d,0xa554248d,0xa554248d,0xa554248d,0x3f75bf7f,0x3f46bf62,0xbf753f7f,0xbf463f62
.long 0xbf0e3e48,0xbf7b3f55,0xbf0e3e48,0xbf7b3f55,0xbf223f75,0x3ef13dc9,0x3f22bf75,0xbef1bdc9
.long 0x3f6dbec4,0x3ec4bf6d,0x3f6dbec4,0x3ec4bf6d,0x3dc9bf62,0xbf753f46,0xbdc93f62,0x3f75bf46
.long 0xbf7b3f0e,0x3f553e48,0xbf7b3f0e,0x3f553e48,0x3ef13f46,0xbdc9bf75,0xbef1bf46,0x3dc93f75
.long 0x3f35bf35,0xbf353f35,0x3f35bf35,0xbf353f35,0xbf62bf22,0x3f7f3e95,0x3f623f22,0xbf7fbe95
.long 0xbe483f55,0xbf0ebf7b,0xbe483f55,0xbf0ebf7b,0x3f7f3ef1,0xbe953f22,0xbf7fbef1,0x3e95bf22
.long 0xbec4bf6d,0x3f6d3ec4,0xbec4bf6d,0x3f6d3ec4,0xbf46be95,0xbf62bf7f,0x3f463e95,0x3f623f7f
.long 0x3f553f7b,0x3e483f0e,0x3f553f7b,0x3e483f0e,0x3e953dc9,0x3f223ef1,0xbe95bdc9,0xbf22bef1
.long 0xa554248d,0xa554248d,0xa554248d,0xa554248d,0x3ef1bf22,0x3dc9be95,0xbef13f22,0xbdc93e95
.long 0xbf553f7b,0xbe483f0e,0xbf553f7b,0xbe483f0e,0x3f7fbf62,0x3e95bf46,0xbf7f3f62,0xbe953f46
.long 0xbf6d3ec4,0xbec43f6d,0xbf6d3ec4,0xbec43f6d,0x3f223e95,0x3ef1bf7f,0xbf22be95,0xbef13f7f
.long 0xbe48bf55,0xbf0e3f7b,0xbe48bf55,0xbf0e3f7b,0xbe953f7f,0x3f22bf62,0x3e95bf7f,0xbf223f62
.long 0x3f35bf35,0xbf353f35,0x3f35bf35,0xbf353f35,0xbf753dc9,0x3f46bef1,0x3f75bdc9,0xbf463ef1
.long 0x3f7b3f0e,0xbf553e48,0x3f7b3f0e,0xbf553e48,0xbf46bf75,0x3f623dc9,0x3f463f75,0xbf62bdc9
.long 0x3ec43f6d,0xbf6dbec4,0x3ec43f6d,0xbf6dbec4,0x3dc9bef1,0x3f753f22,0xbdc93ef1,0xbf75bf22
.long 0xbf0ebe48,0xbf7bbf55,0xbf0ebe48,0xbf7bbf55,0x3f623f46,0x3f7f3f75,0xbf62bf46,0xbf7fbf75
.long 0x0,0x0,0x0,0x0,0x3e480000,0x3f0e3ec4,0xbe48250d,0xbf0ebec4
.long 0x3ec40000,0x3f6d3f35,0x3ec40000,0x3f6d3f35,0x3f0e0000,0x3f7b3f6d,0xbf0e250d,0xbf7bbf6d
.long 0x3f350000,0x3f353f80,0x3f350000,0x3f353f80,0x3f550000,0x3e483f6d,0xbf55250d,0xbe48bf6d
.long 0x3f6d0000,0xbec43f35,0x3f6d0000,0xbec43f35,0x3f7b0000,0xbf553ec4,0xbf7b250d,0x3f55bec4
.long 0x3f800000,0xbf80250d,0x3f800000,0xbf80250d,0x3f7b0000,0xbf55bec4,0xbf7b250d,0x3f553ec4
.long 0x3f6d0000,0xbec4bf35,0x3f6d0000,0xbec4bf35,0x3f550000,0x3e48bf6d,0xbf55250d,0xbe483f6d
.long 0x3f350000,0x3f35bf80,0x3f350000,0x3f35bf80,0x3f0e0000,0x3f7bbf6d,0xbf0e250d,0xbf7b3f6d
.long 0x3ec40000,0x3f6dbf35,0x3ec40000,0x3f6dbf35,0x3e480000,0x3f0ebec4,0xbe48250d,0xbf0e3ec4
.long 0x0,0x0,0x0,0x0,0x3f553f35,0x3f7b3f6d,0xbf55bf35,0xbf7bbf6d
.long 0x3f6d3f80,0x3ec43f35,0x3f6d3f80,0x3ec43f35,0x3e483f35,0xbf55bec4,0xbe48bf35,0x3f553ec4
.long 0xbf35250d,0xbf35bf80,0xbf35250d,0xbf35bf80,0xbf7bbf35,0x3f0ebec4,0x3f7b3f35,0xbf0e3ec4
.long 0xbec4bf80,0x3f6d3f35,0xbec4bf80,0x3f6d3f35,0x3f0ebf35,0xbe483f6d,0xbf0e3f35,0x3e48bf6d
.long 0x3f800000,0xbf80250d,0x3f800000,0xbf80250d,0x3f0e3f35,0xbe48bf6d,0xbf0ebf35,0x3e483f6d
.long 0xbec43f80,0x3f6dbf35,0xbec43f80,0x3f6dbf35,0xbf7b3f35,0x3f0e3ec4,0x3f7bbf35,0xbf0ebec4
.long 0xbf35250d,0xbf353f80,0xbf35250d,0xbf353f80,0x3e48bf35,0xbf553ec4,0xbe483f35,0x3f55bec4
.long 0x3f6dbf80,0x3ec4bf35,0x3f6dbf80,0x3ec4bf35,0x3f55bf35,0x3f7bbf6d,0xbf553f35,0xbf7b3f6d
.long 0x0,0x0,0x0,0x0,0x3f7b3f80,0x3f553f6d,0xbf7bbf80,0xbf55bf6d
.long 0xbec4250d,0xbf6dbf35,0xbec4250d,0xbf6dbf35,0xbf55bf80,0x3e48bec4,0x3f553f80,0xbe483ec4
.long 0x3f350000,0x3f353f80,0x3f350000,0x3f353f80,0x3f0e3f80,0xbf7bbec4,0xbf0ebf80,0x3f7b3ec4
.long 0xbf6d250d,0x3ec4bf35,0xbf6d250d,0x3ec4bf35,0xbe48bf80,0x3f0e3f6d,0x3e483f80,0xbf0ebf6d
.long 0x3f800000,0xbf80250d,0x3f800000,0xbf80250d,0xbe483f80,0x3f0ebf6d,0x3e48bf80,0xbf0e3f6d
.long 0xbf6d250d,0x3ec43f35,0xbf6d250d,0x3ec43f35,0x3f0ebf80,0xbf7b3ec4,0xbf0e3f80,0x3f7bbec4
.long 0x3f350000,0x3f35bf80,0x3f350000,0x3f35bf80,0xbf553f80,0x3e483ec4,0x3f55bf80,0xbe48bec4
.long 0xbec4250d,0xbf6d3f35,0xbec4250d,0xbf6d3f35,0x3f7bbf80,0x3f55bf6d,0xbf7b3f80,0xbf553f6d
.long 0x0,0x0,0x0,0x0,0x3f0e3f35,0x3e483ec4,0xbf0ebf35,0xbe48bec4
.long 0xbf6dbf80,0xbec4bf35,0xbf6dbf80,0xbec4bf35,0x3f7b3f35,0x3f0e3f6d,0xbf7bbf35,0xbf0ebf6d
.long 0xbf35250d,0xbf35bf80,0xbf35250d,0xbf35bf80,0x3e48bf35,0x3f553f6d,0xbe483f35,0xbf55bf6d
.long 0x3ec43f80,0xbf6dbf35,0x3ec43f80,0xbf6dbf35,0xbf55bf35,0x3f7b3ec4,0x3f553f35,0xbf7bbec4
.long 0x3f800000,0xbf80250d,0x3f800000,0xbf80250d,0xbf553f35,0x3f7bbec4,0x3f55bf35,0xbf7b3ec4
.long 0x3ec4bf80,0xbf6d3f35,0x3ec4bf80,0xbf6d3f35,0x3e483f35,0x3f55bf6d,0xbe48bf35,0xbf553f6d
.long 0xbf35250d,0xbf353f80,0xbf35250d,0xbf353f80,0x3f7bbf35,0x3f0ebf6d,0xbf7b3f35,0xbf0e3f6d
.long 0xbf6d3f80,0xbec43f35,0xbf6d3f80,0xbec43f35,0x3f0ebf35,0x3e48bec4,0xbf0e3f35,0xbe483ec4
.long 0x0,0x0,0x0,0x0,0x3e953dc9,0x3f223ef1,0xbe95bdc9,0xbf22bef1
.long 0x3f0e3e48,0x3f7b3f55,0x3f0e3e48,0x3f7b3f55,0x3f463e95,0x3f623f7f,0xbf46be95,0xbf62bf7f
.long 0x3f6d3ec4,0x3ec43f6d,0x3f6d3ec4,0x3ec43f6d,0x3f7f3ef1,0xbe953f22,0xbf7fbef1,0x3e95bf22
.long 0x3f7b3f0e,0xbf553e48,0x3f7b3f0e,0xbf553e48,0x3f623f22,0xbf7fbe95,0xbf62bf22,0x3f7f3e95
.long 0x3f353f35,0xbf35bf35,0x3f353f35,0xbf35bf35,0x3ef13f46,0xbdc9bf75,0xbef1bf46,0x3dc93f75
.long 0x3e483f55,0x3f0ebf7b,0x3e483f55,0x3f0ebf7b,0xbdc93f62,0x3f75bf46,0x3dc9bf62,0xbf753f46
.long 0xbec43f6d,0x3f6dbec4,0xbec43f6d,0x3f6dbec4,0xbf223f75,0x3ef13dc9,0x3f22bf75,0xbef1bdc9
.long 0xbf553f7b,0xbe483f0e,0xbf553f7b,0xbe483f0e,0xbf753f7f,0xbf463f62,0x3f75bf7f,0x3f46bf62
.long 0x0,0x0,0x0,0x0,0x3f623f46,0x3f7f3f75,0xbf62bf46,0xbf7fbf75
.long 0x3f553f7b,0x3e483f0e,0x3f553f7b,0x3e483f0e,0xbdc93ef1,0xbf75bf22,0x3dc9bef1,0x3f753f22
.long 0xbf6dbec4,0xbec4bf6d,0xbf6dbec4,0xbec4bf6d,0xbf46bf75,0x3f623dc9,0x3f463f75,0xbf62bdc9
.long 0x3e48bf55,0x3f0e3f7b,0x3e48bf55,0x3f0e3f7b,0x3f75bdc9,0xbf463ef1,0xbf753dc9,0x3f46bef1
.long 0x3f353f35,0xbf35bf35,0x3f353f35,0xbf35bf35,0xbe953f7f,0x3f22bf62,0x3e95bf7f,0xbf223f62
.long 0xbf7b3f0e,0x3f553e48,0xbf7b3f0e,0x3f553e48,0xbf22be95,0xbef13f7f,0x3f223e95,0x3ef1bf7f
.long 0x3ec4bf6d,0xbf6d3ec4,0x3ec4bf6d,0xbf6d3ec4,0x3f7fbf62,0x3e95bf46,0xbf7f3f62,0xbe953f46
.long 0x3f0ebe48,0x3f7bbf55,0x3f0ebe48,0x3f7bbf55,0xbef13f22,0xbdc93e95,0x3ef1bf22,0x3dc9be95
.long 0x0,0x0,0x0,0x0,0x3f753f7f,0x3f463f62,0xbf75bf7f,0xbf46bf62
.long 0xbf0ebe48,0xbf7bbf55,0xbf0ebe48,0xbf7bbf55,0xbf22bf75,0x3ef1bdc9,0x3f223f75,0xbef13dc9
.long 0x3f6d3ec4,0x3ec43f6d,0x3f6d3ec4,0x3ec43f6d,0x3dc93f62,0xbf75bf46,0xbdc9bf62,0x3f753f46
.long 0xbf7bbf0e,0x3f55be48,0xbf7bbf0e,0x3f55be48,0x3ef1bf46,0xbdc93f75,0xbef13f46,0x3dc9bf75
.long 0x3f353f35,0xbf35bf35,0x3f353f35,0xbf35bf35,0xbf623f22,0x3f7fbe95,0x3f62bf22,0xbf7f3e95
.long 0xbe48bf55,0xbf0e3f7b,0xbe48bf55,0xbf0e3f7b,0x3f7fbef1,0xbe95bf22,0xbf7f3ef1,0x3e953f22
.long 0xbec43f6d,0x3f6dbec4,0xbec43f6d,0x3f6dbec4,0xbf463e95,0xbf623f7f,0x3f46be95,0x3f62bf7f
.long 0x3f55bf7b,0x3e48bf0e,0x3f55bf7b,0x3e48bf0e,0x3e95bdc9,0x3f22bef1,0xbe953dc9,0xbf223ef1
.long 0x0,0x0,0x0,0x0,0x3ef13f22,0x3dc93e95,0xbef1bf22,0xbdc9be95
.long 0xbf55bf7b,0xbe48bf0e,0xbf55bf7b,0xbe48bf0e,0x3f7f3f62,0x3e953f46,0xbf7fbf62,0xbe95bf46
.long 0xbf6dbec4,0xbec4bf6d,0xbf6dbec4,0xbec4bf6d,0x3f22be95,0x3ef13f7f,0xbf223e95,0xbef1bf7f
.long 0xbe483f55,0xbf0ebf7b,0xbe483f55,0xbf0ebf7b,0xbe95bf7f,0x3f223f62,0x3e953f7f,0xbf22bf62
.long 0x3f353f35,0xbf35bf35,0x3f353f35,0xbf35bf35,0xbf75bdc9,0x3f463ef1,0x3f753dc9,0xbf46bef1
.long 0x3f7bbf0e,0xbf55be48,0x3f7bbf0e,0xbf55be48,0xbf463f75,0x3f62bdc9,0x3f46bf75,0xbf623dc9
.long 0x3ec4bf6d,0xbf6d3ec4,0x3ec4bf6d,0xbf6d3ec4,0x3dc93ef1,0x3f75bf22,0xbdc9bef1,0xbf753f22
.long 0xbf0e3e48,0xbf7b3f55,0xbf0e3e48,0xbf7b3f55,0x3f62bf46,0x3f7fbf75,0xbf623f46,0xbf7f3f75
.long 0x250d0000,0x250d0000,0x250d0000,0x250d0000,0xbe480000,0xbf0e3ec4,0x3e48250d,0x3f0ebec4
.long 0xbec40000,0xbf6d3f35,0xbec40000,0xbf6d3f35,0xbf0e0000,0xbf7b3f6d,0x3f0e250d,0x3f7bbf6d
.long 0xbf350000,0xbf353f80,0xbf350000,0xbf353f80,0xbf550000,0xbe483f6d,0x3f55250d,0x3e48bf6d
.long 0xbf6d0000,0x3ec43f35,0xbf6d0000,0x3ec43f35,0xbf7b0000,0x3f553ec4,0x3f7b250d,0xbf55bec4
.long 0xbf800000,0x3f80250d,0xbf800000,0x3f80250d,0xbf7b0000,0x3f55bec4,0x3f7b250d,0xbf553ec4
.long 0xbf6d0000,0x3ec4bf35,0xbf6d0000,0x3ec4bf35,0xbf550000,0xbe48bf6d,0x3f55250d,0x3e483f6d
.long 0xbf350000,0xbf35bf80,0xbf350000,0xbf35bf80,0xbf0e0000,0xbf7bbf6d,0x3f0e250d,0x3f7b3f6d
.long 0xbec40000,0xbf6dbf35,0xbec40000,0xbf6dbf35,0xbe480000,0xbf0ebec4,0x3e48250d,0x3f0e3ec4
.long 0x250d0000,0x250d0000,0x250d0000,0x250d0000,0xbf553f35,0xbf7b3f6d,0x3f55bf35,0x3f7bbf6d
.long 0xbf6d3f80,0xbec43f35,0xbf6d3f80,0xbec43f35,0xbe483f35,0x3f55bec4,0x3e48bf35,0xbf553ec4
.long 0x3f35250d,0x3f35bf80,0x3f35250d,0x3f35bf80,0x3f7bbf35,0xbf0ebec4,0xbf7b3f35,0x3f0e3ec4
.long 0x3ec4bf80,0xbf6d3f35,0x3ec4bf80,0xbf6d3f35,0xbf0ebf35,0x3e483f6d,0x3f0e3f35,0xbe48bf6d
.long 0xbf800000,0x3f80250d,0xbf800000,0x3f80250d,0xbf0e3f35,0x3e48bf6d,0x3f0ebf35,0xbe483f6d
.long 0x3ec43f80,0xbf6dbf35,0x3ec43f80,0xbf6dbf35,0x3f7b3f35,0xbf0e3ec4,0xbf7bbf35,0x3f0ebec4
.long 0x3f35250d,0x3f353f80,0x3f35250d,0x3f353f80,0xbe48bf35,0x3f553ec4,0x3e483f35,0xbf55bec4
.long 0xbf6dbf80,0xbec4bf35,0xbf6dbf80,0xbec4bf35,0xbf55bf35,0xbf7bbf6d,0x3f553f35,0x3f7b3f6d
.long 0x250d0000,0x250d0000,0x250d0000,0x250d0000,0xbf7b3f80,0xbf553f6d,0x3f7bbf80,0x3f55bf6d
.long 0x3ec4250d,0x3f6dbf35,0x3ec4250d,0x3f6dbf35,0x3f55bf80,0xbe48bec4,0xbf553f80,0x3e483ec4
.long 0xbf350000,0xbf353f80,0xbf350000,0xbf353f80,0xbf0e3f80,0x3f7bbec4,0x3f0ebf80,0xbf7b3ec4
.long 0x3f6d250d,0xbec4bf35,0x3f6d250d,0xbec4bf35,0x3e48bf80,0xbf0e3f6d,0xbe483f80,0x3f0ebf6d
.long 0xbf800000,0x3f80250d,0xbf800000,0x3f80250d,0x3e483f80,0xbf0ebf6d,0xbe48bf80,0x3f0e3f6d
.long 0x3f6d250d,0xbec43f35,0x3f6d250d,0xbec43f35,0xbf0ebf80,0x3f7b3ec4,0x3f0e3f80,0xbf7bbec4
.long 0xbf350000,0xbf35bf80,0xbf350000,0xbf35bf80,0x3f553f80,0xbe483ec4,0xbf55bf80,0x3e48bec4
.long 0x3ec4250d,0x3f6d3f35,0x3ec4250d,0x3f6d3f35,0xbf7bbf80,0xbf55bf6d,0x3f7b3f80,0x3f553f6d
.long 0x250d0000,0x250d0000,0x250d0000,0x250d0000,0xbf0e3f35,0xbe483ec4,0x3f0ebf35,0x3e48bec4
.long 0x3f6dbf80,0x3ec4bf35,0x3f6dbf80,0x3ec4bf35,0xbf7b3f35,0xbf0e3f6d,0x3f7bbf35,0x3f0ebf6d
.long 0x3f35250d,0x3f35bf80,0x3f35250d,0x3f35bf80,0xbe48bf35,0xbf553f6d,0x3e483f35,0x3f55bf6d
.long 0xbec43f80,0x3f6dbf35,0xbec43f80,0x3f6dbf35,0x3f55bf35,0xbf7b3ec4,0xbf553f35,0x3f7bbec4
.long 0xbf800000,0x3f80250d,0xbf800000,0x3f80250d,0x3f553f35,0xbf7bbec4,0xbf55bf35,0x3f7b3ec4
.long 0xbec4bf80,0x3f6d3f35,0xbec4bf80,0x3f6d3f35,0xbe483f35,0xbf55bf6d,0x3e48bf35,0x3f553f6d
.long 0x3f35250d,0x3f353f80,0x3f35250d,0x3f353f80,0xbf7bbf35,0xbf0ebf6d,0x3f7b3f35,0x3f0e3f6d
.long 0x3f6d3f80,0x3ec43f35,0x3f6d3f80,0x3ec43f35,0xbf0ebf35,0xbe48bec4,0x3f0e3f35,0x3e483ec4
.long 0xbf803f80,0xbf803f80,0xbf803f80,0xbf803f80,0xbf753f7f,0xbf463f62,0x3f75bf7f,0x3f46bf62
.long 0xbf553f7b,0xbe483f0e,0xbf553f7b,0xbe483f0e,0xbf223f75,0x3ef13dc9,0x3f22bf75,0xbef1bdc9
.long 0xbec43f6d,0x3f6dbec4,0xbec43f6d,0x3f6dbec4,0xbdc93f62,0x3f75bf46,0x3dc9bf62,0xbf753f46
.long 0x3e483f55,0x3f0ebf7b,0x3e483f55,0x3f0ebf7b,0x3ef13f46,0xbdc9bf75,0xbef1bf46,0x3dc93f75
.long 0x3f353f35,0xbf35bf35,0x3f353f35,0xbf35bf35,0x3f623f22,0xbf7fbe95,0xbf62bf22,0x3f7f3e95
.long 0x3f7b3f0e,0xbf553e48,0x3f7b3f0e,0xbf553e48,0x3f7f3ef1,0xbe953f22,0xbf7fbef1,0x3e95bf22
.long 0x3f6d3ec4,0x3ec43f6d,0x3f6d3ec4,0x3ec43f6d,0x3f463e95,0x3f623f7f,0xbf46be95,0xbf62bf7f
.long 0x3f0e3e48,0x3f7b3f55,0x3f0e3e48,0x3f7b3f55,0x3e953dc9,0x3f223ef1,0xbe95bdc9,0xbf22bef1
.long 0xbf803f80,0xbf803f80,0xbf803f80,0xbf803f80,0xbef13f22,0xbdc93e95,0x3ef1bf22,0x3dc9be95
.long 0x3f0ebe48,0x3f7bbf55,0x3f0ebe48,0x3f7bbf55,0x3f7fbf62,0x3e95bf46,0xbf7f3f62,0xbe953f46
.long 0x3ec4bf6d,0xbf6d3ec4,0x3ec4bf6d,0xbf6d3ec4,0xbf22be95,0xbef13f7f,0x3f223e95,0x3ef1bf7f
.long 0xbf7b3f0e,0x3f553e48,0xbf7b3f0e,0x3f553e48,0xbe953f7f,0x3f22bf62,0x3e95bf7f,0xbf223f62
.long 0x3f353f35,0xbf35bf35,0x3f353f35,0xbf35bf35,0x3f75bdc9,0xbf463ef1,0xbf753dc9,0x3f46bef1
.long 0x3e48bf55,0x3f0e3f7b,0x3e48bf55,0x3f0e3f7b,0xbf46bf75,0x3f623dc9,0x3f463f75,0xbf62bdc9
.long 0xbf6dbec4,0xbec4bf6d,0xbf6dbec4,0xbec4bf6d,0xbdc93ef1,0xbf75bf22,0x3dc9bef1,0x3f753f22
.long 0x3f553f7b,0x3e483f0e,0x3f553f7b,0x3e483f0e,0x3f623f46,0x3f7f3f75,0xbf62bf46,0xbf7fbf75
.long 0xbf803f80,0xbf803f80,0xbf803f80,0xbf803f80,0x3e95bdc9,0x3f22bef1,0xbe953dc9,0xbf223ef1
.long 0x3f55bf7b,0x3e48bf0e,0x3f55bf7b,0x3e48bf0e,0xbf463e95,0xbf623f7f,0x3f46be95,0x3f62bf7f
.long 0xbec43f6d,0x3f6dbec4,0xbec43f6d,0x3f6dbec4,0x3f7fbef1,0xbe95bf22,0xbf7f3ef1,0x3e953f22
.long 0xbe48bf55,0xbf0e3f7b,0xbe48bf55,0xbf0e3f7b,0xbf623f22,0x3f7fbe95,0x3f62bf22,0xbf7f3e95
.long 0x3f353f35,0xbf35bf35,0x3f353f35,0xbf35bf35,0x3ef1bf46,0xbdc93f75,0xbef13f46,0x3dc9bf75
.long 0xbf7bbf0e,0x3f55be48,0xbf7bbf0e,0x3f55be48,0x3dc93f62,0xbf75bf46,0xbdc9bf62,0x3f753f46
.long 0x3f6d3ec4,0x3ec43f6d,0x3f6d3ec4,0x3ec43f6d,0xbf22bf75,0x3ef1bdc9,0x3f223f75,0xbef13dc9
.long 0xbf0ebe48,0xbf7bbf55,0xbf0ebe48,0xbf7bbf55,0x3f753f7f,0x3f463f62,0xbf75bf7f,0xbf46bf62
.long 0xbf803f80,0xbf803f80,0xbf803f80,0xbf803f80,0x3f62bf46,0x3f7fbf75,0xbf623f46,0xbf7f3f75
.long 0xbf0e3e48,0xbf7b3f55,0xbf0e3e48,0xbf7b3f55,0x3dc93ef1,0x3f75bf22,0xbdc9bef1,0xbf753f22
.long 0x3ec4bf6d,0xbf6d3ec4,0x3ec4bf6d,0xbf6d3ec4,0xbf463f75,0x3f62bdc9,0x3f46bf75,0xbf623dc9
.long 0x3f7bbf0e,0xbf55be48,0x3f7bbf0e,0xbf55be48,0xbf75bdc9,0x3f463ef1,0x3f753dc9,0xbf46bef1
.long 0x3f353f35,0xbf35bf35,0x3f353f35,0xbf35bf35,0xbe95bf7f,0x3f223f62,0x3e953f7f,0xbf22bf62
.long 0xbe483f55,0xbf0ebf7b,0xbe483f55,0xbf0ebf7b,0x3f22be95,0x3ef13f7f,0xbf223e95,0xbef1bf7f
.long 0xbf6dbec4,0xbec4bf6d,0xbf6dbec4,0xbec4bf6d,0x3f7f3f62,0x3e953f46,0xbf7fbf62,0xbe95bf46
.long 0xbf55bf7b,0xbe48bf0e,0xbf55bf7b,0xbe48bf0e,0x3ef13f22,0x3dc93e95,0xbef1bf22,0xbdc9be95
.long 0x3f803f80,0x3f803f80,0x3f803f80,0x3f803f80,0x3f7b3f80,0xbe48248d,0xbf7bbf80,0x3e48a554
.long 0x3f6d3f80,0xbf6dbf80,0x3f6d3f80,0xbf6dbf80,0x3f553f80,0x3f0ea554,0xbf55bf80,0xbf0e248d
.long 0x3f353f80,0x3f353f80,0x3f353f80,0x3f353f80,0x3f0e3f80,0xbf55248d,0xbf0ebf80,0x3f55a554
.long 0x3ec43f80,0xbec4bf80,0x3ec43f80,0xbec4bf80,0x3e483f80,0x3f7ba554,0xbe48bf80,0xbf7b248d
.long 0x248d3f80,0x248d3f80,0x248d3f80,0x248d3f80,0xbe483f80,0xbf7b248d,0x3e48bf80,0x3f7ba554
.long 0xbec43f80,0x3ec4bf80,0xbec43f80,0x3ec4bf80,0xbf0e3f80,0x3f55a554,0x3f0ebf80,0xbf55248d
.long 0xbf353f80,0xbf353f80,0xbf353f80,0xbf353f80,0xbf553f80,0xbf0e248d,0x3f55bf80,0x3f0ea554
.long 0xbf6d3f80,0x3f6dbf80,0xbf6d3f80,0x3f6dbf80,0xbf7b3f80,0x3e48a554,0x3f7bbf80,0xbe48248d
.long 0x3f803f80,0x3f803f80,0x3f803f80,0x3f803f80,0x3f553f6d,0xbf0ebec4,0xbf55bf6d,0x3f0e3ec4
.long 0x3ec43f35,0xbec4bf35,0x3ec43f35,0xbec4bf35,0xbe483ec4,0x3f7b3f6d,0x3e48bec4,0xbf7bbf6d
.long 0xbf35248d,0xbf35248d,0xbf35248d,0xbf35248d,0xbf7bbec4,0xbe48bf6d,0x3f7b3ec4,0x3e483f6d
.long 0xbf6dbf35,0x3f6d3f35,0xbf6dbf35,0x3f6d3f35,0xbf0ebf6d,0xbf553ec4,0x3f0e3f6d,0x3f55bec4
.long 0xa554bf80,0xa554bf80,0xa554bf80,0xa554bf80,0x3f0ebf6d,0x3f553ec4,0xbf0e3f6d,0xbf55bec4
.long 0x3f6dbf35,0xbf6d3f35,0x3f6dbf35,0xbf6d3f35,0x3f7bbec4,0x3e48bf6d,0xbf7b3ec4,0xbe483f6d
.long 0x3f35a554,0x3f35a554,0x3f35a554,0x3f35a554,0x3e483ec4,0xbf7b3f6d,0xbe48bec4,0x3f7bbf6d
.long 0xbec43f35,0x3ec4bf35,0xbec43f35,0x3ec4bf35,0xbf553f6d,0x3f0ebec4,0x3f55bf6d,0xbf0e3ec4
.long 0x3f803f80,0x3f803f80,0x3f803f80,0x3f803f80,0x3f0e3f35,0xbf55bf35,0xbf0ebf35,0x3f553f35
.long 0xbec4248d,0x3ec4a554,0xbec4248d,0x3ec4a554,0xbf7bbf35,0x3e483f35,0x3f7b3f35,0xbe48bf35
.long 0xbf35bf80,0xbf35bf80,0xbf35bf80,0xbf35bf80,0x3e48bf35,0x3f7b3f35,0xbe483f35,0xbf7bbf35
.long 0x3f6da554,0xbf6d248d,0x3f6da554,0xbf6d248d,0x3f553f35,0x3f0ebf35,0xbf55bf35,0xbf0e3f35
.long 0x248d3f80,0x248d3f80,0x248d3f80,0x248d3f80,0xbf553f35,0xbf0ebf35,0x3f55bf35,0x3f0e3f35
.long 0xbf6d248d,0x3f6da554,0xbf6d248d,0x3f6da554,0xbe48bf35,0xbf7b3f35,0x3e483f35,0x3f7bbf35
.long 0x3f35bf80,0x3f35bf80,0x3f35bf80,0x3f35bf80,0x3f7bbf35,0xbe483f35,0xbf7b3f35,0x3e48bf35
.long 0x3ec4a554,0xbec4248d,0x3ec4a554,0xbec4248d,0xbf0e3f35,0x3f55bf35,0x3f0ebf35,0xbf553f35
.long 0x3f803f80,0x3f803f80,0x3f803f80,0x3f803f80,0x3e483ec4,0xbf7bbf6d,0xbe48bec4,0x3f7b3f6d
.long 0xbf6dbf35,0x3f6d3f35,0xbf6dbf35,0x3f6d3f35,0xbf0ebf6d,0xbf55bec4,0x3f0e3f6d,0x3f553ec4
.long 0x3f35a554,0x3f35a554,0x3f35a554,0x3f35a554,0x3f553f6d,0xbf0e3ec4,0xbf55bf6d,0x3f0ebec4
.long 0xbec43f35,0x3ec4bf35,0xbec43f35,0x3ec4bf35,0xbf7bbec4,0xbe483f6d,0x3f7b3ec4,0x3e48bf6d
.long 0xa554bf80,0xa554bf80,0xa554bf80,0xa554bf80,0x3f7bbec4,0x3e483f6d,0xbf7b3ec4,0xbe48bf6d
.long 0x3ec43f35,0xbec4bf35,0x3ec43f35,0xbec4bf35,0xbf553f6d,0x3f0e3ec4,0x3f55bf6d,0xbf0ebec4
.long 0xbf35248d,0xbf35248d,0xbf35248d,0xbf35248d,0x3f0ebf6d,0x3f55bec4,0xbf0e3f6d,0xbf553ec4
.long 0x3f6dbf35,0xbf6d3f35,0x3f6dbf35,0xbf6d3f35,0xbe483ec4,0x3f7bbf6d,0x3e48bec4,0xbf7b3f6d
.long 0x3f803f80,0x3f803f80,0x3f803f80,0x3f803f80,0x3f753f7f,0xbe95bdc9,0xbf75bf7f,0x3e953dc9
.long 0x3f553f7b,0xbf55bf7b,0x3f553f7b,0xbf55bf7b,0x3f223f75,0x3f463e95,0xbf22bf75,0xbf46be95
.long 0x3ec43f6d,0x3ec43f6d,0x3ec43f6d,0x3ec43f6d,0x3dc93f62,0xbf7fbef1,0xbdc9bf62,0x3f7f3ef1
.long 0xbe483f55,0x3e48bf55,0xbe483f55,0x3e48bf55,0xbef13f46,0x3f623f22,0x3ef1bf46,0xbf62bf22
.long 0xbf353f35,0xbf353f35,0xbf353f35,0xbf353f35,0xbf623f22,0xbef1bf46,0x3f62bf22,0x3ef13f46
.long 0xbf7b3f0e,0x3f7bbf0e,0xbf7b3f0e,0x3f7bbf0e,0xbf7f3ef1,0xbdc93f62,0x3f7fbef1,0x3dc9bf62
.long 0xbf6d3ec4,0xbf6d3ec4,0xbf6d3ec4,0xbf6d3ec4,0xbf463e95,0x3f22bf75,0x3f46be95,0xbf223f75
.long 0xbf0e3e48,0x3f0ebe48,0xbf0e3e48,0x3f0ebe48,0xbe953dc9,0xbf753f7f,0x3e95bdc9,0x3f75bf7f
.long 0x3f803f80,0x3f803f80,0x3f803f80,0x3f803f80,0x3f463f62,0xbf22bef1,0xbf46bf62,0x3f223ef1
.long 0x3e483f0e,0xbe48bf0e,0x3e483f0e,0xbe48bf0e,0xbef13dc9,0x3f623f7f,0x3ef1bdc9,0xbf62bf7f
.long 0xbf6dbec4,0xbf6dbec4,0xbf6dbec4,0xbf6dbec4,0xbf75bf46,0x3e95bf22,0x3f753f46,0xbe953f22
.long 0xbf0ebf7b,0x3f0e3f7b,0xbf0ebf7b,0x3f0e3f7b,0x3dc9bf75,0xbf7fbe95,0xbdc93f75,0x3f7f3e95
.long 0x3f35bf35,0x3f35bf35,0x3f35bf35,0x3f35bf35,0x3f7fbe95,0x3dc93f75,0xbf7f3e95,0xbdc9bf75
.long 0x3f553e48,0xbf55be48,0x3f553e48,0xbf55be48,0x3e953f22,0x3f75bf46,0xbe95bf22,0xbf753f46
.long 0xbec43f6d,0xbec43f6d,0xbec43f6d,0xbec43f6d,0xbf623f7f,0xbef1bdc9,0x3f62bf7f,0x3ef13dc9
.long 0xbf7b3f55,0x3f7bbf55,0xbf7b3f55,0x3f7bbf55,0xbf223ef1,0xbf463f62,0x3f22bef1,0x3f46bf62
.long 0x3f803f80,0x3f803f80,0x3f803f80,0x3f803f80,0x3ef13f22,0xbf62bf46,0xbef1bf22,0x3f623f46
.long 0xbf0ebe48,0x3f0e3e48,0xbf0ebe48,0x3f0e3e48,0xbf7fbf62,0xbdc93ef1,0x3f7f3f62,0x3dc9bef1
.long 0xbec4bf6d,0xbec4bf6d,0xbec4bf6d,0xbec4bf6d,0x3f22be95,0x3f463f75,0xbf223e95,0xbf46bf75
.long 0x3f7b3f0e,0xbf7bbf0e,0x3f7b3f0e,0xbf7bbf0e,0x3e953f7f,0x3f75bdc9,0xbe95bf7f,0xbf753dc9
.long 0xbf353f35,0xbf353f35,0xbf353f35,0xbf353f35,0xbf75bdc9,0x3e95bf7f,0x3f753dc9,0xbe953f7f
.long 0xbe48bf55,0x3e483f55,0xbe48bf55,0x3e483f55,0x3f46bf75,0xbf22be95,0xbf463f75,0x3f223e95
.long 0x3f6dbec4,0x3f6dbec4,0x3f6dbec4,0x3f6dbec4,0x3dc93ef1,0xbf7f3f62,0xbdc9bef1,0x3f7fbf62
.long 0xbf553f7b,0x3f55bf7b,0xbf553f7b,0x3f55bf7b,0xbf623f46,0xbef13f22,0x3f62bf46,0x3ef1bf22
.long 0x3f803f80,0x3f803f80,0x3f803f80,0x3f803f80,0x3dc93e95,0xbf7fbf75,0xbdc9be95,0x3f7f3f75
.long 0xbf7bbf55,0x3f7b3f55,0xbf7bbf55,0x3f7b3f55,0xbe95bf46,0xbf75bf22,0x3e953f46,0x3f753f22
.long 0x3f6d3ec4,0x3f6d3ec4,0x3f6d3ec4,0x3f6d3ec4,0x3ef13f7f,0xbf62bdc9,0xbef1bf7f,0x3f623dc9
.long 0xbf553e48,0x3f55be48,0xbf553e48,0x3f55be48,0xbf22bf62,0xbf463ef1,0x3f223f62,0x3f46bef1
.long 0x3f35bf35,0x3f35bf35,0x3f35bf35,0x3f35bf35,0x3f463ef1,0xbf223f62,0xbf46bef1,0x3f22bf62
.long 0xbf0e3f7b,0x3f0ebf7b,0xbf0e3f7b,0x3f0ebf7b,0xbf623dc9,0xbef13f7f,0x3f62bdc9,0x3ef1bf7f
.long 0x3ec4bf6d,0x3ec4bf6d,0x3ec4bf6d,0x3ec4bf6d,0x3f75bf22,0xbe953f46,0xbf753f22,0x3e95bf46
.long 0xbe483f0e,0x3e48bf0e,0xbe483f0e,0x3e48bf0e,0xbf7f3f75,0xbdc93e95,0x3f7fbf75,0x3dc9be95
.long 0xbf803f80,0xbf803f80,0xbf803f80,0xbf803f80,0xbf7b3f80,0x3e48248d,0x3f7bbf80,0xbe48a554
.long 0xbf6d3f80,0x3f6dbf80,0xbf6d3f80,0x3f6dbf80,0xbf553f80,0xbf0ea554,0x3f55bf80,0x3f0e248d
.long 0xbf353f80,0xbf353f80,0xbf353f80,0xbf353f80,0xbf0e3f80,0x3f55248d,0x3f0ebf80,0xbf55a554
.long 0xbec43f80,0x3ec4bf80,0xbec43f80,0x3ec4bf80,0xbe483f80,0xbf7ba554,0x3e48bf80,0x3f7b248d
.long 0xa5543f80,0xa5543f80,0xa5543f80,0xa5543f80,0x3e483f80,0x3f7b248d,0xbe48bf80,0xbf7ba554
.long 0x3ec43f80,0xbec4bf80,0x3ec43f80,0xbec4bf80,0x3f0e3f80,0xbf55a554,0xbf0ebf80,0x3f55248d
.long 0x3f353f80,0x3f353f80,0x3f353f80,0x3f353f80,0x3f553f80,0x3f0e248d,0xbf55bf80,0xbf0ea554
.long 0x3f6d3f80,0xbf6dbf80,0x3f6d3f80,0xbf6dbf80,0x3f7b3f80,0xbe48a554,0xbf7bbf80,0x3e48248d
.long 0xbf803f80,0xbf803f80,0xbf803f80,0xbf803f80,0xbf553f6d,0x3f0ebec4,0x3f55bf6d,0xbf0e3ec4
.long 0xbec43f35,0x3ec4bf35,0xbec43f35,0x3ec4bf35,0x3e483ec4,0xbf7b3f6d,0xbe48bec4,0x3f7bbf6d
.long 0x3f35248d,0x3f35248d,0x3f35248d,0x3f35248d,0x3f7bbec4,0x3e48bf6d,0xbf7b3ec4,0xbe483f6d
.long 0x3f6dbf35,0xbf6d3f35,0x3f6dbf35,0xbf6d3f35,0x3f0ebf6d,0x3f553ec4,0xbf0e3f6d,0xbf55bec4
.long 0x248dbf80,0x248dbf80,0x248dbf80,0x248dbf80,0xbf0ebf6d,0xbf553ec4,0x3f0e3f6d,0x3f55bec4
.long 0xbf6dbf35,0x3f6d3f35,0xbf6dbf35,0x3f6d3f35,0xbf7bbec4,0xbe48bf6d,0x3f7b3ec4,0x3e483f6d
.long 0xbf35a554,0xbf35a554,0xbf35a554,0xbf35a554,0xbe483ec4,0x3f7b3f6d,0x3e48bec4,0xbf7bbf6d
.long 0x3ec43f35,0xbec4bf35,0x3ec43f35,0xbec4bf35,0x3f553f6d,0xbf0ebec4,0xbf55bf6d,0x3f0e3ec4
.long 0xbf803f80,0xbf803f80,0xbf803f80,0xbf803f80,0xbf0e3f35,0x3f55bf35,0x3f0ebf35,0xbf553f35
.long 0x3ec4248d,0xbec4a554,0x3ec4248d,0xbec4a554,0x3f7bbf35,0xbe483f35,0xbf7b3f35,0x3e48bf35
.long 0x3f35bf80,0x3f35bf80,0x3f35bf80,0x3f35bf80,0xbe48bf35,0xbf7b3f35,0x3e483f35,0x3f7bbf35
.long 0xbf6da554,0x3f6d248d,0xbf6da554,0x3f6d248d,0xbf553f35,0xbf0ebf35,0x3f55bf35,0x3f0e3f35
.long 0xa5543f80,0xa5543f80,0xa5543f80,0xa5543f80,0x3f553f35,0x3f0ebf35,0xbf55bf35,0xbf0e3f35
.long 0x3f6d248d,0xbf6da554,0x3f6d248d,0xbf6da554,0x3e48bf35,0x3f7b3f35,0xbe483f35,0xbf7bbf35
.long 0xbf35bf80,0xbf35bf80,0xbf35bf80,0xbf35bf80,0xbf7bbf35,0x3e483f35,0x3f7b3f35,0xbe48bf35
.long 0xbec4a554,0x3ec4248d,0xbec4a554,0x3ec4248d,0x3f0e3f35,0xbf55bf35,0xbf0ebf35,0x3f553f35
.long 0xbf803f80,0xbf803f80,0xbf803f80,0xbf803f80,0xbe483ec4,0x3f7bbf6d,0x3e48bec4,0xbf7b3f6d
.long 0x3f6dbf35,0xbf6d3f35,0x3f6dbf35,0xbf6d3f35,0x3f0ebf6d,0x3f55bec4,0xbf0e3f6d,0xbf553ec4
.long 0xbf35a554,0xbf35a554,0xbf35a554,0xbf35a554,0xbf553f6d,0x3f0e3ec4,0x3f55bf6d,0xbf0ebec4
.long 0x3ec43f35,0xbec4bf35,0x3ec43f35,0xbec4bf35,0x3f7bbec4,0x3e483f6d,0xbf7b3ec4,0xbe48bf6d
.long 0x248dbf80,0x248dbf80,0x248dbf80,0x248dbf80,0xbf7bbec4,0xbe483f6d,0x3f7b3ec4,0x3e48bf6d
.long 0xbec43f35,0x3ec4bf35,0xbec43f35,0x3ec4bf35,0x3f553f6d,0xbf0e3ec4,0xbf55bf6d,0x3f0ebec4
.long 0x3f35248d,0x3f35248d,0x3f35248d,0x3f35248d,0xbf0ebf6d,0xbf55bec4,0x3f0e3f6d,0x3f553ec4
.long 0xbf6dbf35,0x3f6d3f35,0xbf6dbf35,0x3f6d3f35,0x3e483ec4,0xbf7bbf6d,0xbe48bec4,0x3f7b3f6d
.long 0xa554248d,0xa554248d,0xa554248d,0xa554248d,0x3e95bdc9,0x3f75bf7f,0xbe953dc9,0xbf753f7f
.long 0x3f0ebe48,0xbf0e3e48,0x3f0ebe48,0xbf0e3e48,0x3f46be95,0xbf223f75,0xbf463e95,0x3f22bf75
.long 0x3f6dbec4,0x3f6dbec4,0x3f6dbec4,0x3f6dbec4,0x3f7fbef1,0x3dc9bf62,0xbf7f3ef1,0xbdc93f62
.long 0x3f7bbf0e,0xbf7b3f0e,0x3f7bbf0e,0xbf7b3f0e,0x3f62bf22,0x3ef13f46,0xbf623f22,0xbef1bf46
.long 0x3f35bf35,0x3f35bf35,0x3f35bf35,0x3f35bf35,0x3ef1bf46,0xbf62bf22,0xbef13f46,0x3f623f22
.long 0x3e48bf55,0xbe483f55,0x3e48bf55,0xbe483f55,0xbdc9bf62,0x3f7f3ef1,0x3dc93f62,0xbf7fbef1
.long 0xbec4bf6d,0xbec4bf6d,0xbec4bf6d,0xbec4bf6d,0xbf22bf75,0xbf46be95,0x3f223f75,0x3f463e95
.long 0xbf55bf7b,0x3f553f7b,0xbf55bf7b,0x3f553f7b,0xbf75bf7f,0x3e953dc9,0x3f753f7f,0xbe95bdc9
.long 0xa554248d,0xa554248d,0xa554248d,0xa554248d,0x3f22bef1,0x3f46bf62,0xbf223ef1,0xbf463f62
.long 0x3f7bbf55,0xbf7b3f55,0x3f7bbf55,0xbf7b3f55,0x3f62bf7f,0x3ef13dc9,0xbf623f7f,0xbef1bdc9
.long 0x3ec4bf6d,0x3ec4bf6d,0x3ec4bf6d,0x3ec4bf6d,0xbe95bf22,0xbf753f46,0x3e953f22,0x3f75bf46
.long 0xbf55be48,0x3f553e48,0xbf55be48,0x3f553e48,0xbf7f3e95,0xbdc9bf75,0x3f7fbe95,0x3dc93f75
.long 0xbf353f35,0xbf353f35,0xbf353f35,0xbf353f35,0xbdc93f75,0x3f7f3e95,0x3dc9bf75,0xbf7fbe95
.long 0x3f0e3f7b,0xbf0ebf7b,0x3f0e3f7b,0xbf0ebf7b,0x3f753f46,0xbe953f22,0xbf75bf46,0x3e95bf22
.long 0x3f6d3ec4,0x3f6d3ec4,0x3f6d3ec4,0x3f6d3ec4,0x3ef1bdc9,0xbf62bf7f,0xbef13dc9,0x3f623f7f
.long 0xbe48bf0e,0x3e483f0e,0xbe48bf0e,0x3e483f0e,0xbf46bf62,0x3f223ef1,0x3f463f62,0xbf22bef1
.long 0xa554248d,0xa554248d,0xa554248d,0xa554248d,0x3f62bf46,0x3ef1bf22,0xbf623f46,0xbef13f22
.long 0x3f55bf7b,0xbf553f7b,0x3f55bf7b,0xbf553f7b,0xbdc9bef1,0x3f7fbf62,0x3dc93ef1,0xbf7f3f62
.long 0xbf6d3ec4,0xbf6d3ec4,0xbf6d3ec4,0xbf6d3ec4,0xbf463f75,0x3f223e95,0x3f46bf75,0xbf22be95
.long 0x3e483f55,0xbe48bf55,0x3e483f55,0xbe48bf55,0x3f753dc9,0xbe953f7f,0xbf75bdc9,0x3e95bf7f
.long 0x3f35bf35,0x3f35bf35,0x3f35bf35,0x3f35bf35,0xbe95bf7f,0xbf753dc9,0x3e953f7f,0x3f75bdc9
.long 0xbf7bbf0e,0x3f7b3f0e,0xbf7bbf0e,0x3f7b3f0e,0xbf223e95,0xbf46bf75,0x3f22be95,0x3f463f75
.long 0x3ec43f6d,0x3ec43f6d,0x3ec43f6d,0x3ec43f6d,0x3f7f3f62,0x3dc9bef1,0xbf7fbf62,0xbdc93ef1
.long 0x3f0e3e48,0xbf0ebe48,0x3f0e3e48,0xbf0ebe48,0xbef1bf22,0x3f623f46,0x3ef13f22,0xbf62bf46
.long 0xa554248d,0xa554248d,0xa554248d,0xa554248d,0x3f7fbf75,0x3dc9be95,0xbf7f3f75,0xbdc93e95
.long 0x3e48bf0e,0xbe483f0e,0x3e48bf0e,0xbe483f0e,0xbf753f22,0x3e95bf46,0x3f75bf22,0xbe953f46
.long 0xbec43f6d,0xbec43f6d,0xbec43f6d,0xbec43f6d,0x3f62bdc9,0x3ef1bf7f,0xbf623dc9,0xbef13f7f
.long 0x3f0ebf7b,0xbf0e3f7b,0x3f0ebf7b,0xbf0e3f7b,0xbf46bef1,0x3f22bf62,0x3f463ef1,0xbf223f62
.long 0xbf353f35,0xbf353f35,0xbf353f35,0xbf353f35,0x3f223f62,0x3f46bef1,0xbf22bf62,0xbf463ef1
.long 0x3f55be48,0xbf553e48,0x3f55be48,0xbf553e48,0xbef1bf7f,0x3f623dc9,0x3ef13f7f,0xbf62bdc9
.long 0xbf6dbec4,0xbf6dbec4,0xbf6dbec4,0xbf6dbec4,0x3e953f46,0x3f753f22,0xbe95bf46,0xbf75bf22
.long 0x3f7b3f55,0xbf7bbf55,0x3f7b3f55,0xbf7bbf55,0xbdc9be95,0x3f7f3f75,0x3dc93e95,0xbf7fbf75
.long 0x0,0x0,0x0,0x0,0x3e480000,0x3f7b3f80,0xbe48250d,0xbf7bbf80
.long 0x3ec40000,0xbec4250d,0x3ec40000,0xbec4250d,0x3f0e0000,0xbf55bf80,0xbf0e250d,0x3f553f80
.long 0x3f350000,0x3f350000,0x3f350000,0x3f350000,0x3f550000,0x3f0e3f80,0xbf55250d,0xbf0ebf80
.long 0x3f6d0000,0xbf6d250d,0x3f6d0000,0xbf6d250d,0x3f7b0000,0xbe48bf80,0xbf7b250d,0x3e483f80
.long 0x3f800000,0x3f800000,0x3f800000,0x3f800000,0x3f7b0000,0xbe483f80,0xbf7b250d,0x3e48bf80
.long 0x3f6d0000,0xbf6d250d,0x3f6d0000,0xbf6d250d,0x3f550000,0x3f0ebf80,0xbf55250d,0xbf0e3f80
.long 0x3f350000,0x3f350000,0x3f350000,0x3f350000,0x3f0e0000,0xbf553f80,0xbf0e250d,0x3f55bf80
.long 0x3ec40000,0xbec4250d,0x3ec40000,0xbec4250d,0x3e480000,0x3f7bbf80,0xbe48250d,0xbf7b3f80
.long 0x0,0x0,0x0,0x0,0x3f0e3ec4,0x3f553f6d,0xbf0ebec4,0xbf55bf6d
.long 0x3f6d3f35,0xbf6dbf35,0x3f6d3f35,0xbf6dbf35,0x3f7b3f6d,0x3e48bec4,0xbf7bbf6d,0xbe483ec4
.long 0x3f353f80,0x3f353f80,0x3f353f80,0x3f353f80,0x3e483f6d,0xbf7bbec4,0xbe48bf6d,0x3f7b3ec4
.long 0xbec43f35,0x3ec4bf35,0xbec43f35,0x3ec4bf35,0xbf553ec4,0x3f0e3f6d,0x3f55bec4,0xbf0ebf6d
.long 0xbf80250d,0xbf80250d,0xbf80250d,0xbf80250d,0xbf55bec4,0x3f0ebf6d,0x3f553ec4,0xbf0e3f6d
.long 0xbec4bf35,0x3ec43f35,0xbec4bf35,0x3ec43f35,0x3e48bf6d,0xbf7b3ec4,0xbe483f6d,0x3f7bbec4
.long 0x3f35bf80,0x3f35bf80,0x3f35bf80,0x3f35bf80,0x3f7bbf6d,0x3e483ec4,0xbf7b3f6d,0xbe48bec4
.long 0x3f6dbf35,0xbf6d3f35,0x3f6dbf35,0xbf6d3f35,0x3f0ebec4,0x3f55bf6d,0xbf0e3ec4,0xbf553f6d
.long 0x0,0x0,0x0,0x0,0x3f553f35,0x3f0e3f35,0xbf55bf35,0xbf0ebf35
.long 0x3f6d3f80,0xbf6dbf80,0x3f6d3f80,0xbf6dbf80,0x3e483f35,0x3f7b3f35,0xbe48bf35,0xbf7bbf35
.long 0xbf35250d,0xbf35250d,0xbf35250d,0xbf35250d,0xbf7bbf35,0x3e48bf35,0x3f7b3f35,0xbe483f35
.long 0xbec4bf80,0x3ec43f80,0xbec4bf80,0x3ec43f80,0x3f0ebf35,0xbf55bf35,0xbf0e3f35,0x3f553f35
.long 0x3f800000,0x3f800000,0x3f800000,0x3f800000,0x3f0e3f35,0xbf553f35,0xbf0ebf35,0x3f55bf35
.long 0xbec43f80,0x3ec4bf80,0xbec43f80,0x3ec4bf80,0xbf7b3f35,0x3e483f35,0x3f7bbf35,0xbe48bf35
.long 0xbf35250d,0xbf35250d,0xbf35250d,0xbf35250d,0x3e48bf35,0x3f7bbf35,0xbe483f35,0xbf7b3f35
.long 0x3f6dbf80,0xbf6d3f80,0x3f6dbf80,0xbf6d3f80,0x3f55bf35,0x3f0ebf35,0xbf553f35,0xbf0e3f35
.long 0x0,0x0,0x0,0x0,0x3f7b3f6d,0x3e483ec4,0xbf7bbf6d,0xbe48bec4
.long 0x3ec43f35,0xbec4bf35,0x3ec43f35,0xbec4bf35,0xbf55bec4,0x3f0e3f6d,0x3f553ec4,0xbf0ebf6d
.long 0xbf35bf80,0xbf35bf80,0xbf35bf80,0xbf35bf80,0x3f0ebec4,0x3f553f6d,0xbf0e3ec4,0xbf55bf6d
.long 0x3f6d3f35,0xbf6dbf35,0x3f6d3f35,0xbf6dbf35,0xbe483f6d,0x3f7b3ec4,0x3e48bf6d,0xbf7bbec4
.long 0xbf80250d,0xbf80250d,0xbf80250d,0xbf80250d,0xbe48bf6d,0x3f7bbec4,0x3e483f6d,0xbf7b3ec4
.long 0x3f6dbf35,0xbf6d3f35,0x3f6dbf35,0xbf6d3f35,0x3f0e3ec4,0x3f55bf6d,0xbf0ebec4,0xbf553f6d
.long 0xbf353f80,0xbf353f80,0xbf353f80,0xbf353f80,0xbf553ec4,0x3f0ebf6d,0x3f55bec4,0xbf0e3f6d
.long 0x3ec4bf35,0xbec43f35,0x3ec4bf35,0xbec43f35,0x3f7bbf6d,0x3e48bec4,0xbf7b3f6d,0xbe483ec4
.long 0x0,0x0,0x0,0x0,0x3e953dc9,0x3f753f7f,0xbe95bdc9,0xbf75bf7f
.long 0x3f0e3e48,0xbf0ebe48,0x3f0e3e48,0xbf0ebe48,0x3f463e95,0xbf22bf75,0xbf46be95,0x3f223f75
.long 0x3f6d3ec4,0x3f6d3ec4,0x3f6d3ec4,0x3f6d3ec4,0x3f7f3ef1,0x3dc93f62,0xbf7fbef1,0xbdc9bf62
.long 0x3f7b3f0e,0xbf7bbf0e,0x3f7b3f0e,0xbf7bbf0e,0x3f623f22,0x3ef1bf46,0xbf62bf22,0xbef13f46
.long 0x3f353f35,0x3f353f35,0x3f353f35,0x3f353f35,0x3ef13f46,0xbf623f22,0xbef1bf46,0x3f62bf22
.long 0x3e483f55,0xbe48bf55,0x3e483f55,0xbe48bf55,0xbdc93f62,0x3f7fbef1,0x3dc9bf62,0xbf7f3ef1
.long 0xbec43f6d,0xbec43f6d,0xbec43f6d,0xbec43f6d,0xbf223f75,0xbf463e95,0x3f22bf75,0x3f46be95
.long 0xbf553f7b,0x3f55bf7b,0xbf553f7b,0x3f55bf7b,0xbf753f7f,0x3e95bdc9,0x3f75bf7f,0xbe953dc9
.long 0x0,0x0,0x0,0x0,0x3f223ef1,0x3f463f62,0xbf22bef1,0xbf46bf62
.long 0x3f7b3f55,0xbf7bbf55,0x3f7b3f55,0xbf7bbf55,0x3f623f7f,0x3ef1bdc9,0xbf62bf7f,0xbef13dc9
.long 0x3ec43f6d,0x3ec43f6d,0x3ec43f6d,0x3ec43f6d,0xbe953f22,0xbf75bf46,0x3e95bf22,0x3f753f46
.long 0xbf553e48,0x3f55be48,0xbf553e48,0x3f55be48,0xbf7fbe95,0xbdc93f75,0x3f7f3e95,0x3dc9bf75
.long 0xbf35bf35,0xbf35bf35,0xbf35bf35,0xbf35bf35,0xbdc9bf75,0x3f7fbe95,0x3dc93f75,0xbf7f3e95
.long 0x3f0ebf7b,0xbf0e3f7b,0x3f0ebf7b,0xbf0e3f7b,0x3f75bf46,0xbe95bf22,0xbf753f46,0x3e953f22
.long 0x3f6dbec4,0x3f6dbec4,0x3f6dbec4,0x3f6dbec4,0x3ef13dc9,0xbf623f7f,0xbef1bdc9,0x3f62bf7f
.long 0xbe483f0e,0x3e48bf0e,0xbe483f0e,0x3e48bf0e,0xbf463f62,0x3f22bef1,0x3f46bf62,0xbf223ef1
.long 0x0,0x0,0x0,0x0,0x3f623f46,0x3ef13f22,0xbf62bf46,0xbef1bf22
.long 0x3f553f7b,0xbf55bf7b,0x3f553f7b,0xbf55bf7b,0xbdc93ef1,0x3f7f3f62,0x3dc9bef1,0xbf7fbf62
.long 0xbf6dbec4,0xbf6dbec4,0xbf6dbec4,0xbf6dbec4,0xbf46bf75,0x3f22be95,0x3f463f75,0xbf223e95
.long 0x3e48bf55,0xbe483f55,0x3e48bf55,0xbe483f55,0x3f75bdc9,0xbe95bf7f,0xbf753dc9,0x3e953f7f
.long 0x3f353f35,0x3f353f35,0x3f353f35,0x3f353f35,0xbe953f7f,0xbf75bdc9,0x3e95bf7f,0x3f753dc9
.long 0xbf7b3f0e,0x3f7bbf0e,0xbf7b3f0e,0x3f7bbf0e,0xbf22be95,0xbf463f75,0x3f223e95,0x3f46bf75
.long 0x3ec4bf6d,0x3ec4bf6d,0x3ec4bf6d,0x3ec4bf6d,0x3f7fbf62,0x3dc93ef1,0xbf7f3f62,0xbdc9bef1
.long 0x3f0ebe48,0xbf0e3e48,0x3f0ebe48,0xbf0e3e48,0xbef13f22,0x3f62bf46,0x3ef1bf22,0xbf623f46
.long 0x0,0x0,0x0,0x0,0x3f7f3f75,0x3dc93e95,0xbf7fbf75,0xbdc9be95
.long 0x3e483f0e,0xbe48bf0e,0x3e483f0e,0xbe48bf0e,0xbf75bf22,0x3e953f46,0x3f753f22,0xbe95bf46
.long 0xbec4bf6d,0xbec4bf6d,0xbec4bf6d,0xbec4bf6d,0x3f623dc9,0x3ef13f7f,0xbf62bdc9,0xbef1bf7f
.long 0x3f0e3f7b,0xbf0ebf7b,0x3f0e3f7b,0xbf0ebf7b,0xbf463ef1,0x3f223f62,0x3f46bef1,0xbf22bf62
.long 0xbf35bf35,0xbf35bf35,0xbf35bf35,0xbf35bf35,0x3f22bf62,0x3f463ef1,0xbf223f62,0xbf46bef1
.long 0x3f553e48,0xbf55be48,0x3f553e48,0xbf55be48,0xbef13f7f,0x3f62bdc9,0x3ef1bf7f,0xbf623dc9
.long 0xbf6d3ec4,0xbf6d3ec4,0xbf6d3ec4,0xbf6d3ec4,0x3e95bf46,0x3f75bf22,0xbe953f46,0xbf753f22
.long 0x3f7bbf55,0xbf7b3f55,0x3f7bbf55,0xbf7b3f55,0xbdc93e95,0x3f7fbf75,0x3dc9be95,0xbf7f3f75
.long 0x250d0000,0x250d0000,0x250d0000,0x250d0000,0xbe480000,0xbf7b3f80,0x3e48250d,0x3f7bbf80
.long 0xbec40000,0x3ec4250d,0xbec40000,0x3ec4250d,0xbf0e0000,0x3f55bf80,0x3f0e250d,0xbf553f80
.long 0xbf350000,0xbf350000,0xbf350000,0xbf350000,0xbf550000,0xbf0e3f80,0x3f55250d,0x3f0ebf80
.long 0xbf6d0000,0x3f6d250d,0xbf6d0000,0x3f6d250d,0xbf7b0000,0x3e48bf80,0x3f7b250d,0xbe483f80
.long 0xbf800000,0xbf800000,0xbf800000,0xbf800000,0xbf7b0000,0x3e483f80,0x3f7b250d,0xbe48bf80
.long 0xbf6d0000,0x3f6d250d,0xbf6d0000,0x3f6d250d,0xbf550000,0xbf0ebf80,0x3f55250d,0x3f0e3f80
.long 0xbf350000,0xbf350000,0xbf350000,0xbf350000,0xbf0e0000,0x3f553f80,0x3f0e250d,0xbf55bf80
.long 0xbec40000,0x3ec4250d,0xbec40000,0x3ec4250d,0xbe480000,0xbf7bbf80,0x3e48250d,0x3f7b3f80
.long 0x250d0000,0x250d0000,0x250d0000,0x250d0000,0xbf0e3ec4,0xbf553f6d,0x3f0ebec4,0x3f55bf6d
.long 0xbf6d3f35,0x3f6dbf35,0xbf6d3f35,0x3f6dbf35,0xbf7b3f6d,0xbe48bec4,0x3f7bbf6d,0x3e483ec4
.long 0xbf353f80,0xbf353f80,0xbf353f80,0xbf353f80,0xbe483f6d,0x3f7bbec4,0x3e48bf6d,0xbf7b3ec4
.long 0x3ec43f35,0xbec4bf35,0x3ec43f35,0xbec4bf35,0x3f553ec4,0xbf0e3f6d,0xbf55bec4,0x3f0ebf6d
.long 0x3f80250d,0x3f80250d,0x3f80250d,0x3f80250d,0x3f55bec4,0xbf0ebf6d,0xbf553ec4,0x3f0e3f6d
.long 0x3ec4bf35,0xbec43f35,0x3ec4bf35,0xbec43f35,0xbe48bf6d,0x3f7b3ec4,0x3e483f6d,0xbf7bbec4
.long 0xbf35bf80,0xbf35bf80,0xbf35bf80,0xbf35bf80,0xbf7bbf6d,0xbe483ec4,0x3f7b3f6d,0x3e48bec4
.long 0xbf6dbf35,0x3f6d3f35,0xbf6dbf35,0x3f6d3f35,0xbf0ebec4,0xbf55bf6d,0x3f0e3ec4,0x3f553f6d
.long 0x250d0000,0x250d0000,0x250d0000,0x250d0000,0xbf553f35,0xbf0e3f35,0x3f55bf35,0x3f0ebf35
.long 0xbf6d3f80,0x3f6dbf80,0xbf6d3f80,0x3f6dbf80,0xbe483f35,0xbf7b3f35,0x3e48bf35,0x3f7bbf35
.long 0x3f35250d,0x3f35250d,0x3f35250d,0x3f35250d,0x3f7bbf35,0xbe48bf35,0xbf7b3f35,0x3e483f35
.long 0x3ec4bf80,0xbec43f80,0x3ec4bf80,0xbec43f80,0xbf0ebf35,0x3f55bf35,0x3f0e3f35,0xbf553f35
.long 0xbf800000,0xbf800000,0xbf800000,0xbf800000,0xbf0e3f35,0x3f553f35,0x3f0ebf35,0xbf55bf35
.long 0x3ec43f80,0xbec4bf80,0x3ec43f80,0xbec4bf80,0x3f7b3f35,0xbe483f35,0xbf7bbf35,0x3e48bf35
.long 0x3f35250d,0x3f35250d,0x3f35250d,0x3f35250d,0xbe48bf35,0xbf7bbf35,0x3e483f35,0x3f7b3f35
.long 0xbf6dbf80,0x3f6d3f80,0xbf6dbf80,0x3f6d3f80,0xbf55bf35,0xbf0ebf35,0x3f553f35,0x3f0e3f35
.long 0x250d0000,0x250d0000,0x250d0000,0x250d0000,0xbf7b3f6d,0xbe483ec4,0x3f7bbf6d,0x3e48bec4
.long 0xbec43f35,0x3ec4bf35,0xbec43f35,0x3ec4bf35,0x3f55bec4,0xbf0e3f6d,0xbf553ec4,0x3f0ebf6d
.long 0x3f35bf80,0x3f35bf80,0x3f35bf80,0x3f35bf80,0xbf0ebec4,0xbf553f6d,0x3f0e3ec4,0x3f55bf6d
.long 0xbf6d3f35,0x3f6dbf35,0xbf6d3f35,0x3f6dbf35,0x3e483f6d,0xbf7b3ec4,0xbe48bf6d,0x3f7bbec4
.long 0x3f80250d,0x3f80250d,0x3f80250d,0x3f80250d,0x3e48bf6d,0xbf7bbec4,0xbe483f6d,0x3f7b3ec4
.long 0xbf6dbf35,0x3f6d3f35,0xbf6dbf35,0x3f6d3f35,0xbf0e3ec4,0xbf55bf6d,0x3f0ebec4,0x3f553f6d
.long 0x3f353f80,0x3f353f80,0x3f353f80,0x3f353f80,0x3f553ec4,0xbf0ebf6d,0xbf55bec4,0x3f0e3f6d
.long 0xbec4bf35,0x3ec43f35,0xbec4bf35,0x3ec43f35,0xbf7bbf6d,0xbe48bec4,0x3f7b3f6d,0x3e483ec4
.long 0xbf803f80,0xbf803f80,0xbf803f80,0xbf803f80,0xbf753f7f,0x3e95bdc9,0x3f75bf7f,0xbe953dc9
.long 0xbf553f7b,0x3f55bf7b,0xbf553f7b,0x3f55bf7b,0xbf223f75,0xbf463e95,0x3f22bf75,0x3f46be95
.long 0xbec43f6d,0xbec43f6d,0xbec43f6d,0xbec43f6d,0xbdc93f62,0x3f7fbef1,0x3dc9bf62,0xbf7f3ef1
.long 0x3e483f55,0xbe48bf55,0x3e483f55,0xbe48bf55,0x3ef13f46,0xbf623f22,0xbef1bf46,0x3f62bf22
.long 0x3f353f35,0x3f353f35,0x3f353f35,0x3f353f35,0x3f623f22,0x3ef1bf46,0xbf62bf22,0xbef13f46
.long 0x3f7b3f0e,0xbf7bbf0e,0x3f7b3f0e,0xbf7bbf0e,0x3f7f3ef1,0x3dc93f62,0xbf7fbef1,0xbdc9bf62
.long 0x3f6d3ec4,0x3f6d3ec4,0x3f6d3ec4,0x3f6d3ec4,0x3f463e95,0xbf22bf75,0xbf46be95,0x3f223f75
.long 0x3f0e3e48,0xbf0ebe48,0x3f0e3e48,0xbf0ebe48,0x3e953dc9,0x3f753f7f,0xbe95bdc9,0xbf75bf7f
.long 0xbf803f80,0xbf803f80,0xbf803f80,0xbf803f80,0xbf463f62,0x3f22bef1,0x3f46bf62,0xbf223ef1
.long 0xbe483f0e,0x3e48bf0e,0xbe483f0e,0x3e48bf0e,0x3ef13dc9,0xbf623f7f,0xbef1bdc9,0x3f62bf7f
.long 0x3f6dbec4,0x3f6dbec4,0x3f6dbec4,0x3f6dbec4,0x3f75bf46,0xbe95bf22,0xbf753f46,0x3e953f22
.long 0x3f0ebf7b,0xbf0e3f7b,0x3f0ebf7b,0xbf0e3f7b,0xbdc9bf75,0x3f7fbe95,0x3dc93f75,0xbf7f3e95
.long 0xbf35bf35,0xbf35bf35,0xbf35bf35,0xbf35bf35,0xbf7fbe95,0xbdc93f75,0x3f7f3e95,0x3dc9bf75
.long 0xbf553e48,0x3f55be48,0xbf553e48,0x3f55be48,0xbe953f22,0xbf75bf46,0x3e95bf22,0x3f753f46
.long 0x3ec43f6d,0x3ec43f6d,0x3ec43f6d,0x3ec43f6d,0x3f623f7f,0x3ef1bdc9,0xbf62bf7f,0xbef13dc9
.long 0x3f7b3f55,0xbf7bbf55,0x3f7b3f55,0xbf7bbf55,0x3f223ef1,0x3f463f62,0xbf22bef1,0xbf46bf62
.long 0xbf803f80,0xbf803f80,0xbf803f80,0xbf803f80,0xbef13f22,0x3f62bf46,0x3ef1bf22,0xbf623f46
.long 0x3f0ebe48,0xbf0e3e48,0x3f0ebe48,0xbf0e3e48,0x3f7fbf62,0x3dc93ef1,0xbf7f3f62,0xbdc9bef1
.long 0x3ec4bf6d,0x3ec4bf6d,0x3ec4bf6d,0x3ec4bf6d,0xbf22be95,0xbf463f75,0x3f223e95,0x3f46bf75
.long 0xbf7b3f0e,0x3f7bbf0e,0xbf7b3f0e,0x3f7bbf0e,0xbe953f7f,0xbf75bdc9,0x3e95bf7f,0x3f753dc9
.long 0x3f353f35,0x3f353f35,0x3f353f35,0x3f353f35,0x3f75bdc9,0xbe95bf7f,0xbf753dc9,0x3e953f7f
.long 0x3e48bf55,0xbe483f55,0x3e48bf55,0xbe483f55,0xbf46bf75,0x3f22be95,0x3f463f75,0xbf223e95
.long 0xbf6dbec4,0xbf6dbec4,0xbf6dbec4,0xbf6dbec4,0xbdc93ef1,0x3f7f3f62,0x3dc9bef1,0xbf7fbf62
.long 0x3f553f7b,0xbf55bf7b,0x3f553f7b,0xbf55bf7b,0x3f623f46,0x3ef13f22,0xbf62bf46,0xbef1bf22
.long 0xbf803f80,0xbf803f80,0xbf803f80,0xbf803f80,0xbdc93e95,0x3f7fbf75,0x3dc9be95,0xbf7f3f75
.long 0x3f7bbf55,0xbf7b3f55,0x3f7bbf55,0xbf7b3f55,0x3e95bf46,0x3f75bf22,0xbe953f46,0xbf753f22
.long 0xbf6d3ec4,0xbf6d3ec4,0xbf6d3ec4,0xbf6d3ec4,0xbef13f7f,0x3f62bdc9,0x3ef1bf7f,0xbf623dc9
.long 0x3f553e48,0xbf55be48,0x3f553e48,0xbf55be48,0x3f22bf62,0x3f463ef1,0xbf223f62,0xbf46bef1
.long 0xbf35bf35,0xbf35bf35,0xbf35bf35,0xbf35bf35,0xbf463ef1,0x3f223f62,0x3f46bef1,0xbf22bf62
.long 0x3f0e3f7b,0xbf0ebf7b,0x3f0e3f7b,0xbf0ebf7b,0x3f623dc9,0x3ef13f7f,0xbf62bdc9,0xbef1bf7f
.long 0xbec4bf6d,0xbec4bf6d,0xbec4bf6d,0xbec4bf6d,0xbf75bf22,0x3e953f46,0x3f753f22,0xbe95bf46
.long 0x3e483f0e,0xbe48bf0e,0x3e483f0e,0xbe48bf0e,0x3f7f3f75,0x3dc93e95,0xbf7fbf75,0xbdc9be95
.size F_TAB, 30720
.section .rodata,"a"
.p2align 6
.amdhsa_kernel f_kernel
  .amdhsa_next_free_vgpr 256
  .amdhsa_next_free_sgpr 102
  .amdhsa_accum_offset 256
  .amdhsa_group_segment_fixed_size 0
  .amdhsa_kernarg_size 80
  .amdhsa_user_sgpr_count 2
  .amdhsa_user_sgpr_kernarg_segment_ptr 1
  .amdhsa_system_sgpr_workgroup_id_x 1
.end_amdhsa_kernel
```
